```python
import torch

def _softmax(x, axis=-1):
    return torch.softmax(x, dim=axis)
def _gelu(x):
    return torch.nn.functional.gelu(x, approximate="tanh")
def _silu(x):
    return torch.nn.functional.silu(x)
def _sigmoid(x):
    return torch.sigmoid(x)
def _layernorm(x, axis=-1, eps=1e-5):
    m = x.mean(dim=axis, keepdim=True)
    v = x.var(dim=axis, keepdim=True, unbiased=False)
    return (x - m) / torch.sqrt(v + eps)
def _scatter_add(tgt, idx, src, axis=0):
    return tgt.clone().index_add_(axis, idx, src)
def _segment_sum(src, seg, n):
    out = torch.zeros((n,) + src.shape[1:], dtype=src.dtype)
    return out.index_add_(0, seg, src)
def _pad(x, pw):
    flat = tuple(v for pair in reversed(pw) for v in pair)
    return torch.nn.functional.pad(x, flat)

kernel_name = 'interleave_layers__sliding_local_dilated__glu_gated_reglu__prompt'

def setup_inputs():

    _w = (lambda a: (lambda t: t.to(torch.bfloat16) if t.is_floating_point() else t)(torch.as_tensor(a)))
    def _A_setup():
        B, S, D = 1, 2048, 512
        return {
            "x": _w((lambda *s: torch.randn(*s, dtype=torch.bfloat16) * 0.05)(B, S, D)),
            "wqkv": _w((lambda *s: torch.randn(*s, dtype=torch.bfloat16) * 0.05)(D, 3 * D)),
            "wo": _w((lambda *s: torch.randn(*s, dtype=torch.bfloat16) * 0.05)(D, D)),
        }
    _A_in = _A_setup()

    def _B_setup():
        B, S, D, F = 1, 2048, 512, 1792
        return {
            "x": _w((lambda *s: torch.randn(*s, dtype=torch.bfloat16) * 0.05)(B, S, D)),
            "W_gate": _w((lambda *s: torch.randn(*s, dtype=torch.bfloat16) * 0.8)(D, F) * (2.0 / D) ** 0.5),
            "W_up": _w((lambda *s: torch.randn(*s, dtype=torch.bfloat16) * 0.8)(D, F) * (2.0 / D) ** 0.5),
            "W_down": _w((lambda *s: torch.randn(*s, dtype=torch.bfloat16) * 0.8)(F, D) * (1.0 / F) ** 0.5),
        }
    _B_in = _B_setup()

    return {
        "A_x": _A_in["x"],
        "A_wqkv": _A_in["wqkv"],
        "A_wo": _A_in["wo"],
        "B_x": _B_in["x"],
        "B_W_gate": _B_in["W_gate"],
        "B_W_up": _B_in["W_up"],
        "B_W_down": _B_in["W_down"],
    }

def reference(A_x, A_wqkv, A_wo, B_x, B_W_gate, B_W_up, B_W_down):
    def _A_ref(x, wqkv, wo):
        B, S, D = x.shape
        H = 32; Dh = D // H
        W, dil = 8, 2
        qkv = (lambda x, *d: x.permute(*d))((x @ wqkv).reshape(B, S, 3, H, Dh), 2, 0, 3, 1, 4)
        q, k, v = qkv[0], qkv[1], qkv[2]
        scale = Dh ** -0.5
        pos = torch.arange(S)
        off = torch.arange(W) * dil
        idx = pos[:, None] - off[None, :]
        mask = idx >= 0
        idx_c = torch.where(mask, idx, 0).reshape(-1)
        kg = k[:, :, idx_c, :].reshape(B, H, S, W, Dh)
        vg = v[:, :, idx_c, :].reshape(B, H, S, W, Dh)
        logits = torch.einsum("bhsd,bhswd->bhsw", q, kg) * scale
        logits = torch.where(mask[None, None, :, :], logits, -1e9)
        attn = _softmax(logits, axis=-1)
        o = torch.einsum("bhsw,bhswd->bhsd", attn, vg)
        return (lambda x, *d: x.permute(*d))(o, 0, 2, 1, 3).reshape(B, S, D) @ wo

    def _B_ref(x, W_gate, W_up, W_down):
        gate = torch.einsum("bsd,df->bsf", x, W_gate)
        up = torch.einsum("bsd,df->bsf", x, W_up)
        gate = gate * (lambda x, dt: x.to(dt))(gate > 0, gate.dtype)
        h = gate * up
        return torch.einsum("bsf,fd->bsd", h, W_down)

    x = A_x
    x = x + _A_ref(_layernorm(x, axis=-1), A_wqkv, A_wo)
    x = x + _B_ref(_layernorm(x, axis=-1), B_W_gate, B_W_up, B_W_down)
    x = x + _A_ref(_layernorm(x, axis=-1), A_wqkv, A_wo)
    x = x + _B_ref(_layernorm(x, axis=-1), B_W_gate, B_W_up, B_W_down)
    return x
```

```asm
; @launch grid=(256,1,1) block=(256,1,1) lds=138240
.amdgcn_target "amdgcn-amd-amdhsa--gfx950"
.text
.globl interleave_layers__sliding_local_dilated__glu_gated_reglu__prompt_kernel
.p2align 8
.type interleave_layers__sliding_local_dilated__glu_gated_reglu__prompt_kernel,@function
interleave_layers__sliding_local_dilated__glu_gated_reglu__prompt_kernel:
L_top:
    s_cmp_ge_u32 s2, 256
    s_cbranch_scc1 L_exit
    s_load_dwordx16 s[36:51], s[0:1], 0
    s_load_dwordx4 s[52:55], s[0:1], 64
    s_and_b32 s3, s2, 7
    s_lshr_b32 s33, s2, 3
    v_lshrrev_b32 v1, 6, v0
    v_and_b32 v0, 63, v0
    v_readfirstlane_b32 s34, v1
    s_getreg_b32 s35, hwreg(HW_REG_XCC_ID)
    s_and_b32 s35, s35, 15
    s_or_b32 s35, s35, 0x80
    s_mov_b32 s56, 200000
    s_mov_b32 s74, 0
    v_mov_b32 v7, 0
    v_and_b32 v1, 15, v0
    v_lshrrev_b32 v2, 4, v0
    v_lshlrev_b32 v3, 4, v0
    s_lshl_b32 s65, s3, 11
    s_mov_b32 s79, s65
    s_cmp_ge_u32 s33, 24
    s_cbranch_scc1 L_nopf
    s_lshl_b32 s63, s33, 2
    s_add_u32 s63, s63, s34
    s_getpc_b64 s[26:27]
L_pc_1:
    s_sub_u32 s26, s26, L_pc_1-L_top
    s_subb_u32 s27, s27, 0
    v_and_b32 v8, 3, v0
    v_mul_u32_u24 v8, 96, v8
    v_add_lshl_u32 v8, v8, s63, 7
    v_min_u32 v8, L_exit-L_top, v8
    v_mov_b32 v255, s27
    v_add_co_u32 v254, vcc, s26, v8
    s_nop 1
    v_addc_co_u32 v255, vcc, 0, v255, vcc
    global_load_dword v252, v[254:255], off
L_nopf:
    v_mov_b32 v12, 0x3f803f80
    v_mov_b32 v13, 0x3f803f80
    v_mov_b32 v14, 0x3f803f80
    v_mov_b32 v15, 0x3f803f80
    s_lshl_b32 s63, s34, 8
    s_add_u32 s63, s63, 137216
    v_lshl_add_u32 v246, v0, 2, s63
    v_mul_u32_u24 v247, 20, v0
    v_and_b32 v247, 1020, v247
    v_add_u32 v247, 137216, v247
    v_mov_b32 v248, 0
    ds_write_b32 v246, v248
    s_waitcnt lgkmcnt(0)
    s_mov_b32 s4, s54
    s_mov_b32 s5, s55
    s_mov_b32 s6, 268435456
    s_mov_b32 s7, 0x20000
    s_mov_b32 s20, s52
    s_mov_b32 s21, s53
    s_mov_b32 s22, 256
    s_mov_b32 s23, 0x20000
    s_cmp_lt_u32 s33, 8
    s_cbranch_scc1 L_qkv
    s_cmp_lt_u32 s33, 10
    s_cbranch_scc1 L_wo
    s_cmp_lt_u32 s33, 24
    s_cbranch_scc1 L_gu
    s_branch L_dn
L_qkv:
    s_mov_b32 s8, s38
    s_mov_b32 s9, s39
    s_mov_b32 s10, 1572864
    s_mov_b32 s11, 0x20000
    s_mov_b32 s12, s36
    s_mov_b32 s13, s37
    s_mov_b32 s14, 2097152
    s_mov_b32 s15, 0x20000
    v_lshrrev_b32 v8, 3, v0
    s_lshl_b32 s63, s34, 3
    v_add_u32 v9, s63, v8
    v_mul_u32_u24 v16, 3072, v9
    v_and_b32 v8, 2, v8
    s_and_b32 s63, s34, 1
    s_lshl_b32 s63, s63, 2
    v_or_b32 v8, s63, v8
    v_and_b32 v9, 7, v0
    v_xor_b32 v8, v8, v9
    v_lshl_add_u32 v16, v8, 4, v16
    s_lshl_b32 s63, s33, 7
    v_add_u32 v16, s63, v16
    s_mul_i32 s62, s34, 3072
    s_add_u32 s62, s62, 40960
    s_mov_b32 s70, 0
    v_add_u32 v8, 0, v2
    v_xor_b32 v9, v8, v1
    v_lshlrev_b32 v18, 10, v2
    v_lshl_add_u32 v18, v9, 4, v18
    s_lshl_b32 s63, s34, 8
    s_add_u32 s63, s63, 0
    v_add_u32 v18, s63, v18
    v_add_u32 v8, 4, v2
    v_xor_b32 v9, v8, v1
    v_lshlrev_b32 v19, 10, v2
    v_lshl_add_u32 v19, v9, 4, v19
    s_lshl_b32 s63, s34, 8
    s_add_u32 s63, s63, 3072
    v_add_u32 v19, s63, v19
    v_add_u32 v8, 8, v2
    v_xor_b32 v9, v8, v1
    v_lshlrev_b32 v20, 10, v2
    v_lshl_add_u32 v20, v9, 4, v20
    s_lshl_b32 s63, s34, 8
    s_add_u32 s63, s63, 6144
    v_add_u32 v20, s63, v20
    v_add_u32 v8, 12, v2
    v_xor_b32 v9, v8, v1
    v_lshlrev_b32 v21, 10, v2
    v_lshl_add_u32 v21, v9, 4, v21
    s_lshl_b32 s63, s34, 8
    s_add_u32 s63, s63, 9216
    v_add_u32 v21, s63, v21
    s_lshl_b32 s78, s34, 12
    s_lshl_b32 s66, s3, 18
    s_sub_u32 s66, s66, 16384
    s_and_b32 s66, s66, 0x1fffff
    s_add_u32 m0, s62, 0
    s_nop 0
    buffer_load_dwordx4 v16, s[8:11], s70 offen offset:0 lds
    buffer_load_dwordx4 v16, s[8:11], s70 offen offset:1024 lds
    buffer_load_dwordx4 v16, s[8:11], s70 offen offset:2048 lds
    s_add_u32 s70, s70, 98304
    s_add_u32 m0, s62, 12288
    s_nop 0
    buffer_load_dwordx4 v16, s[8:11], s70 offen offset:0 lds
    buffer_load_dwordx4 v16, s[8:11], s70 offen offset:1024 lds
    buffer_load_dwordx4 v16, s[8:11], s70 offen offset:2048 lds
    s_add_u32 s70, s70, 98304
    s_add_u32 m0, s62, 24576
    s_nop 0
    buffer_load_dwordx4 v16, s[8:11], s70 offen offset:0 lds
    buffer_load_dwordx4 v16, s[8:11], s70 offen offset:1024 lds
    buffer_load_dwordx4 v16, s[8:11], s70 offen offset:2048 lds
    s_add_u32 s70, s70, 98304
    v_lshrrev_b32 v8, 2, v1
    v_mul_u32_u24 v17, 3072, v2
    v_lshl_add_u32 v17, v8, 7, v17
    v_lshrrev_b32 v8, 1, v8
    v_and_b32 v9, 1, v2
    v_lshl_add_u32 v8, v9, 1, v8
    v_xor_b32 v8, s34, v8
    v_lshl_add_u32 v17, v8, 5, v17
    v_and_b32 v8, 3, v0
    v_lshl_add_u32 v17, v8, 3, v17
    v_add_u32 v17, 40960, v17
    v_add_u32 v8, 0, v2
    v_xor_b32 v8, v8, v1
    v_lshlrev_b32 v22, 8, v1
    v_lshl_add_u32 v22, v8, 4, v22
    v_add_u32 v208, 102400, v22
    v_add_u32 v8, 4, v2
    v_xor_b32 v8, v8, v1
    v_lshlrev_b32 v23, 8, v1
    v_lshl_add_u32 v23, v8, 4, v23
    v_add_u32 v209, 102400, v23
    v_add_u32 v8, 8, v2
    v_xor_b32 v8, v8, v1
    v_lshlrev_b32 v24, 8, v1
    v_lshl_add_u32 v24, v8, 4, v24
    v_add_u32 v210, 102400, v24
    v_add_u32 v8, 12, v2
    v_xor_b32 v8, v8, v1
    v_lshlrev_b32 v25, 8, v1
    v_lshl_add_u32 v25, v8, 4, v25
    v_add_u32 v211, 102400, v25
    s_lshl_b32 s63, s34, 8
    v_lshl_add_u32 v26, v0, 2, s63
    s_add_u32 s68, s63, 16384
    v_lshlrev_b32 v27, 8, v2
    v_lshl_add_u32 v27, v1, 3, v27
    v_add_u32 v27, 16384, v27
    v_add_u32 v28, 17408, v27
    v_add_u32 v212, 102400, v27
    v_add_u32 v213, 102400, v28
    v_mov_b32 v214, 0x3b000000
    v_mov_b32 v240, 0
    v_mov_b32 v241, 0
    v_mov_b32 v244, 0
    v_mov_b32 v245, 0
    v_mov_b32 v229, 0
    v_mov_b32 v230, 0
    v_mov_b32 v231, 0
    v_mov_b32 v237, 0
    v_mov_b32 v238, 0
    v_mov_b32 v239, 0
    v_mov_b32 v37, 0
    v_mov_b32 v38, 0
    v_mov_b32 v39, 0
    v_mov_b32 v41, 0
    v_mov_b32 v42, 0
    v_mov_b32 v43, 0
    v_mov_b32 v45, 0
    v_mov_b32 v46, 0
    v_mov_b32 v47, 0
    v_cmp_eq_u32 s[28:29], 1, v2
    v_cmp_gt_u32 s[30:31], 2, v2
    s_lshl_b32 s57, s33, 2
    s_add_u32 s57, s57, s34
    s_lshl_b32 s63, s57, 9
    v_lshrrev_b32 v8, 1, v2
    v_lshlrev_b32 v30, 8, v8
    v_lshl_add_u32 v30, v1, 4, v30
    v_and_b32 v8, 1, v2
    v_lshl_add_u32 v30, v8, 3, v30
    v_add_u32 v29, s63, v30
    s_lshl_b32 s63, s34, 7
    s_add_u32 s63, s63, 36864
    v_lshl_add_u32 v31, v1, 2, s63
    v_lshl_add_u32 v32, v2, 4, s63
    v_and_b32 v8, 7, v0
    v_lshlrev_b32 v8, 2, v8
    v_add_u32 v8, 128, v8
    v_lshlrev_b32 v5, 2, v0
    v_add_u32 v199, 640, v5
    v_add_u32 v5, 512, v5
    v_mov_b32 v250, -3
    v_mov_b32 v251, 1
    v_cmp_gt_u32 vcc, 32, v0
    s_nop 1
    v_cndmask_b32 v5, v8, v5, vcc
    v_cndmask_b32 v199, v8, v199, vcc
    v_cndmask_b32 v250, v250, v7, vcc
    v_cndmask_b32 v251, v251, v7, vcc
    s_lshl_b32 s63, s57, 2
    v_mov_b32 v6, s63
    v_mov_b32 v9, 0x80000000
    v_cmp_eq_u32 vcc, 0, v0
    s_nop 1
    v_cndmask_b32 v6, v9, v6, vcc
    v_lshlrev_b32 v215, 10, v0
    v_add_u32 v215, s63, v215
    v_mov_b32 v9, 0x80000000
    v_cmp_gt_u32 vcc, 2, v0
    s_nop 1
    v_cndmask_b32 v215, v9, v215, vcc
    s_mul_i32 s60, s3, 0x80000
    s_add_u32 s60, s60, 0x100000
    s_mov_b32 s58, 3
    s_mul_i32 s63, s3, 0x20000
    s_add_u32 s63, s63, 0x2300000
    s_add_u32 s16, s54, s63
    s_addc_u32 s17, s55, 0
    s_mov_b32 s18, 0x20000
    s_mov_b32 s19, 0x20000
    s_lshl_b32 s59, s3, 18
    s_lshl_b32 s63, s33, 1
    v_add_u32 v8, s63, v2
    v_lshlrev_b32 v33, 10, v8
    v_lshl_add_u32 v33, v1, 4, v33
    s_lshl_b32 s63, s34, 8
    s_add_u32 s63, s63, s59
    s_add_u32 s63, s63, 0x2000000
    v_add_u32 v33, s63, v33
    v_xor_b32 v11, v8, v1
    v_lshlrev_b32 v34, 8, v8
    v_lshl_add_u32 v34, v11, 4, v34
    v_add_u32 v34, s78, v34
    s_lshl_b32 s75, s33, 7
    s_lshr_b32 s63, s59, 4
    s_add_u32 s63, s63, s75
    s_add_u32 s63, s63, 0x2240000
    v_lshl_add_u32 v8, v1, 4, s63
    s_add_u32 s75, s75, 16384
    v_lshl_add_u32 v11, v1, 4, s75
    v_cmp_gt_u32 vcc, 32, v0
    s_nop 1
    v_cndmask_b32 v33, v8, v33, vcc
    v_cndmask_b32 v34, v11, v34, vcc
    s_lshr_b32 s63, s33, 1
    s_cmp_eq_u32 s34, s63
    s_cselect_b32 s63, 40, 32
    v_mov_b32 v9, 0x80000000
    v_cmp_gt_u32 vcc, s63, v0
    s_nop 1
    v_cndmask_b32 v33, v9, v33, vcc
    s_add_u32 s63, s3, 7
    s_and_b32 s63, s63, 7
    s_lshl_b32 s75, s63, 2
    v_mov_b32 v35, s75
    s_lshl_b32 s63, s63, 11
    s_add_u32 s73, s63, 640
    s_add_u32 s26, s54, 35651584
    s_addc_u32 s27, s55, 0
    s_add_u32 s24, s54, 33554432
    s_addc_u32 s25, s55, 0
    s_add_u32 s86, s54, 35913728
    s_addc_u32 s87, s55, 0
    s_add_u32 s82, s3, 1
    s_and_b32 s82, s82, 7
    s_lshl_b32 s82, s82, 18
    s_mov_b32 s84, 21
    s_add_u32 s85, s59, 16384
    s_mul_i32 s63, s57, 6144
    s_add_u32 s63, s63, s59
    s_add_u32 s63, s63, 65536
    v_lshl_add_u32 v220, v0, 7, s63
    v_mov_b32 v9, 0x80000000
    v_cmp_gt_u32 vcc, 48, v0
    s_nop 1
    v_cndmask_b32 v220, v9, v220, vcc
    v_mov_b32 v11, 0xf149f2ca
    v_lshl_add_u32 v8, v2, 2, 0
    v_sub_u32 v9, v1, v8
    v_and_b32 v184, 0x80000001, v9
    v_cmp_eq_u32 vcc, 0, v184
    s_nop 1
    v_cndmask_b32 v52, v11, v7, vcc
    v_sub_u32 v9, v8, v1
    v_subrev_u32 v9, 2, v9
    v_and_b32 v184, 0x80000001, v9
    v_cmp_eq_u32 vcc, 0, v184
    s_nop 1
    v_cndmask_b32 v56, v11, v7, vcc
    v_lshl_add_u32 v8, v2, 2, 1
    v_sub_u32 v9, v1, v8
    v_and_b32 v184, 0x80000001, v9
    v_cmp_eq_u32 vcc, 0, v184
    s_nop 1
    v_cndmask_b32 v53, v11, v7, vcc
    v_sub_u32 v9, v8, v1
    v_subrev_u32 v9, 2, v9
    v_and_b32 v184, 0x80000001, v9
    v_cmp_eq_u32 vcc, 0, v184
    s_nop 1
    v_cndmask_b32 v57, v11, v7, vcc
    v_lshl_add_u32 v8, v2, 2, 2
    v_sub_u32 v9, v1, v8
    v_and_b32 v184, 0x80000001, v9
    v_cmp_eq_u32 vcc, 0, v184
    s_nop 1
    v_cndmask_b32 v54, v11, v7, vcc
    v_sub_u32 v9, v8, v1
    v_subrev_u32 v9, 2, v9
    v_and_b32 v184, 0x80000001, v9
    v_cmp_eq_u32 vcc, 0, v184
    s_nop 1
    v_cndmask_b32 v58, v11, v7, vcc
    v_lshl_add_u32 v8, v2, 2, 3
    v_sub_u32 v9, v1, v8
    v_and_b32 v184, 0x80000001, v9
    v_cmp_eq_u32 vcc, 0, v184
    s_nop 1
    v_cndmask_b32 v55, v11, v7, vcc
    v_sub_u32 v9, v8, v1
    v_subrev_u32 v9, 2, v9
    v_and_b32 v184, 0x80000001, v9
    v_cmp_eq_u32 vcc, 0, v184
    s_nop 1
    v_cndmask_b32 v59, v11, v7, vcc
    v_mov_b32 v8, 0xffff
    v_cmp_eq_u32 vcc, 0, v56
    s_nop 1
    v_cndmask_b32 v216, v7, v8, vcc
    v_mov_b32 v8, 0xffff0000
    v_cmp_eq_u32 vcc, 0, v57
    s_nop 1
    v_cndmask_b32 v216, v216, v8, vcc
    v_mov_b32 v8, 0xffff
    v_cmp_eq_u32 vcc, 0, v58
    s_nop 1
    v_cndmask_b32 v217, v7, v8, vcc
    v_mov_b32 v8, 0xffff0000
    v_cmp_eq_u32 vcc, 0, v59
    s_nop 1
    v_cndmask_b32 v217, v217, v8, vcc
    v_mov_b32 v8, 0xffff
    v_cmp_eq_u32 vcc, 0, v52
    s_nop 1
    v_cndmask_b32 v218, v7, v8, vcc
    v_mov_b32 v8, 0xffff0000
    v_cmp_eq_u32 vcc, 0, v53
    s_nop 1
    v_cndmask_b32 v218, v218, v8, vcc
    v_mov_b32 v8, 0xffff
    v_cmp_eq_u32 vcc, 0, v54
    s_nop 1
    v_cndmask_b32 v219, v7, v8, vcc
    v_mov_b32 v8, 0xffff0000
    v_cmp_eq_u32 vcc, 0, v55
    s_nop 1
    v_cndmask_b32 v219, v219, v8, vcc
    s_cmp_eq_u32 s3, 0
    s_cselect_b64 vcc, -1, 0
    v_mov_b32 v11, 0xf149f2ca
    s_nop 1
    v_cndmask_b32 v48, v56, v11, vcc
    v_cndmask_b32 v49, v57, v11, vcc
    v_cndmask_b32 v50, v58, v11, vcc
    v_cndmask_b32 v51, v59, v11, vcc
    s_add_u32 m0, s78, 102400
    s_lshr_b32 s67, s66, 4
    buffer_load_dwordx4 v18, s[12:15], s66 offen offset:0 sc1 lds
    buffer_load_dwordx4 v19, s[12:15], s66 offen offset:1024 sc1 lds
    buffer_load_dwordx4 v20, s[12:15], s66 offen offset:2048 sc1 lds
    buffer_load_dwordx4 v21, s[12:15], s66 offen offset:3072 sc1 lds
    s_mov_b32 s76, s67
    s_add_u32 s66, s66, 16384
    s_and_b32 s66, s66, 0x1fffff
    s_add_u32 m0, s78, 119808
    s_lshr_b32 s67, s66, 4
    buffer_load_dwordx4 v18, s[12:15], s66 offen offset:0 sc1 lds
    buffer_load_dwordx4 v19, s[12:15], s66 offen offset:1024 sc1 lds
    buffer_load_dwordx4 v20, s[12:15], s66 offen offset:2048 sc1 lds
    buffer_load_dwordx4 v21, s[12:15], s66 offen offset:3072 sc1 lds
    s_mov_b32 s77, s67
    s_add_u32 s66, s66, 16384
    s_and_b32 s66, s66, 0x1fffff
    s_waitcnt vmcnt(0)
    s_barrier
    s_add_u32 m0, s62, 36864
    s_nop 0
    buffer_load_dwordx4 v16, s[8:11], s70 offen offset:0 lds
    buffer_load_dwordx4 v16, s[8:11], s70 offen offset:1024 lds
    buffer_load_dwordx4 v16, s[8:11], s70 offen offset:2048 lds
    s_add_u32 s70, s70, 98304
    ds_read_b64_tr_b16 a[0:1], v17 offset:0
    ds_read_b64_tr_b16 a[2:3], v17 offset:512
    ds_read_b64_tr_b16 a[4:5], v17 offset:1024
    ds_read_b64_tr_b16 a[6:7], v17 offset:1536
    ds_read_b64_tr_b16 a[8:9], v17 offset:2048
    ds_read_b64_tr_b16 a[10:11], v17 offset:2560
    ds_read_b128 v[96:99], v208 offset:0
    ds_read_b128 v[100:103], v208 offset:17408
    s_barrier
    s_waitcnt lgkmcnt(0)
    v_mfma_f32_16x16x32_bf16 v[68:71], a[4:7], v[96:99], 0
    ds_read_b64_tr_b16 a[12:13], v17 offset:12288
    ds_read_b64_tr_b16 a[14:15], v17 offset:12800
    v_mfma_f32_16x16x32_bf16 v[72:75], v[96:99], a[8:11], 0
    ds_read_b64_tr_b16 a[16:17], v17 offset:13312
    ds_read_b64_tr_b16 a[18:19], v17 offset:13824
    v_mfma_f32_16x16x32_bf16 v[80:83], a[0:3], v[100:103], 0
    ds_read_b64_tr_b16 a[20:21], v17 offset:14336
    ds_read_b64_tr_b16 a[22:23], v17 offset:14848
    v_mfma_f32_16x16x32_bf16 v[84:87], a[4:7], v[100:103], 0
    s_add_u32 m0, s62, 49152
    ds_read_b128 v[104:107], v209 offset:0
    ds_read_b128 v[108:111], v209 offset:17408
    v_mfma_f32_16x16x32_bf16 v[88:91], v[100:103], a[8:11], 0
    buffer_load_dwordx4 v16, s[8:11], s70 offen offset:0 lds
    v_mfma_f32_16x16x32_bf16 v[168:171], v[12:15], a[0:3], 0
    buffer_load_dwordx4 v16, s[8:11], s70 offen offset:1024 lds
    v_mfma_f32_16x16x32_bf16 v[172:175], v[12:15], a[4:7], 0
    buffer_load_dwordx4 v16, s[8:11], s70 offen offset:2048 lds
    v_mfma_f32_16x16x32_bf16 v[176:179], v[12:15], a[8:11], 0
    s_add_u32 s70, s70, 98304
    s_barrier
    s_waitcnt lgkmcnt(0)
    v_mfma_f32_16x16x32_bf16 v[68:71], a[16:19], v[104:107], v[68:71]
    ds_read_b64_tr_b16 a[24:25], v17 offset:24576
    ds_read_b64_tr_b16 a[26:27], v17 offset:25088
    v_mfma_f32_16x16x32_bf16 v[72:75], v[104:107], a[20:23], v[72:75]
    ds_read_b64_tr_b16 a[28:29], v17 offset:25600
    ds_read_b64_tr_b16 a[30:31], v17 offset:26112
    v_mfma_f32_16x16x32_bf16 v[80:83], a[12:15], v[108:111], v[80:83]
    ds_read_b64_tr_b16 a[32:33], v17 offset:26624
    ds_read_b64_tr_b16 a[34:35], v17 offset:27136
    v_mfma_f32_16x16x32_bf16 v[84:87], a[16:19], v[108:111], v[84:87]
    s_add_u32 m0, s62, 0
    ds_read_b128 v[96:99], v210 offset:0
    ds_read_b128 v[100:103], v210 offset:17408
    v_mfma_f32_16x16x32_bf16 v[88:91], v[108:111], a[20:23], v[88:91]
    buffer_load_dwordx4 v16, s[8:11], s70 offen offset:0 lds
    v_mfma_f32_16x16x32_bf16 v[168:171], v[12:15], a[12:15], v[168:171]
    buffer_load_dwordx4 v16, s[8:11], s70 offen offset:1024 lds
    v_mfma_f32_16x16x32_bf16 v[172:175], v[12:15], a[16:19], v[172:175]
    buffer_load_dwordx4 v16, s[8:11], s70 offen offset:2048 lds
    v_mfma_f32_16x16x32_bf16 v[176:179], v[12:15], a[20:23], v[176:179]
    s_add_u32 s70, s70, 98304
    s_lshl_b32 s63, s3, 2
    v_mov_b32 v8, s63
    buffer_load_dword v4, v8, s[20:23], 0 offen sc1
    s_waitcnt vmcnt(7)
    s_barrier
    s_waitcnt lgkmcnt(0)
    v_mfma_f32_16x16x32_bf16 v[68:71], a[28:31], v[96:99], v[68:71]
    ds_read_b64_tr_b16 a[36:37], v17 offset:36864
    ds_read_b64_tr_b16 a[38:39], v17 offset:37376
    v_mfma_f32_16x16x32_bf16 v[72:75], v[96:99], a[32:35], v[72:75]
    ds_read_b64_tr_b16 a[40:41], v17 offset:37888
    ds_read_b64_tr_b16 a[42:43], v17 offset:38400
    v_mfma_f32_16x16x32_bf16 v[80:83], a[24:27], v[100:103], v[80:83]
    ds_read_b64_tr_b16 a[44:45], v17 offset:38912
    ds_read_b64_tr_b16 a[46:47], v17 offset:39424
    v_mfma_f32_16x16x32_bf16 v[84:87], a[28:31], v[100:103], v[84:87]
    s_add_u32 m0, s62, 12288
    ds_read_b128 v[104:107], v211 offset:0
    ds_read_b128 v[108:111], v211 offset:17408
    v_mfma_f32_16x16x32_bf16 v[88:91], v[100:103], a[32:35], v[88:91]
    buffer_load_dwordx4 v16, s[8:11], s70 offen offset:0 lds
    v_mfma_f32_16x16x32_bf16 v[168:171], v[12:15], a[24:27], v[168:171]
    buffer_load_dwordx4 v16, s[8:11], s70 offen offset:1024 lds
    v_mfma_f32_16x16x32_bf16 v[172:175], v[12:15], a[28:31], v[172:175]
    buffer_load_dwordx4 v16, s[8:11], s70 offen offset:2048 lds
    v_mfma_f32_16x16x32_bf16 v[176:179], v[12:15], a[32:35], v[176:179]
    s_add_u32 s70, s70, 98304
    s_waitcnt vmcnt(7)
    s_barrier
    s_waitcnt lgkmcnt(0)
    v_mfma_f32_16x16x32_bf16 v[68:71], a[40:43], v[104:107], v[68:71]
    ds_read_b64_tr_b16 a[48:49], v17 offset:49152
    ds_read_b64_tr_b16 a[50:51], v17 offset:49664
    v_mfma_f32_16x16x32_bf16 v[72:75], v[104:107], a[44:47], v[72:75]
    ds_read_b64_tr_b16 a[52:53], v17 offset:50176
    ds_read_b64_tr_b16 a[54:55], v17 offset:50688
    v_mfma_f32_16x16x32_bf16 v[80:83], a[36:39], v[108:111], v[80:83]
    ds_read_b64_tr_b16 a[56:57], v17 offset:51200
    ds_read_b64_tr_b16 a[58:59], v17 offset:51712
    v_mfma_f32_16x16x32_bf16 v[84:87], a[40:43], v[108:111], v[84:87]
    s_add_u32 m0, s62, 24576
    ds_read_b128 v[96:99], v208 offset:4096
    ds_read_b128 v[100:103], v208 offset:21504
    v_mfma_f32_16x16x32_bf16 v[88:91], v[108:111], a[44:47], v[88:91]
    buffer_load_dwordx4 v16, s[8:11], s70 offen offset:0 lds
    v_mfma_f32_16x16x32_bf16 v[168:171], v[12:15], a[36:39], v[168:171]
    buffer_load_dwordx4 v16, s[8:11], s70 offen offset:1024 lds
    v_mfma_f32_16x16x32_bf16 v[172:175], v[12:15], a[40:43], v[172:175]
    buffer_load_dwordx4 v16, s[8:11], s70 offen offset:2048 lds
    v_mfma_f32_16x16x32_bf16 v[176:179], v[12:15], a[44:47], v[176:179]
    s_add_u32 s70, s70, 98304
    s_waitcnt vmcnt(7)
    s_barrier
    s_waitcnt lgkmcnt(0)
    v_mfma_f32_16x16x32_bf16 v[68:71], a[52:55], v[96:99], v[68:71]
    ds_read_b64_tr_b16 a[60:61], v17 offset:0
    ds_read_b64_tr_b16 a[62:63], v17 offset:512
    v_mfma_f32_16x16x32_bf16 v[72:75], v[96:99], a[56:59], v[72:75]
    ds_read_b64_tr_b16 a[64:65], v17 offset:1024
    ds_read_b64_tr_b16 a[66:67], v17 offset:1536
    v_mfma_f32_16x16x32_bf16 v[80:83], a[48:51], v[100:103], v[80:83]
    ds_read_b64_tr_b16 a[68:69], v17 offset:2048
    ds_read_b64_tr_b16 a[70:71], v17 offset:2560
    v_mfma_f32_16x16x32_bf16 v[84:87], a[52:55], v[100:103], v[84:87]
    s_add_u32 m0, s62, 36864
    ds_read_b128 v[104:107], v209 offset:4096
    ds_read_b128 v[108:111], v209 offset:21504
    v_mfma_f32_16x16x32_bf16 v[88:91], v[100:103], a[56:59], v[88:91]
    buffer_load_dwordx4 v16, s[8:11], s70 offen offset:0 lds
    v_mfma_f32_16x16x32_bf16 v[168:171], v[12:15], a[48:51], v[168:171]
    buffer_load_dwordx4 v16, s[8:11], s70 offen offset:1024 lds
    v_mfma_f32_16x16x32_bf16 v[172:175], v[12:15], a[52:55], v[172:175]
    buffer_load_dwordx4 v16, s[8:11], s70 offen offset:2048 lds
    v_mfma_f32_16x16x32_bf16 v[176:179], v[12:15], a[56:59], v[176:179]
    s_add_u32 s70, s70, 98304
    s_waitcnt vmcnt(9)
    v_cmp_eq_u32 vcc, 0, v4
    s_cbranch_vccnz L_hs_2
L_hsret_3:
    v_cmp_ne_u32 vcc, s35, v4
    s_cbranch_vccnz L_hsmm_4
L_hsok_5:
    s_add_u32 m0, s78, 0
    s_lshr_b32 s67, s66, 4
    buffer_load_dwordx4 v18, s[12:15], s66 offen offset:0 sc1 lds
    buffer_load_dwordx4 v19, s[12:15], s66 offen offset:1024 sc1 lds
    buffer_load_dwordx4 v20, s[12:15], s66 offen offset:2048 sc1 lds
    buffer_load_dwordx4 v21, s[12:15], s66 offen offset:3072 sc1 lds
    buffer_load_dword v4, v5, s[4:7], s65 offen sc1
    s_waitcnt vmcnt(11)
    s_barrier
    s_waitcnt lgkmcnt(0)
    v_mfma_f32_16x16x32_bf16 v[68:71], a[64:67], v[104:107], v[68:71]
    ds_read_b64_tr_b16 a[72:73], v17 offset:12288
    ds_read_b64_tr_b16 a[74:75], v17 offset:12800
    v_mfma_f32_16x16x32_bf16 v[72:75], v[104:107], a[68:71], v[72:75]
    ds_read_b64_tr_b16 a[76:77], v17 offset:13312
    ds_read_b64_tr_b16 a[78:79], v17 offset:13824
    v_mfma_f32_16x16x32_bf16 v[80:83], a[60:63], v[108:111], v[80:83]
    ds_read_b64_tr_b16 a[80:81], v17 offset:14336
    ds_read_b64_tr_b16 a[82:83], v17 offset:14848
    v_mfma_f32_16x16x32_bf16 v[84:87], a[64:67], v[108:111], v[84:87]
    s_add_u32 m0, s62, 49152
    ds_read_b128 v[96:99], v210 offset:4096
    ds_read_b128 v[100:103], v210 offset:21504
    v_mfma_f32_16x16x32_bf16 v[88:91], v[108:111], a[68:71], v[88:91]
    buffer_load_dwordx4 v16, s[8:11], s70 offen offset:0 lds
    v_mfma_f32_16x16x32_bf16 v[168:171], v[12:15], a[60:63], v[168:171]
    buffer_load_dwordx4 v16, s[8:11], s70 offen offset:1024 lds
    v_mfma_f32_16x16x32_bf16 v[172:175], v[12:15], a[64:67], v[172:175]
    buffer_load_dwordx4 v16, s[8:11], s70 offen offset:2048 lds
    v_mfma_f32_16x16x32_bf16 v[176:179], v[12:15], a[68:71], v[176:179]
    s_add_u32 s70, s70, 98304
    s_waitcnt vmcnt(11)
    s_barrier
    s_waitcnt lgkmcnt(0)
    v_mfma_f32_16x16x32_bf16 v[68:71], a[76:79], v[96:99], v[68:71]
    ds_read_b64_tr_b16 a[84:85], v17 offset:24576
    ds_read_b64_tr_b16 a[86:87], v17 offset:25088
    v_mfma_f32_16x16x32_bf16 v[72:75], v[96:99], a[80:83], v[72:75]
    ds_read_b64_tr_b16 a[88:89], v17 offset:25600
    ds_read_b64_tr_b16 a[90:91], v17 offset:26112
    v_mfma_f32_16x16x32_bf16 v[80:83], a[72:75], v[100:103], v[80:83]
    ds_read_b64_tr_b16 a[92:93], v17 offset:26624
    ds_read_b64_tr_b16 a[94:95], v17 offset:27136
    v_mfma_f32_16x16x32_bf16 v[84:87], a[76:79], v[100:103], v[84:87]
    s_add_u32 m0, s62, 0
    ds_read_b128 v[104:107], v211 offset:4096
    ds_read_b128 v[108:111], v211 offset:21504
    v_mfma_f32_16x16x32_bf16 v[88:91], v[100:103], a[80:83], v[88:91]
    buffer_load_dwordx4 v16, s[8:11], s70 offen offset:0 lds
    v_mfma_f32_16x16x32_bf16 v[168:171], v[12:15], a[72:75], v[168:171]
    buffer_load_dwordx4 v16, s[8:11], s70 offen offset:1024 lds
    v_mfma_f32_16x16x32_bf16 v[172:175], v[12:15], a[76:79], v[172:175]
    buffer_load_dwordx4 v16, s[8:11], s70 offen offset:2048 lds
    v_mfma_f32_16x16x32_bf16 v[176:179], v[12:15], a[80:83], v[176:179]
    s_add_u32 s70, s70, 98304
    s_waitcnt vmcnt(11)
    s_barrier
    s_waitcnt lgkmcnt(0)
    v_mfma_f32_16x16x32_bf16 v[68:71], a[88:91], v[104:107], v[68:71]
    ds_read_b64_tr_b16 a[96:97], v17 offset:36864
    ds_read_b64_tr_b16 a[98:99], v17 offset:37376
    v_mfma_f32_16x16x32_bf16 v[72:75], v[104:107], a[92:95], v[72:75]
    ds_read_b64_tr_b16 a[100:101], v17 offset:37888
    ds_read_b64_tr_b16 a[102:103], v17 offset:38400
    v_mfma_f32_16x16x32_bf16 v[80:83], a[84:87], v[108:111], v[80:83]
    ds_read_b64_tr_b16 a[104:105], v17 offset:38912
    ds_read_b64_tr_b16 a[106:107], v17 offset:39424
    v_mfma_f32_16x16x32_bf16 v[84:87], a[88:91], v[108:111], v[84:87]
    s_add_u32 m0, s62, 12288
    ds_read_b128 v[96:99], v208 offset:8192
    ds_read_b128 v[100:103], v208 offset:25600
    v_mfma_f32_16x16x32_bf16 v[88:91], v[108:111], a[92:95], v[88:91]
    buffer_load_dwordx4 v16, s[8:11], s70 offen offset:0 lds
    v_mfma_f32_16x16x32_bf16 v[168:171], v[12:15], a[84:87], v[168:171]
    buffer_load_dwordx4 v16, s[8:11], s70 offen offset:1024 lds
    v_mfma_f32_16x16x32_bf16 v[172:175], v[12:15], a[88:91], v[172:175]
    buffer_load_dwordx4 v16, s[8:11], s70 offen offset:2048 lds
    v_mfma_f32_16x16x32_bf16 v[176:179], v[12:15], a[92:95], v[176:179]
    s_add_u32 s70, s70, 98304
    s_waitcnt vmcnt(9)
    v_add_u32 v4, v4, v250
    v_cmp_gt_i32 vcc, s58, v4
    s_cbranch_vccnz L_spin_qkv_pro
L_ret_qkv_pro:
    s_add_u32 m0, s68, 102400
    s_nop 0
    buffer_load_dword v26, s[16:19], s76 offen sc1 lds
    s_add_u32 m0, s68, 119808
    s_nop 0
    buffer_load_dword v26, s[16:19], s77 offen sc1 lds
    s_add_u32 m0, s68, 0
    s_add_u32 s66, s66, 16384
    buffer_load_dword v26, s[16:19], s67 offen sc1 lds
    s_and_b32 s66, s66, 0x1fffff
    s_add_u32 s58, s58, 1
    s_waitcnt vmcnt(9)
    s_barrier
    s_waitcnt lgkmcnt(0)
    v_mfma_f32_16x16x32_bf16 v[68:71], a[100:103], v[96:99], v[68:71]
    ds_read_b64_tr_b16 a[108:109], v17 offset:49152
    ds_read_b64_tr_b16 a[110:111], v17 offset:49664
    v_mfma_f32_16x16x32_bf16 v[72:75], v[96:99], a[104:107], v[72:75]
    ds_read_b64_tr_b16 a[112:113], v17 offset:50176
    ds_read_b64_tr_b16 a[114:115], v17 offset:50688
    v_mfma_f32_16x16x32_bf16 v[80:83], a[96:99], v[100:103], v[80:83]
    ds_read_b64_tr_b16 a[116:117], v17 offset:51200
    ds_read_b64_tr_b16 a[118:119], v17 offset:51712
    v_mfma_f32_16x16x32_bf16 v[84:87], a[100:103], v[100:103], v[84:87]
    s_add_u32 m0, s62, 24576
    ds_read_b128 v[104:107], v209 offset:8192
    ds_read_b128 v[108:111], v209 offset:25600
    v_mfma_f32_16x16x32_bf16 v[88:91], v[100:103], a[104:107], v[88:91]
    buffer_load_dwordx4 v16, s[8:11], s70 offen offset:0 lds
    v_mfma_f32_16x16x32_bf16 v[168:171], v[12:15], a[96:99], v[168:171]
    buffer_load_dwordx4 v16, s[8:11], s70 offen offset:1024 lds
    v_mfma_f32_16x16x32_bf16 v[172:175], v[12:15], a[100:103], v[172:175]
    buffer_load_dwordx4 v16, s[8:11], s70 offen offset:2048 lds
    v_mfma_f32_16x16x32_bf16 v[176:179], v[12:15], a[104:107], v[176:179]
    s_add_u32 s70, s70, 98304
    s_waitcnt vmcnt(9)
    s_barrier
    s_waitcnt lgkmcnt(0)
    v_mfma_f32_16x16x32_bf16 v[68:71], a[112:115], v[104:107], v[68:71]
    ds_read_b64_tr_b16 a[120:121], v17 offset:0
    ds_read_b64_tr_b16 a[122:123], v17 offset:512
    v_mfma_f32_16x16x32_bf16 v[72:75], v[104:107], a[116:119], v[72:75]
    ds_read_b64_tr_b16 a[124:125], v17 offset:1024
    ds_read_b64_tr_b16 a[126:127], v17 offset:1536
    v_mfma_f32_16x16x32_bf16 v[80:83], a[108:111], v[108:111], v[80:83]
    ds_read_b64_tr_b16 a[128:129], v17 offset:2048
    ds_read_b64_tr_b16 a[130:131], v17 offset:2560
    v_mfma_f32_16x16x32_bf16 v[84:87], a[112:115], v[108:111], v[84:87]
    s_add_u32 m0, s62, 36864
    ds_read_b128 v[96:99], v210 offset:8192
    ds_read_b128 v[100:103], v210 offset:25600
    v_mfma_f32_16x16x32_bf16 v[88:91], v[108:111], a[116:119], v[88:91]
    buffer_load_dwordx4 v16, s[8:11], s70 offen offset:0 lds
    v_mfma_f32_16x16x32_bf16 v[168:171], v[12:15], a[108:111], v[168:171]
    buffer_load_dwordx4 v16, s[8:11], s70 offen offset:1024 lds
    v_mfma_f32_16x16x32_bf16 v[172:175], v[12:15], a[112:115], v[172:175]
    buffer_load_dwordx4 v16, s[8:11], s70 offen offset:2048 lds
    v_mfma_f32_16x16x32_bf16 v[176:179], v[12:15], a[116:119], v[176:179]
    s_add_u32 s70, s70, 98304
    s_waitcnt vmcnt(6)
    s_barrier
    s_waitcnt lgkmcnt(0)
    v_mfma_f32_16x16x32_bf16 v[68:71], a[124:127], v[96:99], v[68:71]
    ds_read2_b64 v[224:227], v212 offset0:0 offset1:16
    ds_read2_b64 v[232:235], v213 offset0:0 offset1:16
    v_mfma_f32_16x16x32_bf16 v[72:75], v[96:99], a[128:131], v[72:75]
    ds_read_b64_tr_b16 a[132:133], v17 offset:12288
    ds_read_b64_tr_b16 a[134:135], v17 offset:12800
    v_mfma_f32_16x16x32_bf16 v[80:83], a[120:123], v[100:103], v[80:83]
    ds_read_b64_tr_b16 a[136:137], v17 offset:13312
    ds_read_b64_tr_b16 a[138:139], v17 offset:13824
    v_mfma_f32_16x16x32_bf16 v[84:87], a[124:127], v[100:103], v[84:87]
    s_add_u32 m0, s62, 49152
    ds_read_b64_tr_b16 a[140:141], v17 offset:14336
    ds_read_b64_tr_b16 a[142:143], v17 offset:14848
    v_mfma_f32_16x16x32_bf16 v[88:91], v[100:103], a[128:131], v[88:91]
    buffer_load_dwordx4 v16, s[8:11], s70 offen offset:0 lds
    v_mfma_f32_16x16x32_bf16 v[168:171], v[12:15], a[120:123], v[168:171]
    buffer_load_dwordx4 v16, s[8:11], s70 offen offset:1024 lds
    v_mfma_f32_16x16x32_bf16 v[172:175], v[12:15], a[124:127], v[172:175]
    buffer_load_dwordx4 v16, s[8:11], s70 offen offset:2048 lds
    v_mfma_f32_16x16x32_bf16 v[176:179], v[12:15], a[128:131], v[176:179]
    s_add_u32 s70, s70, 98304
    ds_read_b128 v[104:107], v211 offset:8192
    ds_read_b128 v[108:111], v211 offset:25600
    s_waitcnt vmcnt(6)
    s_barrier
    s_waitcnt lgkmcnt(0)
    v_mfma_f32_16x16x32_bf16 v[68:71], a[136:139], v[104:107], v[68:71]
    ds_read_b64_tr_b16 a[144:145], v17 offset:24576
    ds_read_b64_tr_b16 a[146:147], v17 offset:25088
    ds_read_b64_tr_b16 a[148:149], v17 offset:25600
    v_mfma_f32_16x16x32_bf16 v[72:75], v[104:107], a[140:143], v[72:75]
    ds_read_b64_tr_b16 a[150:151], v17 offset:26112
    ds_read_b64_tr_b16 a[152:153], v17 offset:26624
    ds_read_b64_tr_b16 a[154:155], v17 offset:27136
    v_mfma_f32_16x16x32_bf16 v[80:83], a[132:135], v[108:111], v[80:83]
    ds_read_b128 v[96:99], v208 offset:12288
    ds_read_b128 v[100:103], v208 offset:29696
    v_add_f32 v224, v224, v226
    v_mfma_f32_16x16x32_bf16 v[84:87], a[136:139], v[108:111], v[84:87]
    s_add_u32 m0, s62, 0
    v_add_f32 v232, v232, v234
    v_add_f32 v226, v225, v227
    v_add_f32 v234, v233, v235
    v_mfma_f32_16x16x32_bf16 v[88:91], v[108:111], a[140:143], v[88:91]
    buffer_load_dwordx4 v16, s[8:11], s70 offen offset:0 lds
    v_mfma_f32_16x16x32_bf16 v[168:171], v[12:15], a[132:135], v[168:171]
    buffer_load_dwordx4 v16, s[8:11], s70 offen offset:1024 lds
    v_mfma_f32_16x16x32_bf16 v[172:175], v[12:15], a[136:139], v[172:175]
    buffer_load_dwordx4 v16, s[8:11], s70 offen offset:2048 lds
    s_add_u32 s70, s70, 98304
    v_mfma_f32_16x16x32_bf16 v[176:179], v[12:15], a[140:143], v[176:179]
    v_permlane16_swap_b32 v224, v226
    v_permlane16_swap_b32 v232, v234
    v_add_f32 v225, v224, v226
    v_add_f32 v233, v232, v234
    v_add_f32 v224, v224, v226
    v_add_f32 v232, v232, v234
    s_nop 0
    v_permlane32_swap_b32 v224, v225
    s_waitcnt vmcnt(6)
    s_barrier
    s_waitcnt lgkmcnt(0)
    v_mfma_f32_16x16x32_bf16 v[68:71], a[148:151], v[96:99], v[68:71]
    ds_read_b64_tr_b16 a[156:157], v17 offset:36864
    ds_read_b64_tr_b16 a[158:159], v17 offset:37376
    ds_read_b64_tr_b16 a[160:161], v17 offset:37888
    v_mfma_f32_16x16x32_bf16 v[72:75], v[96:99], a[152:155], v[72:75]
    ds_read_b64_tr_b16 a[162:163], v17 offset:38400
    ds_read_b64_tr_b16 a[164:165], v17 offset:38912
    ds_read_b64_tr_b16 a[166:167], v17 offset:39424
    v_mfma_f32_16x16x32_bf16 v[80:83], a[144:147], v[100:103], v[80:83]
    ds_read_b128 v[104:107], v209 offset:12288
    ds_read_b128 v[108:111], v209 offset:29696
    v_mfma_f32_16x16x32_bf16 v[84:87], a[148:151], v[100:103], v[84:87]
    v_permlane32_swap_b32 v232, v233
    v_add_f32 v224, v224, v225
    v_mfma_f32_16x16x32_bf16 v[88:91], v[100:103], a[152:155], v[88:91]
    v_add_f32 v232, v232, v233
    v_mul_f32 v226, v214, v224
    v_mul_f32 v234, v214, v232
    v_mfma_f32_16x16x32_bf16 v[168:171], v[12:15], a[144:147], v[168:171]
    v_mul_f32 v224, v214, v224
    v_mul_f32 v232, v214, v232
    v_mfma_f32_16x16x32_bf16 v[172:175], v[12:15], a[148:151], v[172:175]
    v_permlane16_swap_b32 v224, v226
    v_mfma_f32_16x16x32_bf16 v[176:179], v[12:15], a[152:155], v[176:179]
    v_permlane16_swap_b32 v232, v234
    v_cvt_pk_bf16_f32 v225, v224, v224
    v_cvt_pk_bf16_f32 v233, v232, v232
    s_waitcnt vmcnt(3)
    s_barrier
    s_waitcnt lgkmcnt(0)
    v_mfma_f32_16x16x32_bf16 v[68:71], a[160:163], v[104:107], v[68:71]
    ds_read_b64_tr_b16 a[168:169], v17 offset:49152
    ds_read_b64_tr_b16 a[170:171], v17 offset:49664
    ds_read_b64_tr_b16 a[172:173], v17 offset:50176
    v_mfma_f32_16x16x32_bf16 v[72:75], v[104:107], a[164:167], v[72:75]
    ds_read_b64_tr_b16 a[174:175], v17 offset:50688
    ds_read_b64_tr_b16 a[176:177], v17 offset:51200
    ds_read_b64_tr_b16 a[178:179], v17 offset:51712
    v_mfma_f32_16x16x32_bf16 v[80:83], a[156:159], v[108:111], v[80:83]
    ds_read_b128 v[96:99], v210 offset:12288
    ds_read_b128 v[100:103], v210 offset:29696
    v_fma_f32 v226, -v224, v224, v226
    v_mfma_f32_16x16x32_bf16 v[84:87], a[160:163], v[108:111], v[84:87]
    v_fma_f32 v234, -v232, v232, v234
    v_lshlrev_b32 v227, 16, v225
    v_lshlrev_b32 v235, 16, v233
    v_mfma_f32_16x16x32_bf16 v[88:91], v[108:111], a[164:167], v[88:91]
    v_max_f32 v226, 0, v226
    v_max_f32 v234, 0, v234
    v_sub_f32 v227, v224, v227
    v_mfma_f32_16x16x32_bf16 v[168:171], v[12:15], a[156:159], v[168:171]
    v_sub_f32 v235, v232, v235
    v_add_f32 v226, 0x3727c5ac, v226
    v_add_f32 v234, 0x3727c5ac, v234
    v_mfma_f32_16x16x32_bf16 v[172:175], v[12:15], a[160:163], v[172:175]
    v_cvt_pk_bf16_f32 v228, v224, v227
    v_mfma_f32_16x16x32_bf16 v[176:179], v[12:15], a[164:167], v[176:179]
    s_waitcnt vmcnt(0)
    s_barrier
    s_waitcnt lgkmcnt(0)
    v_mfma_f32_16x16x32_bf16 v[68:71], a[172:175], v[96:99], v[68:71]
    ds_read_b64_tr_b16 a[180:181], v17 offset:0
    ds_read_b64_tr_b16 a[182:183], v17 offset:512
    ds_read_b64_tr_b16 a[184:185], v17 offset:1024
    v_mfma_f32_16x16x32_bf16 v[72:75], v[96:99], a[176:179], v[72:75]
    ds_read_b64_tr_b16 a[186:187], v17 offset:1536
    ds_read_b64_tr_b16 a[188:189], v17 offset:2048
    ds_read_b64_tr_b16 a[190:191], v17 offset:2560
    v_mfma_f32_16x16x32_bf16 v[80:83], a[168:171], v[100:103], v[80:83]
    ds_read_b128 v[104:107], v211 offset:12288
    ds_read_b128 v[108:111], v211 offset:29696
    v_cvt_pk_bf16_f32 v236, v232, v235
    v_mfma_f32_16x16x32_bf16 v[84:87], a[172:175], v[100:103], v[84:87]
    v_rsq_f32 v60, v226
    v_mfma_f32_16x16x32_bf16 v[88:91], v[100:103], a[176:179], v[88:91]
    v_rsq_f32 v62, v234
    v_mul_f32 v61, 0x3eb8aa3b, v60
    v_mfma_f32_16x16x32_bf16 v[168:171], v[12:15], a[168:171], v[168:171]
    v_mul_f32 v63, 0x3eb8aa3b, v62
    ds_write_b32 v31, v60 offset:0
    v_mfma_f32_16x16x32_bf16 v[172:175], v[12:15], a[172:175], v[172:175]
    ds_write_b32 v31, v62 offset:512
    ds_read_b128 v[200:203], v32 offset:0
    v_mfma_f32_16x16x32_bf16 v[176:179], v[12:15], a[176:179], v[176:179]
    ds_read_b128 v[204:207], v32 offset:512
    s_waitcnt lgkmcnt(4)
    v_mfma_f32_16x16x32_bf16 v[168:171], v[12:15], a[180:183], v[168:171]
    v_mfma_f32_16x16x32_bf16 v[172:175], v[12:15], a[184:187], v[172:175]
    v_mfma_f32_16x16x32_bf16 v[176:179], v[12:15], a[188:191], v[176:179]
    v_mfma_f32_16x16x32_bf16 v[68:71], a[184:187], v[104:107], v[68:71]
    v_mfma_f32_16x16x32_bf16 v[72:75], v[104:107], a[188:191], v[72:75]
    v_mfma_f32_16x16x32_bf16 v[80:83], a[180:183], v[108:111], v[80:83]
    v_mfma_f32_16x16x32_bf16 v[84:87], a[184:187], v[108:111], v[84:87]
    v_mfma_f32_16x16x32_bf16 v[88:91], v[108:111], a[188:191], v[88:91]
    ds_read_b128 v[96:99], v22 offset:0
    ds_read_b128 v[100:103], v23 offset:0
    ds_read_b128 v[104:107], v24 offset:0
    buffer_load_dword v4, v5, s[4:7], s65 offen sc1
    s_cmp_eq_u32 s3, 0
    s_cselect_b32 s61, 6, 18
    s_mov_b32 s8, s50
    s_mov_b32 s9, s51
    s_mov_b32 s10, 2097152
    s_mov_b32 s11, 0x20000
    v_cvt_pk_bf16_f32 v169, v168, v168
    v_cvt_pk_bf16_f32 v173, v172, v172
    v_cvt_pk_bf16_f32 v177, v176, v176
    v_lshlrev_b32 v169, 16, v169
    v_lshlrev_b32 v173, 16, v173
    v_lshlrev_b32 v177, 16, v177
    v_sub_f32 v169, v168, v169
    v_sub_f32 v173, v172, v173
    v_sub_f32 v177, v176, v177
    v_cndmask_b32 v168, v168, v169, s[28:29]
    v_cndmask_b32 v172, v172, v173, s[28:29]
    v_cndmask_b32 v176, v176, v177, s[28:29]
    v_cndmask_b32 v168, 0, v168, s[30:31]
    v_cndmask_b32 v172, 0, v172, s[30:31]
    v_cndmask_b32 v176, 0, v176, s[30:31]
    v_cvt_pk_bf16_f32 v36, -v168, -v168
    v_cvt_pk_bf16_f32 v40, -v172, -v172
    v_cvt_pk_bf16_f32 v44, -v176, -v176
    s_nop 0
    v_mfma_f32_16x16x32_bf16 v[68:71], v[40:43], v[228:231], v[68:71]
    v_mfma_f32_16x16x32_bf16 v[72:75], v[228:231], v[44:47], v[72:75]
    v_mfma_f32_16x16x32_bf16 v[80:83], v[36:39], v[236:239], v[80:83]
    v_mfma_f32_16x16x32_bf16 v[84:87], v[40:43], v[236:239], v[84:87]
    v_mfma_f32_16x16x32_bf16 v[88:91], v[236:239], v[44:47], v[88:91]
    s_waitcnt lgkmcnt(4)
    s_nop 2
    v_mul_f32 v188, v68, v60
    v_mul_f32 v189, v69, v60
    v_mul_f32 v190, v70, v60
    v_mul_f32 v191, v71, v60
    v_cvt_pk_bf16_f32 v76, v188, v189
    v_cvt_pk_bf16_f32 v77, v190, v191
    v_mul_f32 v192, v72, v200
    v_mul_f32 v193, v73, v201
    v_mul_f32 v194, v74, v202
    v_mul_f32 v195, v75, v203
    v_cvt_pk_bf16_f32 v160, v192, v193
    v_cvt_pk_bf16_f32 v161, v194, v195
    s_cmp_lg_u32 s74, 0
    s_cbranch_scc1 L_qkv_loop_slow
.p2align 4
L_qkv_loop_fast:
    s_waitcnt lgkmcnt(2)
    v_mfma_f32_16x16x32_bf16 v[64:67], a[0:3], v[96:99], 0
    ds_read2_b64 v[224:227], v27 offset0:0 offset1:16
    v_mfma_f32_16x16x32_bf16 v[68:71], a[4:7], v[96:99], 0
    v_cvt_pk_bf16_f32 v242, v80, v81
    v_cvt_pk_bf16_f32 v243, v82, v83
    v_mul_f32 v188, v84, v62
    v_mfma_f32_16x16x32_bf16 v[72:75], v[96:99], a[8:11], 0
    s_waitcnt lgkmcnt(2)
    v_mul_f32 v189, v85, v62
    v_mul_f32 v190, v86, v62
    v_mul_f32 v191, v87, v62
    v_mfma_f32_16x16x32_bf16 v[64:67], a[12:15], v[100:103], v[64:67]
    ds_read_b128 v[108:111], v25 offset:0
    v_cvt_pk_bf16_f32 v78, v188, v189
    v_cvt_pk_bf16_f32 v79, v190, v191
    v_mfma_f32_16x16x32_bf16 v[68:71], a[16:19], v[100:103], v[68:71]
    s_waitcnt vmcnt(0)
    v_add_u32 v4, v4, v250
    v_cmp_gt_i32 vcc, s58, v4
    v_mfma_f32_16x16x32_bf16 v[168:171], v[76:79], v[242:245], v[48:51]
    v_mfma_f32_16x16x32_bf16 v[172:175], v[76:79], v[240:243], v[52:55]
    s_cbranch_vccnz L_spin_qkv0_fast
L_ret_qkv0_fast:
    v_mul_f32 v192, v88, v204
    v_mul_f32 v193, v89, v205
    v_mfma_f32_16x16x32_bf16 v[72:75], v[100:103], a[20:23], v[72:75]
    s_waitcnt lgkmcnt(2)
    v_mul_f32 v194, v90, v206
    v_mul_f32 v195, v91, v207
    v_cvt_pk_bf16_f32 v162, v192, v193
    v_mfma_f32_16x16x32_bf16 v[64:67], a[24:27], v[104:107], v[64:67]
    s_add_u32 m0, s78, 17408
    ds_read_b128 v[112:115], v22 offset:4096
    v_cvt_pk_bf16_f32 v163, v194, v195
    v_max_f32 v184, v168, v169
    v_mfma_f32_16x16x32_bf16 v[68:71], a[28:31], v[104:107], v[68:71]
    s_lshr_b32 s67, s66, 4
    buffer_load_dwordx4 v18, s[12:15], s66 offen offset:0 sc1 lds
    v_max_f32 v185, v170, v171
    v_mfma_f32_16x16x32_bf16 v[72:75], v[104:107], a[32:35], v[72:75]
    s_waitcnt lgkmcnt(1)
    v_max3_f32 v184, v172, v173, v184
    v_max3_f32 v185, v174, v175, v185
    v_max_f32 v196, v184, v185
    v_mfma_f32_16x16x32_bf16 v[64:67], a[36:39], v[108:111], v[64:67]
    buffer_load_dwordx4 v19, s[12:15], s66 offen offset:1024 sc1 lds
    ds_read_b128 v[116:119], v23 offset:4096
    v_mfma_f32_16x16x32_bf16 v[68:71], a[40:43], v[108:111], v[68:71]
    v_max_f32 v197, v184, v185
    v_add_f32 v224, v224, v226
    v_add_f32 v226, v225, v227
    v_mfma_f32_16x16x32_bf16 v[72:75], v[108:111], a[44:47], v[72:75]
    s_waitcnt lgkmcnt(1)
    v_permlane16_swap_b32 v196, v197
    v_max_f32 v198, v196, v197
    v_mfma_f32_16x16x32_bf16 v[64:67], a[48:51], v[112:115], v[64:67]
    buffer_load_dwordx4 v20, s[12:15], s66 offen offset:2048 sc1 lds
    ds_read_b128 v[120:123], v24 offset:4096
    v_mfma_f32_16x16x32_bf16 v[68:71], a[52:55], v[112:115], v[68:71]
    v_max_f32 v196, v196, v197
    v_permlane16_swap_b32 v224, v226
    v_mfma_f32_16x16x32_bf16 v[72:75], v[112:115], a[56:59], v[72:75]
    s_waitcnt lgkmcnt(1)
    v_permlane32_swap_b32 v196, v198
    v_max_f32 v196, v196, v198
    v_mfma_f32_16x16x32_bf16 v[64:67], a[60:63], v[116:119], v[64:67]
    buffer_load_dwordx4 v21, s[12:15], s66 offen offset:3072 sc1 lds
    ds_read_b128 v[124:127], v25 offset:4096
    v_mfma_f32_16x16x32_bf16 v[68:71], a[64:67], v[116:119], v[68:71]
    s_add_u32 m0, s68, 17408
    v_mul_f32 v196, v196, v63
    v_fma_f32 v184, v184, v63, -v196
    v_fma_f32 v185, v185, v63, -v196
    v_mfma_f32_16x16x32_bf16 v[72:75], v[116:119], a[68:71], v[72:75]
    s_waitcnt lgkmcnt(1)
    v_exp_f32 v184, v184
    v_add_f32 v225, v224, v226
    v_mfma_f32_16x16x32_bf16 v[64:67], a[72:75], v[120:123], v[64:67]
    s_add_u32 s66, s66, 16384
    buffer_load_dword v26, s[16:19], s67 offen sc1 lds
    ds_read_b128 v[128:131], v22 offset:8192
    v_mfma_f32_16x16x32_bf16 v[68:71], a[76:79], v[120:123], v[68:71]
    s_and_b32 s66, s66, 0x1fffff
    v_exp_f32 v185, v185
    v_cvt_pk_bf16_f32 v184, v184, v184
    v_mfma_f32_16x16x32_bf16 v[72:75], v[120:123], a[80:83], v[72:75]
    s_waitcnt lgkmcnt(1)
    v_cvt_pk_bf16_f32 v185, v185, v185
    v_and_b32 v164, v216, v184
    v_and_b32 v165, v217, v185
    v_mfma_f32_16x16x32_bf16 v[64:67], a[84:87], v[124:127], v[64:67]
    s_add_u32 s58, s58, 1
    ds_read_b128 v[132:135], v23 offset:8192
    v_and_b32 v166, v218, v184
    v_and_b32 v167, v219, v185
    v_mfma_f32_16x16x32_bf16 v[68:71], a[88:91], v[124:127], v[68:71]
    s_cmp_eq_u32 s58, s84
    s_cselect_b32 s66, s85, s66
    v_add_f32 v224, v224, v226
    v_mfma_f32_16x16x32_bf16 v[180:183], v[12:15], v[164:167], 0
    s_nop 0
    v_permlane32_swap_b32 v224, v225
    v_add_f32 v224, v224, v225
    v_mfma_f32_16x16x32_bf16 v[176:179], v[160:163], v[164:167], 0
    v_mul_f32 v226, v214, v224
    v_mul_f32 v224, v214, v224
    v_mfma_f32_16x16x32_bf16 v[72:75], v[124:127], a[92:95], v[72:75]
    s_waitcnt lgkmcnt(1)
    v_permlane16_swap_b32 v224, v226
    v_cvt_pk_bf16_f32 v225, v224, v224
    v_mfma_f32_16x16x32_bf16 v[64:67], a[96:99], v[128:131], v[64:67]
    ds_read_b128 v[136:139], v24 offset:8192
    v_fma_f32 v226, -v224, v224, v226
    v_mfma_f32_16x16x32_bf16 v[68:71], a[100:103], v[128:131], v[68:71]
    v_rcp_f32 v180, v180
    v_mfma_f32_16x16x32_bf16 v[72:75], v[128:131], a[104:107], v[72:75]
    s_waitcnt lgkmcnt(1)
    v_mul_f32 v176, v176, v180
    v_mul_f32 v177, v177, v180
    v_mfma_f32_16x16x32_bf16 v[64:67], a[108:111], v[132:135], v[64:67]
    ds_read_b128 v[140:143], v25 offset:8192
    v_mul_f32 v178, v178, v180
    v_mfma_f32_16x16x32_bf16 v[68:71], a[112:115], v[132:135], v[68:71]
    v_mul_f32 v179, v179, v180
    v_cvt_pk_bf16_f32 v176, v176, v177
    v_mfma_f32_16x16x32_bf16 v[72:75], v[132:135], a[116:119], v[72:75]
    s_waitcnt lgkmcnt(1)
    v_cvt_pk_bf16_f32 v177, v178, v179
    v_lshlrev_b32 v227, 16, v225
    v_mfma_f32_16x16x32_bf16 v[64:67], a[120:123], v[136:139], v[64:67]
    buffer_store_dwordx2 v[176:177], v29, s[4:7], s60 offen
    v_mfma_f32_16x16x32_bf16 v[68:71], a[124:127], v[136:139], v[68:71]
    s_add_u32 s60, s60, 16384
    ds_read_b128 v[144:147], v22 offset:12288
    v_max_f32 v226, 0, v226
    v_mfma_f32_16x16x32_bf16 v[72:75], v[136:139], a[128:131], v[72:75]
    s_waitcnt lgkmcnt(1)
    v_sub_f32 v227, v224, v227
    v_add_f32 v226, 0x3727c5ac, v226
    v_mfma_f32_16x16x32_bf16 v[64:67], a[132:135], v[140:143], v[64:67]
    s_and_b32 s60, s60, 0x3ffeffff
    ds_read_b128 v[148:151], v23 offset:12288
    v_add_u32 v7, 1, v7
    v_mfma_f32_16x16x32_bf16 v[68:71], a[136:139], v[140:143], v[68:71]
    v_cvt_pk_bf16_f32 v228, v224, v227
    v_mfma_f32_16x16x32_bf16 v[72:75], v[140:143], a[140:143], v[72:75]
    s_waitcnt lgkmcnt(1)
    v_rsq_f32 v60, v226
    v_mfma_f32_16x16x32_bf16 v[64:67], v[36:39], v[228:231], v[64:67]
    v_mfma_f32_16x16x32_bf16 v[68:71], v[40:43], v[228:231], v[68:71]
    v_mfma_f32_16x16x32_bf16 v[72:75], v[228:231], v[44:47], v[72:75]
    v_mul_f32 v61, 0x3eb8aa3b, v60
    v_mfma_f32_16x16x32_bf16 v[64:67], a[144:147], v[144:147], v[64:67]
    ds_read_b128 v[152:155], v24 offset:12288
    v_mfma_f32_16x16x32_bf16 v[68:71], a[148:151], v[144:147], v[68:71]
    ds_read_b128 v[156:159], v25 offset:12288
    v_mfma_f32_16x16x32_bf16 v[72:75], v[144:147], a[152:155], v[72:75]
    s_waitcnt lgkmcnt(2)
    ds_write_b32 v31, v60 offset:0
    v_mfma_f32_16x16x32_bf16 v[64:67], a[156:159], v[148:151], v[64:67]
    ds_read_b128 v[200:203], v32 offset:0
    v_mfma_f32_16x16x32_bf16 v[68:71], a[160:163], v[148:151], v[68:71]
    buffer_load_dword v4, v5, s[4:7], s65 offen sc1
    v_mfma_f32_16x16x32_bf16 v[72:75], v[148:151], a[164:167], v[72:75]
    s_waitcnt lgkmcnt(3)
    v_mfma_f32_16x16x32_bf16 v[64:67], a[168:171], v[152:155], v[64:67]
    s_waitcnt vmcnt(2) lgkmcnt(2)
    s_barrier
    v_mfma_f32_16x16x32_bf16 v[68:71], a[172:175], v[152:155], v[68:71]
    s_waitcnt vmcnt(1)
    buffer_store_dword v7, v6, s[4:7], s65 offen
    v_mfma_f32_16x16x32_bf16 v[72:75], v[152:155], a[176:179], v[72:75]
    ds_read_b128 v[96:99], v22 offset:17408
    v_mfma_f32_16x16x32_bf16 v[64:67], a[180:183], v[156:159], v[64:67]
    ds_read_b128 v[100:103], v23 offset:17408
    v_mfma_f32_16x16x32_bf16 v[68:71], a[184:187], v[156:159], v[68:71]
    ds_read_b128 v[104:107], v24 offset:17408
    v_mfma_f32_16x16x32_bf16 v[72:75], v[156:159], a[188:191], v[72:75]
    s_waitcnt lgkmcnt(2)
    v_mfma_f32_16x16x32_bf16 v[80:83], a[0:3], v[96:99], 0
    ds_read2_b64 v[224:227], v28 offset0:0 offset1:16
    v_mfma_f32_16x16x32_bf16 v[84:87], a[4:7], v[96:99], 0
    v_cvt_pk_bf16_f32 v242, v64, v65
    v_cvt_pk_bf16_f32 v243, v66, v67
    v_mul_f32 v188, v68, v60
    v_mfma_f32_16x16x32_bf16 v[88:91], v[96:99], a[8:11], 0
    s_waitcnt lgkmcnt(2)
    v_mul_f32 v189, v69, v60
    v_mul_f32 v190, v70, v60
    v_mul_f32 v191, v71, v60
    v_mfma_f32_16x16x32_bf16 v[80:83], a[12:15], v[100:103], v[80:83]
    ds_read_b128 v[108:111], v25 offset:17408
    v_cvt_pk_bf16_f32 v76, v188, v189
    v_cvt_pk_bf16_f32 v77, v190, v191
    v_mfma_f32_16x16x32_bf16 v[84:87], a[16:19], v[100:103], v[84:87]
    s_waitcnt vmcnt(1)
    v_add_u32 v4, v4, v250
    v_cmp_gt_i32 vcc, s58, v4
    v_mfma_f32_16x16x32_bf16 v[168:171], v[76:79], v[240:243], v[56:59]
    v_mfma_f32_16x16x32_bf16 v[172:175], v[76:79], v[242:245], v[52:55]
    s_cbranch_vccnz L_spin_qkv1_fast
L_ret_qkv1_fast:
    v_mul_f32 v192, v72, v200
    v_mul_f32 v193, v73, v201
    v_mfma_f32_16x16x32_bf16 v[88:91], v[100:103], a[20:23], v[88:91]
    s_waitcnt lgkmcnt(2)
    v_mul_f32 v194, v74, v202
    v_mul_f32 v195, v75, v203
    v_cvt_pk_bf16_f32 v160, v192, v193
    v_mfma_f32_16x16x32_bf16 v[80:83], a[24:27], v[104:107], v[80:83]
    s_add_u32 m0, s78, 0
    ds_read_b128 v[112:115], v22 offset:21504
    v_cvt_pk_bf16_f32 v161, v194, v195
    v_max_f32 v184, v168, v169
    v_mfma_f32_16x16x32_bf16 v[84:87], a[28:31], v[104:107], v[84:87]
    s_lshr_b32 s67, s66, 4
    buffer_load_dwordx4 v18, s[12:15], s66 offen offset:0 sc1 lds
    v_max_f32 v185, v170, v171
    v_mfma_f32_16x16x32_bf16 v[88:91], v[104:107], a[32:35], v[88:91]
    s_waitcnt lgkmcnt(1)
    v_max3_f32 v184, v172, v173, v184
    v_max3_f32 v185, v174, v175, v185
    v_max_f32 v196, v184, v185
    v_mfma_f32_16x16x32_bf16 v[80:83], a[36:39], v[108:111], v[80:83]
    buffer_load_dwordx4 v19, s[12:15], s66 offen offset:1024 sc1 lds
    ds_read_b128 v[116:119], v23 offset:21504
    v_mfma_f32_16x16x32_bf16 v[84:87], a[40:43], v[108:111], v[84:87]
    v_max_f32 v197, v184, v185
    v_add_f32 v224, v224, v226
    v_add_f32 v226, v225, v227
    v_mfma_f32_16x16x32_bf16 v[88:91], v[108:111], a[44:47], v[88:91]
    s_waitcnt lgkmcnt(1)
    v_permlane16_swap_b32 v196, v197
    v_max_f32 v198, v196, v197
    v_mfma_f32_16x16x32_bf16 v[80:83], a[48:51], v[112:115], v[80:83]
    buffer_load_dwordx4 v20, s[12:15], s66 offen offset:2048 sc1 lds
    ds_read_b128 v[120:123], v24 offset:21504
    v_mfma_f32_16x16x32_bf16 v[84:87], a[52:55], v[112:115], v[84:87]
    v_max_f32 v196, v196, v197
    v_permlane16_swap_b32 v224, v226
    v_mfma_f32_16x16x32_bf16 v[88:91], v[112:115], a[56:59], v[88:91]
    s_waitcnt lgkmcnt(1)
    v_permlane32_swap_b32 v196, v198
    v_max_f32 v196, v196, v198
    v_mfma_f32_16x16x32_bf16 v[80:83], a[60:63], v[116:119], v[80:83]
    buffer_load_dwordx4 v21, s[12:15], s66 offen offset:3072 sc1 lds
    ds_read_b128 v[124:127], v25 offset:21504
    v_mfma_f32_16x16x32_bf16 v[84:87], a[64:67], v[116:119], v[84:87]
    s_add_u32 m0, s68, 0
    v_mul_f32 v196, v196, v61
    v_fma_f32 v184, v184, v61, -v196
    v_fma_f32 v185, v185, v61, -v196
    v_mfma_f32_16x16x32_bf16 v[88:91], v[116:119], a[68:71], v[88:91]
    s_waitcnt lgkmcnt(1)
    v_exp_f32 v184, v184
    v_add_f32 v225, v224, v226
    v_mfma_f32_16x16x32_bf16 v[80:83], a[72:75], v[120:123], v[80:83]
    s_add_u32 s66, s66, 16384
    buffer_load_dword v26, s[16:19], s67 offen sc1 lds
    ds_read_b128 v[128:131], v22 offset:25600
    v_mfma_f32_16x16x32_bf16 v[84:87], a[76:79], v[120:123], v[84:87]
    s_and_b32 s66, s66, 0x1fffff
    v_exp_f32 v185, v185
    v_cvt_pk_bf16_f32 v184, v184, v184
    v_mfma_f32_16x16x32_bf16 v[88:91], v[120:123], a[80:83], v[88:91]
    s_waitcnt lgkmcnt(1)
    v_cvt_pk_bf16_f32 v185, v185, v185
    v_and_b32 v166, v216, v184
    v_and_b32 v167, v217, v185
    v_mfma_f32_16x16x32_bf16 v[80:83], a[84:87], v[124:127], v[80:83]
    s_add_u32 s58, s58, 1
    ds_read_b128 v[132:135], v23 offset:25600
    v_and_b32 v164, v218, v184
    v_and_b32 v165, v219, v185
    v_mfma_f32_16x16x32_bf16 v[84:87], a[88:91], v[124:127], v[84:87]
    s_cmp_ge_u32 s58, 36
    s_cselect_b64 s[28:29], -1, 0
    s_cselect_b64 s[12:13], s[24:25], s[12:13]
    s_cselect_b64 s[16:17], s[86:87], s[16:17]
    v_cndmask_b32 v5, v5, v199, s[28:29]
    v_add_f32 v224, v224, v226
    v_mfma_f32_16x16x32_bf16 v[180:183], v[12:15], v[164:167], 0
    s_nop 0
    v_permlane32_swap_b32 v224, v225
    v_add_f32 v224, v224, v225
    v_mfma_f32_16x16x32_bf16 v[176:179], v[160:163], v[164:167], 0
    v_mul_f32 v226, v214, v224
    v_mul_f32 v224, v214, v224
    v_mfma_f32_16x16x32_bf16 v[88:91], v[124:127], a[92:95], v[88:91]
    s_waitcnt lgkmcnt(1)
    v_permlane16_swap_b32 v224, v226
    v_cvt_pk_bf16_f32 v225, v224, v224
    v_mfma_f32_16x16x32_bf16 v[80:83], a[96:99], v[128:131], v[80:83]
    ds_read_b128 v[136:139], v24 offset:25600
    v_fma_f32 v226, -v224, v224, v226
    v_mfma_f32_16x16x32_bf16 v[84:87], a[100:103], v[128:131], v[84:87]
    v_rcp_f32 v180, v180
    v_mfma_f32_16x16x32_bf16 v[88:91], v[128:131], a[104:107], v[88:91]
    s_waitcnt lgkmcnt(1)
    v_mul_f32 v176, v176, v180
    v_mul_f32 v177, v177, v180
    v_mfma_f32_16x16x32_bf16 v[80:83], a[108:111], v[132:135], v[80:83]
    ds_read_b128 v[140:143], v25 offset:25600
    v_mul_f32 v178, v178, v180
    v_mfma_f32_16x16x32_bf16 v[84:87], a[112:115], v[132:135], v[84:87]
    v_mul_f32 v179, v179, v180
    v_cvt_pk_bf16_f32 v176, v176, v177
    v_mfma_f32_16x16x32_bf16 v[88:91], v[132:135], a[116:119], v[88:91]
    s_waitcnt lgkmcnt(1)
    v_cvt_pk_bf16_f32 v177, v178, v179
    v_lshlrev_b32 v227, 16, v225
    v_mfma_f32_16x16x32_bf16 v[80:83], a[120:123], v[136:139], v[80:83]
    buffer_store_dwordx2 v[176:177], v29, s[4:7], s60 offen
    v_mfma_f32_16x16x32_bf16 v[84:87], a[124:127], v[136:139], v[84:87]
    s_add_u32 s60, s60, 16384
    ds_read_b128 v[144:147], v22 offset:29696
    v_max_f32 v226, 0, v226
    v_mfma_f32_16x16x32_bf16 v[88:91], v[136:139], a[128:131], v[88:91]
    s_waitcnt lgkmcnt(1)
    v_sub_f32 v227, v224, v227
    v_add_f32 v226, 0x3727c5ac, v226
    v_mfma_f32_16x16x32_bf16 v[80:83], a[132:135], v[140:143], v[80:83]
    s_and_b32 s60, s60, 0x3ffeffff
    ds_read_b128 v[148:151], v23 offset:29696
    v_add_u32 v7, 1, v7
    v_mfma_f32_16x16x32_bf16 v[84:87], a[136:139], v[140:143], v[84:87]
    v_cvt_pk_bf16_f32 v228, v224, v227
    v_mfma_f32_16x16x32_bf16 v[88:91], v[140:143], a[140:143], v[88:91]
    s_waitcnt lgkmcnt(1)
    v_rsq_f32 v62, v226
    v_mfma_f32_16x16x32_bf16 v[80:83], v[36:39], v[228:231], v[80:83]
    v_mfma_f32_16x16x32_bf16 v[84:87], v[40:43], v[228:231], v[84:87]
    v_mfma_f32_16x16x32_bf16 v[88:91], v[228:231], v[44:47], v[88:91]
    v_mul_f32 v63, 0x3eb8aa3b, v62
    v_mfma_f32_16x16x32_bf16 v[80:83], a[144:147], v[144:147], v[80:83]
    ds_read_b128 v[152:155], v24 offset:29696
    v_mfma_f32_16x16x32_bf16 v[84:87], a[148:151], v[144:147], v[84:87]
    ds_read_b128 v[156:159], v25 offset:29696
    v_mfma_f32_16x16x32_bf16 v[88:91], v[144:147], a[152:155], v[88:91]
    s_waitcnt lgkmcnt(2)
    ds_write_b32 v31, v62 offset:0
    v_mfma_f32_16x16x32_bf16 v[80:83], a[156:159], v[148:151], v[80:83]
    ds_read_b128 v[204:207], v32 offset:0
    v_mfma_f32_16x16x32_bf16 v[84:87], a[160:163], v[148:151], v[84:87]
    buffer_load_dword v4, v5, s[4:7], s65 offen sc1
    v_mfma_f32_16x16x32_bf16 v[88:91], v[148:151], a[164:167], v[88:91]
    s_waitcnt lgkmcnt(3)
    v_mfma_f32_16x16x32_bf16 v[80:83], a[168:171], v[152:155], v[80:83]
    s_waitcnt vmcnt(2) lgkmcnt(2)
    s_barrier
    v_mfma_f32_16x16x32_bf16 v[84:87], a[172:175], v[152:155], v[84:87]
    s_waitcnt vmcnt(1)
    buffer_store_dword v7, v6, s[4:7], s65 offen
    v_mfma_f32_16x16x32_bf16 v[88:91], v[152:155], a[176:179], v[88:91]
    ds_read_b128 v[96:99], v22 offset:0
    v_mfma_f32_16x16x32_bf16 v[80:83], a[180:183], v[156:159], v[80:83]
    ds_read_b128 v[100:103], v23 offset:0
    v_mfma_f32_16x16x32_bf16 v[84:87], a[184:187], v[156:159], v[84:87]
    s_cmp_lg_u32 s58, s61
    ds_read_b128 v[104:107], v24 offset:0
    v_mfma_f32_16x16x32_bf16 v[88:91], v[156:159], a[188:191], v[88:91]
    s_cbranch_scc1 L_qkv_loop_fast
    s_cmp_gt_u32 s58, 18
    s_cbranch_scc1 L_qkv_loop_fast_e18
    v_mov_b32 v48, v56
    v_mov_b32 v49, v57
    v_mov_b32 v50, v58
    v_mov_b32 v51, v59
    s_mov_b32 s61, 18
    s_cmp_lt_u32 s58, 18
    s_cbranch_scc1 L_qkv_loop_fast
    s_mov_b64 s[12:13], s[50:51]
    s_mov_b64 s[16:17], s[26:27]
    s_mov_b32 s66, s82
    buffer_load_dword v223, v35, s[20:23], 0 offen sc1
    v_lshl_add_u32 v250, v251, 1, v250
    s_mov_b32 s58, 20
    s_mov_b32 s61, 22
    s_branch L_qkv_loop_fast
L_qkv_loop_fast_e18:
    s_cmp_gt_u32 s58, 22
    s_cbranch_scc1 L_qkv_loop_fast_x2
    ds_read_b128 v[92:95], v34 offset:17408
    v_subrev_u32 v7, 1, v7
    v_add_u32 v250, v251, v250
    s_add_u32 s60, s60, 0x3fffc000
    s_mov_b32 s84, 37
    s_mov_b32 s85, 0x40000000
    s_mov_b32 s61, 24
    s_waitcnt lgkmcnt(0)
    buffer_store_dwordx4 v[92:95], v33, s[4:7], 0 offen sc1
    s_branch L_qkv_loop_fast
L_qkv_loop_fast_x2:
    s_cmp_eq_u32 s58, 38
    s_cbranch_scc1 L_qkv_loop_fast_end
L_qkv_loop_fast_x3:
    v_cmp_eq_u32 vcc, 0, v223
    v_mov_b32 v8, 64
    s_mov_b32 s61, 38
    s_cbranch_vccnz L_qkv_loop_fast_nb
    buffer_store_dword v8, v215, s[4:7], s73 offen sc1
    s_branch L_qkv_loop_fast
L_qkv_loop_fast_end:
    s_cmp_eq_u32 s3, 7
    s_cselect_b64 vcc, -1, 0
    v_mov_b32 v11, 0xf149f2ca
    s_nop 1
    v_cndmask_b32 v48, v56, v11, vcc
    v_cndmask_b32 v49, v57, v11, vcc
    v_cndmask_b32 v50, v58, v11, vcc
    v_cndmask_b32 v51, v59, v11, vcc
    v_cvt_pk_bf16_f32 v242, v80, v81
    v_cvt_pk_bf16_f32 v243, v82, v83
    v_mul_f32 v188, v84, v62
    v_mul_f32 v189, v85, v62
    v_mul_f32 v190, v86, v62
    v_mul_f32 v191, v87, v62
    v_cvt_pk_bf16_f32 v78, v188, v189
    v_cvt_pk_bf16_f32 v79, v190, v191
    s_nop 1
    v_mfma_f32_16x16x32_bf16 v[168:171], v[76:79], v[242:245], v[48:51]
    v_mfma_f32_16x16x32_bf16 v[172:175], v[76:79], v[240:243], v[52:55]
    s_waitcnt lgkmcnt(3)
    v_mul_f32 v192, v88, v204
    v_mul_f32 v193, v89, v205
    v_mul_f32 v194, v90, v206
    v_mul_f32 v195, v91, v207
    v_cvt_pk_bf16_f32 v162, v192, v193
    v_cvt_pk_bf16_f32 v163, v194, v195
    v_max_f32 v184, v168, v169
    v_max_f32 v185, v170, v171
    v_max3_f32 v184, v172, v173, v184
    v_max3_f32 v185, v174, v175, v185
    v_max_f32 v196, v184, v185
    v_max_f32 v197, v184, v185
    s_nop 1
    v_permlane16_swap_b32 v196, v197
    v_max_f32 v198, v196, v197
    v_max_f32 v196, v196, v197
    s_nop 1
    v_permlane32_swap_b32 v196, v198
    v_max_f32 v196, v196, v198
    v_mul_f32 v196, v196, v63
    v_fma_f32 v184, v184, v63, -v196
    v_fma_f32 v185, v185, v63, -v196
    v_exp_f32 v184, v184
    v_exp_f32 v185, v185
    v_cvt_pk_bf16_f32 v184, v184, v184
    v_cvt_pk_bf16_f32 v185, v185, v185
    v_and_b32 v164, v216, v184
    v_and_b32 v165, v217, v185
    v_and_b32 v166, v218, v184
    v_and_b32 v167, v219, v185
    s_nop 1
    v_mfma_f32_16x16x32_bf16 v[180:183], v[12:15], v[164:167], 0
    v_mfma_f32_16x16x32_bf16 v[176:179], v[160:163], v[164:167], 0
    s_nop 6
    v_rcp_f32 v180, v180
    s_nop 0
    v_mul_f32 v176, v176, v180
    v_mul_f32 v177, v177, v180
    v_mul_f32 v178, v178, v180
    v_mul_f32 v179, v179, v180
    v_cvt_pk_bf16_f32 v176, v176, v177
    v_cvt_pk_bf16_f32 v177, v178, v179
    s_waitcnt vmcnt(1)
    v_add_u32 v4, v4, v250
    v_cmp_gt_i32 vcc, s58, v4
    s_cbranch_vccnz L_spin_qkvdr_fast
L_ret_qkvdr_fast:
    buffer_store_dwordx2 v[176:177], v29, s[4:7], s60 offen
    v_mov_b32 v7, 64
    s_waitcnt vmcnt(0)
    buffer_store_dword v7, v6, s[4:7], s65 offen
    s_endpgm
L_wo:
    s_sub_u32 s57, s33, 8
    s_mov_b32 s8, s40
    s_mov_b32 s9, s41
    s_mov_b32 s10, 524288
    s_mov_b32 s11, 0x20000
    s_lshl_b32 s57, s57, 2
    s_add_u32 s57, s57, s34
    v_lshrrev_b32 v8, 3, v0
    v_lshlrev_b32 v16, 10, v8
    v_lshlrev_b32 v8, 1, v8
    v_and_b32 v8, 4, v8
    v_and_b32 v9, 7, v0
    v_xor_b32 v8, v8, v9
    v_lshl_add_u32 v16, v8, 4, v16
    s_lshl_b32 s64, s57, 7
    v_add_u32 v16, s64, v16
    v_add_u32 v17, 7168, v16
    v_add_u32 v18, 14336, v16
    v_add_u32 v19, 21504, v16
    s_lshl_b32 s62, s34, 14
    s_add_u32 s62, s62, 49152
    s_mov_b32 s70, 0
    s_add_u32 m0, s62, 0
    s_nop 0
    buffer_load_dwordx4 v16, s[8:11], s70 offen offset:0 lds
    buffer_load_dwordx4 v17, s[8:11], s70 offen offset:1024 lds
    buffer_load_dwordx4 v18, s[8:11], s70 offen offset:2048 lds
    buffer_load_dwordx4 v19, s[8:11], s70 offen offset:3072 lds
    s_add_u32 s70, s70, 32768
    s_add_u32 m0, s62, 4096
    s_nop 0
    buffer_load_dwordx4 v16, s[8:11], s70 offen offset:0 lds
    buffer_load_dwordx4 v17, s[8:11], s70 offen offset:1024 lds
    buffer_load_dwordx4 v18, s[8:11], s70 offen offset:2048 lds
    buffer_load_dwordx4 v19, s[8:11], s70 offen offset:3072 lds
    s_add_u32 s70, s70, 32768
    s_add_u32 m0, s62, 8192
    s_nop 0
    buffer_load_dwordx4 v16, s[8:11], s70 offen offset:0 lds
    buffer_load_dwordx4 v17, s[8:11], s70 offen offset:1024 lds
    buffer_load_dwordx4 v18, s[8:11], s70 offen offset:2048 lds
    buffer_load_dwordx4 v19, s[8:11], s70 offen offset:3072 lds
    s_add_u32 s70, s70, 32768
    v_lshrrev_b32 v8, 2, v1
    v_lshl_add_u32 v20, v2, 3, v8
    v_lshlrev_b32 v20, 7, v20
    v_lshrrev_b32 v8, 1, v8
    v_lshl_add_u32 v20, v8, 6, v20
    v_and_b32 v8, 3, v0
    v_lshl_add_u32 v20, v8, 4, v20
    v_add_u32 v20, s62, v20
    v_xor_b32 v21, 64, v20
    s_lshl_b32 s78, s34, 12
    v_add_u32 v22, s78, v3
    v_lshrrev_b32 v8, 3, v0
    v_and_b32 v9, 7, v0
    v_xor_b32 v9, v9, v8
    v_lshlrev_b32 v26, 10, v8
    v_lshl_add_u32 v26, v9, 4, v26
    v_add_u32 v26, s64, v26
    v_add_u32 v27, 7168, v26
    s_lshl_b32 s68, s34, 11
    s_add_u32 s68, s68, 36864
    v_and_b32 v8, 7, v1
    v_xor_b32 v8, v8, v2
    v_lshlrev_b32 v28, 7, v1
    v_lshl_add_u32 v28, v8, 4, v28
    v_add_u32 v28, s68, v28
    v_xor_b32 v29, 64, v28
    v_lshlrev_b32 v32, 10, v2
    v_lshl_add_u32 v32, v1, 3, v32
    v_add_u32 v32, s64, v32
    v_add_u32 v33, 4096, v32
    v_add_u32 v34, 8192, v32
    v_add_u32 v35, 12288, v32
    v_lshl_add_u32 v25, v0, 2, s64
    v_mov_b32 v9, 0x80000000
    v_cmp_gt_u32 vcc, 32, v0
    s_nop 1
    v_cndmask_b32 v25, v9, v25, vcc
    v_and_b32 v5, 31, v0
    v_lshlrev_b32 v5, 2, v5
    s_lshl_b32 s63, s57, 2
    s_add_u32 s63, s63, 128
    v_mov_b32 v6, s63
    v_mov_b32 v9, 0x80000000
    v_cmp_eq_u32 vcc, 0, v0
    s_nop 1
    v_cndmask_b32 v6, v9, v6, vcc
    s_mov_b32 s12, s36
    s_mov_b32 s13, s37
    s_mov_b32 s14, 2097152
    s_mov_b32 s15, 0x20000
    s_mov_b32 s24, s50
    s_mov_b32 s25, s51
    s_mov_b32 s26, 2097152
    s_mov_b32 s27, 0x20000
    s_add_u32 s16, s54, 35651584
    s_addc_u32 s17, s55, 0
    s_mov_b32 s18, 131072
    s_mov_b32 s19, 0x20000
    s_mul_i32 s59, s3, 0x80000
    s_add_u32 s59, s59, 0x100000
    s_mov_b32 s58, 1
    v_mov_b32 v7, 10
    s_lshl_b32 s66, s3, 18
    s_add_u32 s77, s66, 16384
    s_mov_b32 s83, 0x40000000
    s_mov_b32 s67, 0x40000000
    s_add_u32 s86, s54, 33554432
    s_addc_u32 s87, s55, 0
    s_waitcnt vmcnt(8)
    s_add_u32 m0, s62, 12288
    s_nop 0
    buffer_load_dwordx4 v16, s[8:11], s70 offen offset:0 lds
    buffer_load_dwordx4 v17, s[8:11], s70 offen offset:1024 lds
    buffer_load_dwordx4 v18, s[8:11], s70 offen offset:2048 lds
    buffer_load_dwordx4 v19, s[8:11], s70 offen offset:3072 lds
    s_add_u32 s70, s70, 32768
    ds_read_b64_tr_b16 a[0:1], v20 offset:0
    ds_read_b64_tr_b16 a[2:3], v20 offset:512
    ds_read_b64_tr_b16 a[4:5], v20 offset:8
    ds_read_b64_tr_b16 a[6:7], v20 offset:520
    ds_read_b64_tr_b16 a[8:9], v21 offset:0
    ds_read_b64_tr_b16 a[10:11], v21 offset:512
    ds_read_b64_tr_b16 a[12:13], v21 offset:8
    ds_read_b64_tr_b16 a[14:15], v21 offset:520
    s_waitcnt lgkmcnt(0)
    s_waitcnt vmcnt(8)
    s_add_u32 m0, s62, 0
    s_nop 0
    buffer_load_dwordx4 v16, s[8:11], s70 offen offset:0 lds
    buffer_load_dwordx4 v17, s[8:11], s70 offen offset:1024 lds
    buffer_load_dwordx4 v18, s[8:11], s70 offen offset:2048 lds
    buffer_load_dwordx4 v19, s[8:11], s70 offen offset:3072 lds
    s_add_u32 s70, s70, 32768
    ds_read_b64_tr_b16 a[16:17], v20 offset:4096
    ds_read_b64_tr_b16 a[18:19], v20 offset:4608
    ds_read_b64_tr_b16 a[20:21], v20 offset:4104
    ds_read_b64_tr_b16 a[22:23], v20 offset:4616
    ds_read_b64_tr_b16 a[24:25], v21 offset:4096
    ds_read_b64_tr_b16 a[26:27], v21 offset:4608
    ds_read_b64_tr_b16 a[28:29], v21 offset:4104
    ds_read_b64_tr_b16 a[30:31], v21 offset:4616
    s_waitcnt lgkmcnt(0)
    s_waitcnt vmcnt(8)
    s_add_u32 m0, s62, 4096
    s_nop 0
    buffer_load_dwordx4 v16, s[8:11], s70 offen offset:0 lds
    buffer_load_dwordx4 v17, s[8:11], s70 offen offset:1024 lds
    buffer_load_dwordx4 v18, s[8:11], s70 offen offset:2048 lds
    buffer_load_dwordx4 v19, s[8:11], s70 offen offset:3072 lds
    s_add_u32 s70, s70, 32768
    ds_read_b64_tr_b16 a[32:33], v20 offset:8192
    ds_read_b64_tr_b16 a[34:35], v20 offset:8704
    ds_read_b64_tr_b16 a[36:37], v20 offset:8200
    ds_read_b64_tr_b16 a[38:39], v20 offset:8712
    ds_read_b64_tr_b16 a[40:41], v21 offset:8192
    ds_read_b64_tr_b16 a[42:43], v21 offset:8704
    ds_read_b64_tr_b16 a[44:45], v21 offset:8200
    ds_read_b64_tr_b16 a[46:47], v21 offset:8712
    s_waitcnt lgkmcnt(0)
    s_waitcnt vmcnt(8)
    s_add_u32 m0, s62, 8192
    s_nop 0
    buffer_load_dwordx4 v16, s[8:11], s70 offen offset:0 lds
    buffer_load_dwordx4 v17, s[8:11], s70 offen offset:1024 lds
    buffer_load_dwordx4 v18, s[8:11], s70 offen offset:2048 lds
    buffer_load_dwordx4 v19, s[8:11], s70 offen offset:3072 lds
    s_add_u32 s70, s70, 32768
    ds_read_b64_tr_b16 a[48:49], v20 offset:12288
    ds_read_b64_tr_b16 a[50:51], v20 offset:12800
    ds_read_b64_tr_b16 a[52:53], v20 offset:12296
    ds_read_b64_tr_b16 a[54:55], v20 offset:12808
    ds_read_b64_tr_b16 a[56:57], v21 offset:12288
    ds_read_b64_tr_b16 a[58:59], v21 offset:12800
    ds_read_b64_tr_b16 a[60:61], v21 offset:12296
    ds_read_b64_tr_b16 a[62:63], v21 offset:12808
    s_waitcnt lgkmcnt(0)
    s_waitcnt vmcnt(8)
    s_add_u32 m0, s62, 12288
    s_nop 0
    buffer_load_dwordx4 v16, s[8:11], s70 offen offset:0 lds
    buffer_load_dwordx4 v17, s[8:11], s70 offen offset:1024 lds
    buffer_load_dwordx4 v18, s[8:11], s70 offen offset:2048 lds
    buffer_load_dwordx4 v19, s[8:11], s70 offen offset:3072 lds
    s_add_u32 s70, s70, 32768
    ds_read_b64_tr_b16 a[64:65], v20 offset:0
    ds_read_b64_tr_b16 a[66:67], v20 offset:512
    ds_read_b64_tr_b16 a[68:69], v20 offset:8
    ds_read_b64_tr_b16 a[70:71], v20 offset:520
    ds_read_b64_tr_b16 a[72:73], v21 offset:0
    ds_read_b64_tr_b16 a[74:75], v21 offset:512
    ds_read_b64_tr_b16 a[76:77], v21 offset:8
    ds_read_b64_tr_b16 a[78:79], v21 offset:520
    s_waitcnt lgkmcnt(0)
    s_waitcnt vmcnt(8)
    s_add_u32 m0, s62, 0
    s_nop 0
    buffer_load_dwordx4 v16, s[8:11], s70 offen offset:0 lds
    buffer_load_dwordx4 v17, s[8:11], s70 offen offset:1024 lds
    buffer_load_dwordx4 v18, s[8:11], s70 offen offset:2048 lds
    buffer_load_dwordx4 v19, s[8:11], s70 offen offset:3072 lds
    s_add_u32 s70, s70, 32768
    ds_read_b64_tr_b16 a[80:81], v20 offset:4096
    ds_read_b64_tr_b16 a[82:83], v20 offset:4608
    ds_read_b64_tr_b16 a[84:85], v20 offset:4104
    ds_read_b64_tr_b16 a[86:87], v20 offset:4616
    ds_read_b64_tr_b16 a[88:89], v21 offset:4096
    ds_read_b64_tr_b16 a[90:91], v21 offset:4608
    ds_read_b64_tr_b16 a[92:93], v21 offset:4104
    ds_read_b64_tr_b16 a[94:95], v21 offset:4616
    s_waitcnt lgkmcnt(0)
    s_waitcnt vmcnt(8)
    s_add_u32 m0, s62, 4096
    s_nop 0
    buffer_load_dwordx4 v16, s[8:11], s70 offen offset:0 lds
    buffer_load_dwordx4 v17, s[8:11], s70 offen offset:1024 lds
    buffer_load_dwordx4 v18, s[8:11], s70 offen offset:2048 lds
    buffer_load_dwordx4 v19, s[8:11], s70 offen offset:3072 lds
    s_add_u32 s70, s70, 32768
    ds_read_b64_tr_b16 a[96:97], v20 offset:8192
    ds_read_b64_tr_b16 a[98:99], v20 offset:8704
    ds_read_b64_tr_b16 a[100:101], v20 offset:8200
    ds_read_b64_tr_b16 a[102:103], v20 offset:8712
    ds_read_b64_tr_b16 a[104:105], v21 offset:8192
    ds_read_b64_tr_b16 a[106:107], v21 offset:8704
    ds_read_b64_tr_b16 a[108:109], v21 offset:8200
    ds_read_b64_tr_b16 a[110:111], v21 offset:8712
    s_waitcnt lgkmcnt(0)
    s_waitcnt vmcnt(8)
    s_add_u32 m0, s62, 8192
    s_nop 0
    buffer_load_dwordx4 v16, s[8:11], s70 offen offset:0 lds
    buffer_load_dwordx4 v17, s[8:11], s70 offen offset:1024 lds
    buffer_load_dwordx4 v18, s[8:11], s70 offen offset:2048 lds
    buffer_load_dwordx4 v19, s[8:11], s70 offen offset:3072 lds
    s_add_u32 s70, s70, 32768
    ds_read_b64_tr_b16 a[112:113], v20 offset:12288
    ds_read_b64_tr_b16 a[114:115], v20 offset:12800
    ds_read_b64_tr_b16 a[116:117], v20 offset:12296
    ds_read_b64_tr_b16 a[118:119], v20 offset:12808
    ds_read_b64_tr_b16 a[120:121], v21 offset:12288
    ds_read_b64_tr_b16 a[122:123], v21 offset:12800
    ds_read_b64_tr_b16 a[124:125], v21 offset:12296
    ds_read_b64_tr_b16 a[126:127], v21 offset:12808
    s_waitcnt lgkmcnt(0)
    s_waitcnt vmcnt(8)
    s_add_u32 m0, s62, 12288
    s_nop 0
    buffer_load_dwordx4 v16, s[8:11], s70 offen offset:0 lds
    buffer_load_dwordx4 v17, s[8:11], s70 offen offset:1024 lds
    buffer_load_dwordx4 v18, s[8:11], s70 offen offset:2048 lds
    buffer_load_dwordx4 v19, s[8:11], s70 offen offset:3072 lds
    s_add_u32 s70, s70, 32768
    ds_read_b64_tr_b16 a[128:129], v20 offset:0
    ds_read_b64_tr_b16 a[130:131], v20 offset:512
    ds_read_b64_tr_b16 a[132:133], v20 offset:8
    ds_read_b64_tr_b16 a[134:135], v20 offset:520
    ds_read_b64_tr_b16 a[136:137], v21 offset:0
    ds_read_b64_tr_b16 a[138:139], v21 offset:512
    ds_read_b64_tr_b16 a[140:141], v21 offset:8
    ds_read_b64_tr_b16 a[142:143], v21 offset:520
    s_waitcnt lgkmcnt(0)
    s_waitcnt vmcnt(8)
    s_add_u32 m0, s62, 0
    s_nop 0
    buffer_load_dwordx4 v16, s[8:11], s70 offen offset:0 lds
    buffer_load_dwordx4 v17, s[8:11], s70 offen offset:1024 lds
    buffer_load_dwordx4 v18, s[8:11], s70 offen offset:2048 lds
    buffer_load_dwordx4 v19, s[8:11], s70 offen offset:3072 lds
    s_add_u32 s70, s70, 32768
    s_lshl_b32 s63, s3, 2
    v_mov_b32 v8, s63
    buffer_load_dword v4, v8, s[20:23], 0 offen sc1
    ds_read_b64_tr_b16 a[144:145], v20 offset:4096
    ds_read_b64_tr_b16 a[146:147], v20 offset:4608
    ds_read_b64_tr_b16 a[148:149], v20 offset:4104
    ds_read_b64_tr_b16 a[150:151], v20 offset:4616
    ds_read_b64_tr_b16 a[152:153], v21 offset:4096
    ds_read_b64_tr_b16 a[154:155], v21 offset:4608
    ds_read_b64_tr_b16 a[156:157], v21 offset:4104
    ds_read_b64_tr_b16 a[158:159], v21 offset:4616
    s_waitcnt lgkmcnt(0)
    s_waitcnt vmcnt(9)
    s_add_u32 m0, s62, 4096
    s_nop 0
    buffer_load_dwordx4 v16, s[8:11], s70 offen offset:0 lds
    buffer_load_dwordx4 v17, s[8:11], s70 offen offset:1024 lds
    buffer_load_dwordx4 v18, s[8:11], s70 offen offset:2048 lds
    buffer_load_dwordx4 v19, s[8:11], s70 offen offset:3072 lds
    s_add_u32 s70, s70, 32768
    ds_read_b64_tr_b16 a[160:161], v20 offset:8192
    ds_read_b64_tr_b16 a[162:163], v20 offset:8704
    ds_read_b64_tr_b16 a[164:165], v20 offset:8200
    ds_read_b64_tr_b16 a[166:167], v20 offset:8712
    ds_read_b64_tr_b16 a[168:169], v21 offset:8192
    ds_read_b64_tr_b16 a[170:171], v21 offset:8704
    ds_read_b64_tr_b16 a[172:173], v21 offset:8200
    ds_read_b64_tr_b16 a[174:175], v21 offset:8712
    s_waitcnt lgkmcnt(0)
    s_waitcnt vmcnt(9)
    s_add_u32 m0, s62, 8192
    s_nop 0
    buffer_load_dwordx4 v16, s[8:11], s70 offen offset:0 lds
    buffer_load_dwordx4 v17, s[8:11], s70 offen offset:1024 lds
    buffer_load_dwordx4 v18, s[8:11], s70 offen offset:2048 lds
    buffer_load_dwordx4 v19, s[8:11], s70 offen offset:3072 lds
    s_add_u32 s70, s70, 32768
    ds_read_b64_tr_b16 a[176:177], v20 offset:12288
    ds_read_b64_tr_b16 a[178:179], v20 offset:12800
    ds_read_b64_tr_b16 a[180:181], v20 offset:12296
    ds_read_b64_tr_b16 a[182:183], v20 offset:12808
    ds_read_b64_tr_b16 a[184:185], v21 offset:12288
    ds_read_b64_tr_b16 a[186:187], v21 offset:12800
    ds_read_b64_tr_b16 a[188:189], v21 offset:12296
    ds_read_b64_tr_b16 a[190:191], v21 offset:12808
    s_waitcnt lgkmcnt(0)
    s_waitcnt vmcnt(9)
    s_add_u32 m0, s62, 12288
    s_nop 0
    buffer_load_dwordx4 v16, s[8:11], s70 offen offset:0 lds
    buffer_load_dwordx4 v17, s[8:11], s70 offen offset:1024 lds
    buffer_load_dwordx4 v18, s[8:11], s70 offen offset:2048 lds
    buffer_load_dwordx4 v19, s[8:11], s70 offen offset:3072 lds
    s_add_u32 s70, s70, 32768
    ds_read_b64_tr_b16 a[192:193], v20 offset:0
    ds_read_b64_tr_b16 a[194:195], v20 offset:512
    ds_read_b64_tr_b16 a[196:197], v20 offset:8
    ds_read_b64_tr_b16 a[198:199], v20 offset:520
    ds_read_b64_tr_b16 a[200:201], v21 offset:0
    ds_read_b64_tr_b16 a[202:203], v21 offset:512
    ds_read_b64_tr_b16 a[204:205], v21 offset:8
    ds_read_b64_tr_b16 a[206:207], v21 offset:520
    s_waitcnt lgkmcnt(0)
    s_waitcnt vmcnt(8)
    ds_read_b64_tr_b16 a[208:209], v20 offset:4096
    ds_read_b64_tr_b16 a[210:211], v20 offset:4608
    ds_read_b64_tr_b16 a[212:213], v20 offset:4104
    ds_read_b64_tr_b16 a[214:215], v20 offset:4616
    ds_read_b64_tr_b16 a[216:217], v21 offset:4096
    ds_read_b64_tr_b16 a[218:219], v21 offset:4608
    ds_read_b64_tr_b16 a[220:221], v21 offset:4104
    ds_read_b64_tr_b16 a[222:223], v21 offset:4616
    s_waitcnt lgkmcnt(0)
    s_waitcnt vmcnt(4)
    ds_read_b64_tr_b16 a[224:225], v20 offset:8192
    ds_read_b64_tr_b16 a[226:227], v20 offset:8704
    ds_read_b64_tr_b16 a[228:229], v20 offset:8200
    ds_read_b64_tr_b16 a[230:231], v20 offset:8712
    ds_read_b64_tr_b16 a[232:233], v21 offset:8192
    ds_read_b64_tr_b16 a[234:235], v21 offset:8704
    ds_read_b64_tr_b16 a[236:237], v21 offset:8200
    ds_read_b64_tr_b16 a[238:239], v21 offset:8712
    s_waitcnt lgkmcnt(0)
    s_waitcnt vmcnt(0)
    ds_read_b64_tr_b16 a[240:241], v20 offset:12288
    ds_read_b64_tr_b16 a[242:243], v20 offset:12800
    ds_read_b64_tr_b16 a[244:245], v20 offset:12296
    ds_read_b64_tr_b16 a[246:247], v20 offset:12808
    ds_read_b64_tr_b16 a[248:249], v21 offset:12288
    ds_read_b64_tr_b16 a[250:251], v21 offset:12800
    ds_read_b64_tr_b16 a[252:253], v21 offset:12296
    ds_read_b64_tr_b16 a[254:255], v21 offset:12808
    s_waitcnt lgkmcnt(0)
    v_cmp_eq_u32 vcc, 0, v4
    s_cbranch_vccnz L_hs_6
L_hsret_7:
    v_cmp_ne_u32 vcc, s35, v4
    s_cbranch_vccnz L_hsmm_8
L_hsok_9:
    buffer_load_dword v4, v5, s[4:7], s65 offen sc1
    s_waitcnt vmcnt(0)
    v_cmp_gt_i32 vcc, s58, v4
    s_cbranch_vccnz L_spin_wo_pro
L_ret_wo_pro:
    s_mov_b32 m0, s68
    s_add_u32 s58, s58, 1
    buffer_load_dwordx4 v26, s[12:15], s66 offen offset:0 sc1 lds
    buffer_load_dwordx4 v27, s[12:15], s66 offen offset:1024 sc1 lds
    s_add_u32 m0, s78, 0
    s_mov_b32 s82, s66
    buffer_load_dwordx4 v22, s[4:7], s59 offen offset:0 sc1 lds
    buffer_load_dwordx4 v22, s[4:7], s59 offen offset:1024 sc1 lds
    buffer_load_dwordx4 v22, s[4:7], s59 offen offset:2048 sc1 lds
    buffer_load_dwordx4 v22, s[4:7], s59 offen offset:3072 sc1 lds
    s_add_u32 s59, s59, 16384
    s_and_b32 s59, s59, 0x3ffeffff
    s_add_u32 s66, s66, 16384
    s_and_b32 s66, s66, 0x1fffff
    s_cmp_eq_u32 s58, 32
    s_cselect_b64 s[12:13], s[86:87], s[12:13]
    s_add_u32 s82, s3, 1
    s_and_b32 s82, s82, 7
    s_lshl_b32 s82, s82, 18
    s_waitcnt vmcnt(4)
    ds_read_b128 v[112:115], v28
    ds_read_b128 v[116:119], v29
    s_waitcnt lgkmcnt(0)
    v_lshlrev_b32 v48, 16, v112
    v_and_b32 v49, 0xffff0000, v112
    v_lshlrev_b32 v50, 16, v113
    v_and_b32 v51, 0xffff0000, v113
    v_lshlrev_b32 v52, 16, v114
    v_and_b32 v53, 0xffff0000, v114
    v_lshlrev_b32 v54, 16, v115
    v_and_b32 v55, 0xffff0000, v115
    v_lshlrev_b32 v56, 16, v116
    v_and_b32 v57, 0xffff0000, v116
    v_lshlrev_b32 v58, 16, v117
    v_and_b32 v59, 0xffff0000, v117
    v_lshlrev_b32 v60, 16, v118
    v_and_b32 v61, 0xffff0000, v118
    v_lshlrev_b32 v62, 16, v119
    v_and_b32 v63, 0xffff0000, v119
    s_waitcnt vmcnt(0)
    s_barrier
    ds_read_b128 v[144:147], v3 offset:0
    ds_read_b128 v[148:151], v3 offset:1024
    ds_read_b128 v[152:155], v3 offset:2048
    ds_read_b128 v[156:159], v3 offset:3072
    ds_read_b128 v[160:163], v3 offset:4096
    buffer_load_dword v4, v5, s[4:7], s65 offen sc1
    v_mov_b32 v7, 11
    s_mov_b32 s61, 16
    s_cmp_lg_u32 s74, 0
    s_cbranch_scc1 L_wo_loop_slow
.p2align 4
L_wo_loop_fast:
    s_waitcnt lgkmcnt(4)
    v_mfma_f32_16x16x32_bf16 v[48:51], a[0:3], v[144:147], v[48:51]
    v_mfma_f32_16x16x32_bf16 v[52:55], a[4:7], v[144:147], v[52:55]
    s_waitcnt vmcnt(1)
    buffer_store_dword v7, v6, s[4:7], s65 offen
    v_mfma_f32_16x16x32_bf16 v[56:59], a[8:11], v[144:147], v[56:59]
    v_cvt_pk_bf16_f32 v120, v64, v65
    v_cvt_pk_bf16_f32 v121, v66, v67
    v_mfma_f32_16x16x32_bf16 v[60:63], a[12:15], v[144:147], v[60:63]
    s_waitcnt lgkmcnt(3)
    v_cvt_pk_bf16_f32 v122, v68, v69
    v_cvt_pk_bf16_f32 v123, v70, v71
    v_mfma_f32_16x16x32_bf16 v[48:51], a[16:19], v[148:151], v[48:51]
    v_cvt_pk_bf16_f32 v124, v72, v73
    v_cvt_pk_bf16_f32 v125, v74, v75
    v_mfma_f32_16x16x32_bf16 v[52:55], a[20:23], v[148:151], v[52:55]
    v_cvt_pk_bf16_f32 v126, v76, v77
    v_cvt_pk_bf16_f32 v127, v78, v79
    v_mfma_f32_16x16x32_bf16 v[56:59], a[24:27], v[148:151], v[56:59]
    s_waitcnt vmcnt(1)
    v_cmp_gt_i32 vcc, s58, v4
    v_add_f32 v128, v64, v65
    v_mfma_f32_16x16x32_bf16 v[60:63], a[28:31], v[148:151], v[60:63]
    s_waitcnt lgkmcnt(2)
    v_mul_f32 v129, v64, v64
    v_fmac_f32 v129, v65, v65
    v_mfma_f32_16x16x32_bf16 v[48:51], a[32:35], v[152:155], v[48:51]
    s_cbranch_vccnz L_spin_woeven_fast
L_ret_woeven_fast:
    v_add_f32 v128, v128, v66
    v_fmac_f32 v129, v66, v66
    v_mfma_f32_16x16x32_bf16 v[52:55], a[36:39], v[152:155], v[52:55]
    s_mov_b32 m0, s68
    v_add_f32 v128, v128, v67
    v_fmac_f32 v129, v67, v67
    v_mfma_f32_16x16x32_bf16 v[56:59], a[40:43], v[152:155], v[56:59]
    s_add_u32 s58, s58, 1
    buffer_load_dwordx4 v26, s[12:15], s66 offen offset:0 sc1 lds
    v_mfma_f32_16x16x32_bf16 v[60:63], a[44:47], v[152:155], v[60:63]
    s_waitcnt lgkmcnt(1)
    buffer_load_dwordx4 v27, s[12:15], s66 offen offset:1024 sc1 lds
    v_mfma_f32_16x16x32_bf16 v[48:51], a[48:51], v[156:159], v[48:51]
    s_add_u32 m0, s78, 17408
    ds_read_b128 v[164:167], v3 offset:5120
    v_add_f32 v128, v128, v68
    v_mfma_f32_16x16x32_bf16 v[52:55], a[52:55], v[156:159], v[52:55]
    s_mov_b32 s60, s66
    v_fmac_f32 v129, v68, v68
    v_add_f32 v128, v128, v69
    v_mfma_f32_16x16x32_bf16 v[56:59], a[56:59], v[156:159], v[56:59]
    buffer_load_dwordx4 v22, s[4:7], s59 offen offset:0 sc1 lds
    v_mfma_f32_16x16x32_bf16 v[60:63], a[60:63], v[156:159], v[60:63]
    s_waitcnt lgkmcnt(1)
    v_fmac_f32 v129, v69, v69
    v_add_f32 v128, v128, v70
    v_mfma_f32_16x16x32_bf16 v[48:51], a[64:67], v[160:163], v[48:51]
    ds_read_b128 v[168:171], v3 offset:6144
    v_fmac_f32 v129, v70, v70
    v_mfma_f32_16x16x32_bf16 v[52:55], a[68:71], v[160:163], v[52:55]
    buffer_load_dwordx4 v22, s[4:7], s59 offen offset:1024 sc1 lds
    v_mfma_f32_16x16x32_bf16 v[56:59], a[72:75], v[160:163], v[56:59]
    v_add_f32 v128, v128, v71
    v_fmac_f32 v129, v71, v71
    v_mfma_f32_16x16x32_bf16 v[60:63], a[76:79], v[160:163], v[60:63]
    s_waitcnt lgkmcnt(1)
    v_add_f32 v128, v128, v72
    v_fmac_f32 v129, v72, v72
    v_mfma_f32_16x16x32_bf16 v[48:51], a[80:83], v[164:167], v[48:51]
    buffer_load_dwordx4 v22, s[4:7], s59 offen offset:2048 sc1 lds
    v_mfma_f32_16x16x32_bf16 v[52:55], a[84:87], v[164:167], v[52:55]
    ds_read_b128 v[172:175], v3 offset:7168
    v_add_f32 v128, v128, v73
    v_mfma_f32_16x16x32_bf16 v[56:59], a[88:91], v[164:167], v[56:59]
    v_fmac_f32 v129, v73, v73
    v_add_f32 v128, v128, v74
    v_mfma_f32_16x16x32_bf16 v[60:63], a[92:95], v[164:167], v[60:63]
    s_waitcnt lgkmcnt(1)
    buffer_load_dwordx4 v22, s[4:7], s59 offen offset:3072 sc1 lds
    v_mfma_f32_16x16x32_bf16 v[48:51], a[96:99], v[168:171], v[48:51]
    s_add_u32 s59, s59, 16384
    ds_read_b128 v[176:179], v3 offset:8192
    v_fmac_f32 v129, v74, v74
    v_mfma_f32_16x16x32_bf16 v[52:55], a[100:103], v[168:171], v[52:55]
    s_and_b32 s59, s59, 0x3ffeffff
    v_add_f32 v128, v128, v75
    v_fmac_f32 v129, v75, v75
    v_mfma_f32_16x16x32_bf16 v[56:59], a[104:107], v[168:171], v[56:59]
    s_add_u32 s66, s66, 16384
    buffer_store_dwordx2 v[120:121], v32, s[24:27], s83 offen
    v_mfma_f32_16x16x32_bf16 v[60:63], a[108:111], v[168:171], v[60:63]
    s_waitcnt lgkmcnt(1)
    v_add_f32 v128, v128, v76
    v_fmac_f32 v129, v76, v76
    v_mfma_f32_16x16x32_bf16 v[48:51], a[112:115], v[172:175], v[48:51]
    s_and_b32 s66, s66, 0x1fffff
    ds_read_b128 v[180:183], v3 offset:9216
    v_add_f32 v128, v128, v77
    v_mfma_f32_16x16x32_bf16 v[52:55], a[116:119], v[172:175], v[52:55]
    s_cmp_eq_u32 s58, 17
    s_cselect_b32 s66, s77, s66
    s_cselect_b64 s[12:13], s[24:25], s[12:13]
    v_fmac_f32 v129, v77, v77
    v_add_f32 v128, v128, v78
    v_mfma_f32_16x16x32_bf16 v[56:59], a[120:123], v[172:175], v[56:59]
    s_cmp_eq_u32 s58, 33
    s_cselect_b32 s66, 0x40000000, s66
    v_fmac_f32 v129, v78, v78
    v_add_f32 v128, v128, v79
    v_mfma_f32_16x16x32_bf16 v[60:63], a[124:127], v[172:175], v[60:63]
    s_waitcnt lgkmcnt(1)
    v_fmac_f32 v129, v79, v79
    v_mfma_f32_16x16x32_bf16 v[48:51], a[128:131], v[176:179], v[48:51]
    buffer_store_dwordx2 v[122:123], v33, s[24:27], s83 offen
    v_mfma_f32_16x16x32_bf16 v[52:55], a[132:135], v[176:179], v[52:55]
    ds_read_b128 v[184:187], v3 offset:10240
    v_mfma_f32_16x16x32_bf16 v[56:59], a[136:139], v[176:179], v[56:59]
    v_permlane16_swap_b32 v128, v129
    v_mfma_f32_16x16x32_bf16 v[60:63], a[140:143], v[176:179], v[60:63]
    s_waitcnt lgkmcnt(1)
    v_add_f32 v130, v128, v129
    v_add_f32 v128, v128, v129
    v_mfma_f32_16x16x32_bf16 v[48:51], a[144:147], v[180:183], v[48:51]
    s_waitcnt vmcnt(6)
    ds_read_b128 v[188:191], v3 offset:11264
    ds_read_b128 v[112:115], v28
    v_mfma_f32_16x16x32_bf16 v[52:55], a[148:151], v[180:183], v[52:55]
    ds_read_b128 v[116:119], v29
    v_mfma_f32_16x16x32_bf16 v[56:59], a[152:155], v[180:183], v[56:59]
    buffer_store_dwordx2 v[124:125], v34, s[24:27], s83 offen
    v_mfma_f32_16x16x32_bf16 v[60:63], a[156:159], v[180:183], v[60:63]
    s_waitcnt lgkmcnt(3)
    v_permlane32_swap_b32 v128, v130
    v_mfma_f32_16x16x32_bf16 v[48:51], a[160:163], v[184:187], v[48:51]
    ds_read_b128 v[192:195], v3 offset:12288
    v_add_f32 v128, v128, v130
    v_mfma_f32_16x16x32_bf16 v[52:55], a[164:167], v[184:187], v[52:55]
    buffer_store_dword v128, v25, s[16:19], s67 offen
    v_mfma_f32_16x16x32_bf16 v[56:59], a[168:171], v[184:187], v[56:59]
    s_waitcnt lgkmcnt(1)
    v_lshlrev_b32 v64, 16, v112
    v_and_b32 v65, 0xffff0000, v112
    v_mfma_f32_16x16x32_bf16 v[60:63], a[172:175], v[184:187], v[60:63]
    v_lshlrev_b32 v66, 16, v113
    v_and_b32 v67, 0xffff0000, v113
    v_mfma_f32_16x16x32_bf16 v[48:51], a[176:179], v[188:191], v[48:51]
    buffer_store_dwordx2 v[126:127], v35, s[24:27], s83 offen
    v_mfma_f32_16x16x32_bf16 v[52:55], a[180:183], v[188:191], v[52:55]
    s_mov_b32 s83, s82
    ds_read_b128 v[196:199], v3 offset:13312
    v_lshlrev_b32 v68, 16, v114
    v_mfma_f32_16x16x32_bf16 v[56:59], a[184:187], v[188:191], v[56:59]
    s_lshr_b32 s67, s82, 4
    v_add_u32 v7, 1, v7
    v_and_b32 v69, 0xffff0000, v114
    v_mfma_f32_16x16x32_bf16 v[60:63], a[188:191], v[188:191], v[60:63]
    s_waitcnt lgkmcnt(1)
    v_lshlrev_b32 v70, 16, v115
    v_and_b32 v71, 0xffff0000, v115
    v_mfma_f32_16x16x32_bf16 v[48:51], a[192:195], v[192:195], v[48:51]
    ds_read_b128 v[200:203], v3 offset:14336
    v_lshlrev_b32 v72, 16, v116
    v_mfma_f32_16x16x32_bf16 v[52:55], a[196:199], v[192:195], v[52:55]
    v_and_b32 v73, 0xffff0000, v116
    v_lshlrev_b32 v74, 16, v117
    v_mfma_f32_16x16x32_bf16 v[56:59], a[200:203], v[192:195], v[56:59]
    v_and_b32 v75, 0xffff0000, v117
    v_lshlrev_b32 v76, 16, v118
    v_mfma_f32_16x16x32_bf16 v[60:63], a[204:207], v[192:195], v[60:63]
    s_waitcnt lgkmcnt(1)
    v_and_b32 v77, 0xffff0000, v118
    v_lshlrev_b32 v78, 16, v119
    v_mfma_f32_16x16x32_bf16 v[48:51], a[208:211], v[196:199], v[48:51]
    buffer_load_dword v4, v5, s[4:7], s65 offen sc1
    v_mfma_f32_16x16x32_bf16 v[52:55], a[212:215], v[196:199], v[52:55]
    ds_read_b128 v[204:207], v3 offset:15360
    v_and_b32 v79, 0xffff0000, v119
    v_mfma_f32_16x16x32_bf16 v[56:59], a[216:219], v[196:199], v[56:59]
    v_mfma_f32_16x16x32_bf16 v[60:63], a[220:223], v[196:199], v[60:63]
    s_waitcnt lgkmcnt(1)
    v_mfma_f32_16x16x32_bf16 v[48:51], a[224:227], v[200:203], v[48:51]
    v_mfma_f32_16x16x32_bf16 v[52:55], a[228:231], v[200:203], v[52:55]
    s_waitcnt vmcnt(6) lgkmcnt(0)
    s_barrier
    v_mfma_f32_16x16x32_bf16 v[56:59], a[232:235], v[200:203], v[56:59]
    ds_read_b128 v[144:147], v3 offset:17408
    v_mfma_f32_16x16x32_bf16 v[60:63], a[236:239], v[200:203], v[60:63]
    ds_read_b128 v[148:151], v3 offset:18432
    v_mfma_f32_16x16x32_bf16 v[48:51], a[240:243], v[204:207], v[48:51]
    ds_read_b128 v[152:155], v3 offset:19456
    v_mfma_f32_16x16x32_bf16 v[52:55], a[244:247], v[204:207], v[52:55]
    ds_read_b128 v[156:159], v3 offset:20480
    v_mfma_f32_16x16x32_bf16 v[56:59], a[248:251], v[204:207], v[56:59]
    ds_read_b128 v[160:163], v3 offset:21504
    v_mfma_f32_16x16x32_bf16 v[60:63], a[252:255], v[204:207], v[60:63]
    s_waitcnt lgkmcnt(4)
    v_mfma_f32_16x16x32_bf16 v[64:67], a[0:3], v[144:147], v[64:67]
    v_mfma_f32_16x16x32_bf16 v[68:71], a[4:7], v[144:147], v[68:71]
    s_waitcnt vmcnt(1)
    buffer_store_dword v7, v6, s[4:7], s65 offen
    v_mfma_f32_16x16x32_bf16 v[72:75], a[8:11], v[144:147], v[72:75]
    v_cvt_pk_bf16_f32 v120, v48, v49
    v_cvt_pk_bf16_f32 v121, v50, v51
    v_mfma_f32_16x16x32_bf16 v[76:79], a[12:15], v[144:147], v[76:79]
    s_waitcnt lgkmcnt(3)
    v_cvt_pk_bf16_f32 v122, v52, v53
    v_cvt_pk_bf16_f32 v123, v54, v55
    v_mfma_f32_16x16x32_bf16 v[64:67], a[16:19], v[148:151], v[64:67]
    v_cvt_pk_bf16_f32 v124, v56, v57
    v_cvt_pk_bf16_f32 v125, v58, v59
    v_mfma_f32_16x16x32_bf16 v[68:71], a[20:23], v[148:151], v[68:71]
    v_cvt_pk_bf16_f32 v126, v60, v61
    v_cvt_pk_bf16_f32 v127, v62, v63
    v_mfma_f32_16x16x32_bf16 v[72:75], a[24:27], v[148:151], v[72:75]
    s_waitcnt vmcnt(1)
    v_cmp_gt_i32 vcc, s58, v4
    v_add_f32 v128, v48, v49
    v_mfma_f32_16x16x32_bf16 v[76:79], a[28:31], v[148:151], v[76:79]
    s_waitcnt lgkmcnt(2)
    v_mul_f32 v129, v48, v48
    v_fmac_f32 v129, v49, v49
    v_mfma_f32_16x16x32_bf16 v[64:67], a[32:35], v[152:155], v[64:67]
    s_cbranch_vccnz L_spin_woodd_fast
L_ret_woodd_fast:
    v_add_f32 v128, v128, v50
    v_fmac_f32 v129, v50, v50
    v_mfma_f32_16x16x32_bf16 v[68:71], a[36:39], v[152:155], v[68:71]
    s_mov_b32 m0, s68
    v_add_f32 v128, v128, v51
    v_fmac_f32 v129, v51, v51
    v_mfma_f32_16x16x32_bf16 v[72:75], a[40:43], v[152:155], v[72:75]
    s_add_u32 s58, s58, 1
    buffer_load_dwordx4 v26, s[12:15], s66 offen offset:0 sc1 lds
    v_mfma_f32_16x16x32_bf16 v[76:79], a[44:47], v[152:155], v[76:79]
    s_waitcnt lgkmcnt(1)
    buffer_load_dwordx4 v27, s[12:15], s66 offen offset:1024 sc1 lds
    v_mfma_f32_16x16x32_bf16 v[64:67], a[48:51], v[156:159], v[64:67]
    s_add_u32 m0, s78, 0
    ds_read_b128 v[164:167], v3 offset:22528
    v_add_f32 v128, v128, v52
    v_mfma_f32_16x16x32_bf16 v[68:71], a[52:55], v[156:159], v[68:71]
    s_mov_b32 s82, s66
    v_fmac_f32 v129, v52, v52
    v_add_f32 v128, v128, v53
    v_mfma_f32_16x16x32_bf16 v[72:75], a[56:59], v[156:159], v[72:75]
    buffer_load_dwordx4 v22, s[4:7], s59 offen offset:0 sc1 lds
    v_mfma_f32_16x16x32_bf16 v[76:79], a[60:63], v[156:159], v[76:79]
    s_waitcnt lgkmcnt(1)
    v_fmac_f32 v129, v53, v53
    v_add_f32 v128, v128, v54
    v_mfma_f32_16x16x32_bf16 v[64:67], a[64:67], v[160:163], v[64:67]
    ds_read_b128 v[168:171], v3 offset:23552
    v_fmac_f32 v129, v54, v54
    v_mfma_f32_16x16x32_bf16 v[68:71], a[68:71], v[160:163], v[68:71]
    buffer_load_dwordx4 v22, s[4:7], s59 offen offset:1024 sc1 lds
    v_mfma_f32_16x16x32_bf16 v[72:75], a[72:75], v[160:163], v[72:75]
    v_add_f32 v128, v128, v55
    v_fmac_f32 v129, v55, v55
    v_mfma_f32_16x16x32_bf16 v[76:79], a[76:79], v[160:163], v[76:79]
    s_waitcnt lgkmcnt(1)
    v_add_f32 v128, v128, v56
    v_fmac_f32 v129, v56, v56
    v_mfma_f32_16x16x32_bf16 v[64:67], a[80:83], v[164:167], v[64:67]
    buffer_load_dwordx4 v22, s[4:7], s59 offen offset:2048 sc1 lds
    v_mfma_f32_16x16x32_bf16 v[68:71], a[84:87], v[164:167], v[68:71]
    ds_read_b128 v[172:175], v3 offset:24576
    v_add_f32 v128, v128, v57
    v_mfma_f32_16x16x32_bf16 v[72:75], a[88:91], v[164:167], v[72:75]
    v_fmac_f32 v129, v57, v57
    v_add_f32 v128, v128, v58
    v_mfma_f32_16x16x32_bf16 v[76:79], a[92:95], v[164:167], v[76:79]
    s_waitcnt lgkmcnt(1)
    buffer_load_dwordx4 v22, s[4:7], s59 offen offset:3072 sc1 lds
    v_mfma_f32_16x16x32_bf16 v[64:67], a[96:99], v[168:171], v[64:67]
    s_add_u32 s59, s59, 16384
    ds_read_b128 v[176:179], v3 offset:25600
    v_fmac_f32 v129, v58, v58
    v_mfma_f32_16x16x32_bf16 v[68:71], a[100:103], v[168:171], v[68:71]
    s_and_b32 s59, s59, 0x3ffeffff
    v_add_f32 v128, v128, v59
    v_fmac_f32 v129, v59, v59
    v_mfma_f32_16x16x32_bf16 v[72:75], a[104:107], v[168:171], v[72:75]
    s_add_u32 s66, s66, 16384
    buffer_store_dwordx2 v[120:121], v32, s[24:27], s83 offen
    v_mfma_f32_16x16x32_bf16 v[76:79], a[108:111], v[168:171], v[76:79]
    s_waitcnt lgkmcnt(1)
    v_add_f32 v128, v128, v60
    v_fmac_f32 v129, v60, v60
    v_mfma_f32_16x16x32_bf16 v[64:67], a[112:115], v[172:175], v[64:67]
    s_and_b32 s66, s66, 0x1fffff
    ds_read_b128 v[180:183], v3 offset:26624
    v_add_f32 v128, v128, v61
    v_mfma_f32_16x16x32_bf16 v[68:71], a[116:119], v[172:175], v[68:71]
    s_cmp_eq_u32 s58, 32
    s_cselect_b64 s[12:13], s[86:87], s[12:13]
    v_fmac_f32 v129, v61, v61
    v_add_f32 v128, v128, v62
    v_mfma_f32_16x16x32_bf16 v[72:75], a[120:123], v[172:175], v[72:75]
    v_fmac_f32 v129, v62, v62
    v_add_f32 v128, v128, v63
    v_mfma_f32_16x16x32_bf16 v[76:79], a[124:127], v[172:175], v[76:79]
    s_waitcnt lgkmcnt(1)
    v_fmac_f32 v129, v63, v63
    v_mfma_f32_16x16x32_bf16 v[64:67], a[128:131], v[176:179], v[64:67]
    buffer_store_dwordx2 v[122:123], v33, s[24:27], s83 offen
    v_mfma_f32_16x16x32_bf16 v[68:71], a[132:135], v[176:179], v[68:71]
    ds_read_b128 v[184:187], v3 offset:27648
    v_mfma_f32_16x16x32_bf16 v[72:75], a[136:139], v[176:179], v[72:75]
    v_permlane16_swap_b32 v128, v129
    v_mfma_f32_16x16x32_bf16 v[76:79], a[140:143], v[176:179], v[76:79]
    s_waitcnt lgkmcnt(1)
    v_add_f32 v130, v128, v129
    v_add_f32 v128, v128, v129
    v_mfma_f32_16x16x32_bf16 v[64:67], a[144:147], v[180:183], v[64:67]
    s_waitcnt vmcnt(6)
    ds_read_b128 v[188:191], v3 offset:28672
    ds_read_b128 v[112:115], v28
    v_mfma_f32_16x16x32_bf16 v[68:71], a[148:151], v[180:183], v[68:71]
    ds_read_b128 v[116:119], v29
    v_mfma_f32_16x16x32_bf16 v[72:75], a[152:155], v[180:183], v[72:75]
    buffer_store_dwordx2 v[124:125], v34, s[24:27], s83 offen
    v_mfma_f32_16x16x32_bf16 v[76:79], a[156:159], v[180:183], v[76:79]
    s_waitcnt lgkmcnt(3)
    v_permlane32_swap_b32 v128, v130
    v_mfma_f32_16x16x32_bf16 v[64:67], a[160:163], v[184:187], v[64:67]
    ds_read_b128 v[192:195], v3 offset:29696
    v_add_f32 v128, v128, v130
    v_mfma_f32_16x16x32_bf16 v[68:71], a[164:167], v[184:187], v[68:71]
    buffer_store_dword v128, v25, s[16:19], s67 offen
    v_mfma_f32_16x16x32_bf16 v[72:75], a[168:171], v[184:187], v[72:75]
    s_waitcnt lgkmcnt(1)
    v_lshlrev_b32 v48, 16, v112
    v_and_b32 v49, 0xffff0000, v112
    v_mfma_f32_16x16x32_bf16 v[76:79], a[172:175], v[184:187], v[76:79]
    v_lshlrev_b32 v50, 16, v113
    v_and_b32 v51, 0xffff0000, v113
    v_mfma_f32_16x16x32_bf16 v[64:67], a[176:179], v[188:191], v[64:67]
    buffer_store_dwordx2 v[126:127], v35, s[24:27], s83 offen
    v_mfma_f32_16x16x32_bf16 v[68:71], a[180:183], v[188:191], v[68:71]
    s_mov_b32 s83, s60
    ds_read_b128 v[196:199], v3 offset:30720
    v_lshlrev_b32 v52, 16, v114
    v_mfma_f32_16x16x32_bf16 v[72:75], a[184:187], v[188:191], v[72:75]
    s_lshr_b32 s67, s60, 4
    v_add_u32 v7, 1, v7
    v_and_b32 v53, 0xffff0000, v114
    v_mfma_f32_16x16x32_bf16 v[76:79], a[188:191], v[188:191], v[76:79]
    s_waitcnt lgkmcnt(1)
    v_lshlrev_b32 v54, 16, v115
    v_and_b32 v55, 0xffff0000, v115
    v_mfma_f32_16x16x32_bf16 v[64:67], a[192:195], v[192:195], v[64:67]
    ds_read_b128 v[200:203], v3 offset:31744
    v_lshlrev_b32 v56, 16, v116
    v_mfma_f32_16x16x32_bf16 v[68:71], a[196:199], v[192:195], v[68:71]
    v_and_b32 v57, 0xffff0000, v116
    v_lshlrev_b32 v58, 16, v117
    v_mfma_f32_16x16x32_bf16 v[72:75], a[200:203], v[192:195], v[72:75]
    v_and_b32 v59, 0xffff0000, v117
    v_lshlrev_b32 v60, 16, v118
    v_mfma_f32_16x16x32_bf16 v[76:79], a[204:207], v[192:195], v[76:79]
    s_waitcnt lgkmcnt(1)
    v_and_b32 v61, 0xffff0000, v118
    v_lshlrev_b32 v62, 16, v119
    v_mfma_f32_16x16x32_bf16 v[64:67], a[208:211], v[196:199], v[64:67]
    buffer_load_dword v4, v5, s[4:7], s65 offen sc1
    v_mfma_f32_16x16x32_bf16 v[68:71], a[212:215], v[196:199], v[68:71]
    ds_read_b128 v[204:207], v3 offset:32768
    v_and_b32 v63, 0xffff0000, v119
    v_mfma_f32_16x16x32_bf16 v[72:75], a[216:219], v[196:199], v[72:75]
    v_mfma_f32_16x16x32_bf16 v[76:79], a[220:223], v[196:199], v[76:79]
    s_waitcnt lgkmcnt(1)
    v_mfma_f32_16x16x32_bf16 v[64:67], a[224:227], v[200:203], v[64:67]
    v_mfma_f32_16x16x32_bf16 v[68:71], a[228:231], v[200:203], v[68:71]
    s_waitcnt vmcnt(6) lgkmcnt(0)
    s_barrier
    v_mfma_f32_16x16x32_bf16 v[72:75], a[232:235], v[200:203], v[72:75]
    ds_read_b128 v[144:147], v3 offset:0
    v_mfma_f32_16x16x32_bf16 v[76:79], a[236:239], v[200:203], v[76:79]
    ds_read_b128 v[148:151], v3 offset:1024
    v_mfma_f32_16x16x32_bf16 v[64:67], a[240:243], v[204:207], v[64:67]
    ds_read_b128 v[152:155], v3 offset:2048
    v_mfma_f32_16x16x32_bf16 v[68:71], a[244:247], v[204:207], v[68:71]
    s_sub_u32 s61, s61, 1
    ds_read_b128 v[156:159], v3 offset:3072
    v_mfma_f32_16x16x32_bf16 v[72:75], a[248:251], v[204:207], v[72:75]
    s_cmp_lg_u32 s61, 0
    ds_read_b128 v[160:163], v3 offset:4096
    v_mfma_f32_16x16x32_bf16 v[76:79], a[252:255], v[204:207], v[76:79]
    s_cbranch_scc1 L_wo_loop_fast
    s_waitcnt vmcnt(1)
    buffer_store_dword v7, v6, s[4:7], s65 offen
    v_cvt_pk_bf16_f32 v120, v64, v65
    v_cvt_pk_bf16_f32 v121, v66, v67
    buffer_store_dwordx2 v[120:121], v32, s[24:27], s83 offen
    v_cvt_pk_bf16_f32 v122, v68, v69
    v_cvt_pk_bf16_f32 v123, v70, v71
    buffer_store_dwordx2 v[122:123], v33, s[24:27], s83 offen
    v_cvt_pk_bf16_f32 v124, v72, v73
    v_cvt_pk_bf16_f32 v125, v74, v75
    buffer_store_dwordx2 v[124:125], v34, s[24:27], s83 offen
    v_cvt_pk_bf16_f32 v126, v76, v77
    v_cvt_pk_bf16_f32 v127, v78, v79
    buffer_store_dwordx2 v[126:127], v35, s[24:27], s83 offen
    v_add_f32 v128, v64, v65
    v_mul_f32 v129, v64, v64
    v_fmac_f32 v129, v65, v65
    v_add_f32 v128, v128, v66
    v_fmac_f32 v129, v66, v66
    v_add_f32 v128, v128, v67
    v_fmac_f32 v129, v67, v67
    v_add_f32 v128, v128, v68
    v_fmac_f32 v129, v68, v68
    v_add_f32 v128, v128, v69
    v_fmac_f32 v129, v69, v69
    v_add_f32 v128, v128, v70
    v_fmac_f32 v129, v70, v70
    v_add_f32 v128, v128, v71
    v_fmac_f32 v129, v71, v71
    v_add_f32 v128, v128, v72
    v_fmac_f32 v129, v72, v72
    v_add_f32 v128, v128, v73
    v_fmac_f32 v129, v73, v73
    v_add_f32 v128, v128, v74
    v_fmac_f32 v129, v74, v74
    v_add_f32 v128, v128, v75
    v_fmac_f32 v129, v75, v75
    v_add_f32 v128, v128, v76
    v_fmac_f32 v129, v76, v76
    v_add_f32 v128, v128, v77
    v_fmac_f32 v129, v77, v77
    v_add_f32 v128, v128, v78
    v_fmac_f32 v129, v78, v78
    v_add_f32 v128, v128, v79
    v_fmac_f32 v129, v79, v79
    s_nop 1
    v_permlane16_swap_b32 v128, v129
    v_add_f32 v130, v128, v129
    v_add_f32 v128, v128, v129
    s_nop 1
    v_permlane32_swap_b32 v128, v130
    v_add_f32 v128, v128, v130
    buffer_store_dword v128, v25, s[16:19], s67 offen
    v_mov_b32 v7, 64
    s_waitcnt vmcnt(0)
    buffer_store_dword v7, v6, s[4:7], s65 offen
    s_endpgm
L_gu:
    s_sub_u32 s57, s33, 10
    s_lshl_b32 s68, s57, 2
    s_add_u32 s68, s68, s34
    s_lshl_b32 s75, s68, 3
    s_add_u32 s75, s75, s3
    v_lshlrev_b32 v11, 7, v0
    v_mov_b32 v9, 0x80000000
    v_cmp_gt_u32 vcc, 28, v0
    s_nop 1
    v_cndmask_b32 v11, v9, v11, vcc
    s_mov_b32 s16, s38
    s_mov_b32 s17, s39
    s_mov_b32 s18, 1572864
    s_mov_b32 s19, 0x20000
    s_mul_i32 s63, s75, 3584
    s_add_u32 s63, s63, 0
    buffer_load_dword v252, v11, s[16:19], s63 offen
    s_add_u32 s63, s63, 1605632
    v_lshlrev_b32 v11, 7, v0
    v_mov_b32 v9, 0x80000000
    v_cmp_gt_u32 vcc, 10, v0
    s_nop 1
    v_cndmask_b32 v11, v9, v11, vcc
    s_mov_b32 s16, s40
    s_mov_b32 s17, s41
    s_mov_b32 s18, 524288
    s_mov_b32 s19, 0x20000
    s_mul_i32 s63, s75, 1280
    s_add_u32 s63, s63, 0
    buffer_load_dword v252, v11, s[16:19], s63 offen
    s_add_u32 s63, s63, 573440
    s_cmp_lt_u32 s34, 2
    s_cselect_b32 s8, s44, s46
    s_cselect_b32 s9, s45, s47
    s_mov_b32 s10, 1835008
    s_mov_b32 s11, 0x20000
    v_lshrrev_b32 v8, 3, v0
    v_mul_u32_u24 v16, 3584, v8
    v_lshlrev_b32 v8, 1, v8
    v_and_b32 v8, 4, v8
    v_and_b32 v9, 7, v0
    v_xor_b32 v8, v8, v9
    v_lshl_add_u32 v16, v8, 4, v16
    s_and_b32 s63, s34, 1
    s_lshl_b32 s63, s63, 7
    s_lshl_b32 s64, s57, 8
    s_add_u32 s63, s63, s64
    v_add_u32 v16, s63, v16
    v_add_u32 v17, 27648, v16
    v_add_u32 v18, 55296, v16
    v_add_u32 v19, 82944, v16
    s_lshl_b32 s62, s34, 12
    s_add_u32 s62, s62, 40960
    s_mov_b32 s70, 0
    v_lshlrev_b32 v11, 7, v0
    s_mov_b32 s16, s38
    s_mov_b32 s17, s39
    s_mov_b32 s18, 1572864
    s_mov_b32 s19, 0x20000
    s_mul_i32 s63, s68, 8192
    s_add_u32 s63, s63, 294912
    s_waitcnt vmcnt(1)
    buffer_load_dword v252, v11, s[16:19], s63 offen
    s_add_u32 s63, s63, 458752
    s_waitcnt vmcnt(1)
    buffer_load_dword v252, v11, s[16:19], s63 offen
    s_add_u32 s63, s63, 458752
    s_waitcnt vmcnt(1)
    buffer_load_dword v252, v11, s[16:19], s63 offen
    s_add_u32 s63, s63, 458752
    s_mov_b32 s16, s40
    s_mov_b32 s17, s41
    s_mov_b32 s18, 524288
    s_mov_b32 s19, 0x20000
    s_mul_i32 s63, s68, 8192
    s_add_u32 s63, s63, 98304
    s_waitcnt vmcnt(1)
    buffer_load_dword v252, v11, s[16:19], s63 offen
    s_add_u32 s63, s63, 458752
    s_waitcnt vmcnt(1)
    s_add_u32 m0, s62, 0
    s_nop 0
    buffer_load_dwordx4 v16, s[8:11], s70 offen offset:0 lds
    buffer_load_dwordx4 v17, s[8:11], s70 offen offset:1024 lds
    buffer_load_dwordx4 v18, s[8:11], s70 offen offset:2048 lds
    buffer_load_dwordx4 v19, s[8:11], s70 offen offset:3072 lds
    s_add_u32 s70, s70, 114688
    s_add_u32 m0, s62, 16384
    s_nop 0
    buffer_load_dwordx4 v16, s[8:11], s70 offen offset:0 lds
    buffer_load_dwordx4 v17, s[8:11], s70 offen offset:1024 lds
    buffer_load_dwordx4 v18, s[8:11], s70 offen offset:2048 lds
    buffer_load_dwordx4 v19, s[8:11], s70 offen offset:3072 lds
    s_add_u32 s70, s70, 114688
    s_add_u32 m0, s62, 32768
    s_nop 0
    buffer_load_dwordx4 v16, s[8:11], s70 offen offset:0 lds
    buffer_load_dwordx4 v17, s[8:11], s70 offen offset:1024 lds
    buffer_load_dwordx4 v18, s[8:11], s70 offen offset:2048 lds
    buffer_load_dwordx4 v19, s[8:11], s70 offen offset:3072 lds
    s_add_u32 s70, s70, 114688
    v_lshrrev_b32 v8, 2, v1
    v_lshl_add_u32 v20, v2, 3, v8
    v_lshlrev_b32 v20, 7, v20
    v_lshrrev_b32 v8, 1, v8
    s_and_b32 s63, s34, 1
    v_xor_b32 v8, s63, v8
    v_lshl_add_u32 v20, v8, 6, v20
    v_and_b32 v8, 3, v0
    v_lshl_add_u32 v20, v8, 4, v20
    s_lshr_b32 s63, s34, 1
    s_lshl_b32 s63, s63, 12
    s_add_u32 s63, s63, 40960
    v_add_u32 v20, s63, v20
    s_mul_i32 s78, s34, 4352
    s_lshl_b32 s63, s34, 8
    v_lshl_add_u32 v22, v0, 2, s63
    v_lshrrev_b32 v8, 3, v0
    v_and_b32 v9, 7, v0
    v_lshlrev_b32 v8, 10, v8
    v_lshl_add_u32 v8, v9, 4, v8
    v_add_u32 v8, s63, v8
    v_add_u32 v84, 3840, v8
    v_add_u32 v85, 11008, v8
    v_add_u32 v86, 1920, v8
    v_add_u32 v87, 9088, v8
    s_sub_u32 s12, s50, 4096
    s_subb_u32 s13, s51, 0
    s_mov_b32 s14, 2101248
    s_mov_b32 s15, 0x20000
    s_add_u32 s24, s54, 35651584
    s_addc_u32 s25, s55, 0
    s_mov_b32 s26, 131072
    s_mov_b32 s27, 0x20000
    v_mul_u32_u24 v24, 4352, v2
    v_lshl_add_u32 v24, v1, 2, v24
    v_add_u32 v25, 17408, v24
    v_and_b32 v8, 7, v0
    v_lshlrev_b32 v5, 2, v8
    v_add_u32 v5, 128, v5
    s_lshl_b32 s63, s68, 10
    v_add_u32 v28, s63, v3
    s_lshl_b32 s63, s68, 2
    s_add_u32 s63, s63, 256
    v_mov_b32 v6, s63
    v_mov_b32 v9, 0x80000000
    v_cmp_eq_u32 vcc, 0, v0
    s_nop 1
    v_cndmask_b32 v6, v9, v6, vcc
    v_lshlrev_b32 v80, 3, v0
    v_add_u32 v81, 256, v80
    s_lshl_b32 s66, s3, 18
    s_add_u32 s77, s66, 16384
    s_mov_b32 s58, 13
    s_mov_b32 s82, s66
    s_mul_i32 s60, s3, 0x200000
    s_add_u32 s60, s60, 0x1000000
    s_add_u32 s32, s60, 262144
    s_mul_i32 s63, s68, 4682
    s_lshr_b32 s63, s63, 16
    s_lshl_b32 s63, s63, 2
    s_add_u32 s63, s63, 512
    v_and_b32 v8, 7, v0
    v_lshl_add_u32 v8, v8, 4, s63
    v_and_b32 v11, 8, v0
    v_cmp_ne_u32 vcc, 0, v11
    s_nop 1
    v_cndmask_b32 v5, v5, v8, vcc
    v_lshrrev_b32 v8, 3, v0
    v_lshlrev_b32 v250, 16, v8
    v_and_b32 v8, 7, v0
    v_lshl_add_u32 v250, v8, 7, v250
    s_lshl_b32 s63, s68, 10
    s_add_u32 s63, s63, s60
    v_add_u32 v250, s63, v250
    v_mov_b32 v9, 0x80000000
    v_cmp_gt_u32 vcc, 32, v0
    s_nop 1
    v_cndmask_b32 v250, v9, v250, vcc
    s_waitcnt vmcnt(8)
    s_barrier
    s_add_u32 m0, s62, 49152
    s_nop 0
    buffer_load_dwordx4 v16, s[8:11], s70 offen offset:0 lds
    buffer_load_dwordx4 v17, s[8:11], s70 offen offset:1024 lds
    buffer_load_dwordx4 v18, s[8:11], s70 offen offset:2048 lds
    buffer_load_dwordx4 v19, s[8:11], s70 offen offset:3072 lds
    s_add_u32 s70, s70, 114688
    s_lshl_b32 s63, s3, 2
    v_mov_b32 v8, s63
    buffer_load_dword v4, v8, s[20:23], 0 offen sc1
    ds_read_b64_tr_b16 a[0:1], v20 offset:0
    ds_read_b64_tr_b16 a[2:3], v20 offset:512
    ds_read_b64_tr_b16 a[4:5], v20 offset:8
    ds_read_b64_tr_b16 a[6:7], v20 offset:520
    ds_read_b64_tr_b16 a[8:9], v20 offset:8192
    ds_read_b64_tr_b16 a[10:11], v20 offset:8704
    ds_read_b64_tr_b16 a[12:13], v20 offset:8200
    ds_read_b64_tr_b16 a[14:15], v20 offset:8712
    s_waitcnt lgkmcnt(0)
    v_mfma_f32_16x16x32_bf16 v[32:35], a[0:3], v[12:15], 0
    v_mfma_f32_16x16x32_bf16 v[36:39], a[4:7], v[12:15], 0
    v_mfma_f32_16x16x32_bf16 v[40:43], a[8:11], v[12:15], 0
    v_mfma_f32_16x16x32_bf16 v[44:47], a[12:15], v[12:15], 0
    s_waitcnt vmcnt(9)
    s_barrier
    s_add_u32 m0, s62, 0
    s_nop 0
    buffer_load_dwordx4 v16, s[8:11], s70 offen offset:0 lds
    buffer_load_dwordx4 v17, s[8:11], s70 offen offset:1024 lds
    buffer_load_dwordx4 v18, s[8:11], s70 offen offset:2048 lds
    buffer_load_dwordx4 v19, s[8:11], s70 offen offset:3072 lds
    s_add_u32 s70, s70, 114688
    ds_read_b64_tr_b16 a[16:17], v20 offset:16384
    ds_read_b64_tr_b16 a[18:19], v20 offset:16896
    ds_read_b64_tr_b16 a[20:21], v20 offset:16392
    ds_read_b64_tr_b16 a[22:23], v20 offset:16904
    ds_read_b64_tr_b16 a[24:25], v20 offset:24576
    ds_read_b64_tr_b16 a[26:27], v20 offset:25088
    ds_read_b64_tr_b16 a[28:29], v20 offset:24584
    ds_read_b64_tr_b16 a[30:31], v20 offset:25096
    s_waitcnt lgkmcnt(0)
    v_mfma_f32_16x16x32_bf16 v[32:35], a[16:19], v[12:15], v[32:35]
    v_mfma_f32_16x16x32_bf16 v[36:39], a[20:23], v[12:15], v[36:39]
    v_mfma_f32_16x16x32_bf16 v[40:43], a[24:27], v[12:15], v[40:43]
    v_mfma_f32_16x16x32_bf16 v[44:47], a[28:31], v[12:15], v[44:47]
    s_waitcnt vmcnt(9)
    s_barrier
    s_add_u32 m0, s62, 16384
    s_nop 0
    buffer_load_dwordx4 v16, s[8:11], s70 offen offset:0 lds
    buffer_load_dwordx4 v17, s[8:11], s70 offen offset:1024 lds
    buffer_load_dwordx4 v18, s[8:11], s70 offen offset:2048 lds
    buffer_load_dwordx4 v19, s[8:11], s70 offen offset:3072 lds
    s_add_u32 s70, s70, 114688
    ds_read_b64_tr_b16 a[32:33], v20 offset:32768
    ds_read_b64_tr_b16 a[34:35], v20 offset:33280
    ds_read_b64_tr_b16 a[36:37], v20 offset:32776
    ds_read_b64_tr_b16 a[38:39], v20 offset:33288
    ds_read_b64_tr_b16 a[40:41], v20 offset:40960
    ds_read_b64_tr_b16 a[42:43], v20 offset:41472
    ds_read_b64_tr_b16 a[44:45], v20 offset:40968
    ds_read_b64_tr_b16 a[46:47], v20 offset:41480
    s_waitcnt lgkmcnt(0)
    v_mfma_f32_16x16x32_bf16 v[32:35], a[32:35], v[12:15], v[32:35]
    v_mfma_f32_16x16x32_bf16 v[36:39], a[36:39], v[12:15], v[36:39]
    v_mfma_f32_16x16x32_bf16 v[40:43], a[40:43], v[12:15], v[40:43]
    v_mfma_f32_16x16x32_bf16 v[44:47], a[44:47], v[12:15], v[44:47]
    s_waitcnt vmcnt(9)
    s_barrier
    s_add_u32 m0, s62, 32768
    s_nop 0
    buffer_load_dwordx4 v16, s[8:11], s70 offen offset:0 lds
    buffer_load_dwordx4 v17, s[8:11], s70 offen offset:1024 lds
    buffer_load_dwordx4 v18, s[8:11], s70 offen offset:2048 lds
    buffer_load_dwordx4 v19, s[8:11], s70 offen offset:3072 lds
    s_add_u32 s70, s70, 114688
    s_waitcnt vmcnt(12)
    v_cmp_eq_u32 vcc, 0, v4
    s_cbranch_vccnz L_hs_10
L_hsret_11:
    v_cmp_ne_u32 vcc, s35, v4
    s_cbranch_vccnz L_hsmm_12
L_hsok_13:
    ds_read_b64_tr_b16 a[48:49], v20 offset:49152
    ds_read_b64_tr_b16 a[50:51], v20 offset:49664
    ds_read_b64_tr_b16 a[52:53], v20 offset:49160
    ds_read_b64_tr_b16 a[54:55], v20 offset:49672
    ds_read_b64_tr_b16 a[56:57], v20 offset:57344
    ds_read_b64_tr_b16 a[58:59], v20 offset:57856
    ds_read_b64_tr_b16 a[60:61], v20 offset:57352
    ds_read_b64_tr_b16 a[62:63], v20 offset:57864
    s_waitcnt lgkmcnt(0)
    v_mfma_f32_16x16x32_bf16 v[32:35], a[48:51], v[12:15], v[32:35]
    v_mfma_f32_16x16x32_bf16 v[36:39], a[52:55], v[12:15], v[36:39]
    v_mfma_f32_16x16x32_bf16 v[40:43], a[56:59], v[12:15], v[40:43]
    v_mfma_f32_16x16x32_bf16 v[44:47], a[60:63], v[12:15], v[44:47]
    s_waitcnt vmcnt(8)
    s_barrier
    s_add_u32 m0, s62, 49152
    s_nop 0
    buffer_load_dwordx4 v16, s[8:11], s70 offen offset:0 lds
    buffer_load_dwordx4 v17, s[8:11], s70 offen offset:1024 lds
    buffer_load_dwordx4 v18, s[8:11], s70 offen offset:2048 lds
    buffer_load_dwordx4 v19, s[8:11], s70 offen offset:3072 lds
    s_add_u32 s70, s70, 114688
    ds_read_b64_tr_b16 a[64:65], v20 offset:0
    ds_read_b64_tr_b16 a[66:67], v20 offset:512
    ds_read_b64_tr_b16 a[68:69], v20 offset:8
    ds_read_b64_tr_b16 a[70:71], v20 offset:520
    ds_read_b64_tr_b16 a[72:73], v20 offset:8192
    ds_read_b64_tr_b16 a[74:75], v20 offset:8704
    ds_read_b64_tr_b16 a[76:77], v20 offset:8200
    ds_read_b64_tr_b16 a[78:79], v20 offset:8712
    s_waitcnt lgkmcnt(0)
    v_mfma_f32_16x16x32_bf16 v[32:35], a[64:67], v[12:15], v[32:35]
    v_mfma_f32_16x16x32_bf16 v[36:39], a[68:71], v[12:15], v[36:39]
    v_mfma_f32_16x16x32_bf16 v[40:43], a[72:75], v[12:15], v[40:43]
    v_mfma_f32_16x16x32_bf16 v[44:47], a[76:79], v[12:15], v[44:47]
    s_waitcnt vmcnt(8)
    s_barrier
    s_add_u32 m0, s62, 0
    s_nop 0
    buffer_load_dwordx4 v16, s[8:11], s70 offen offset:0 lds
    buffer_load_dwordx4 v17, s[8:11], s70 offen offset:1024 lds
    buffer_load_dwordx4 v18, s[8:11], s70 offen offset:2048 lds
    buffer_load_dwordx4 v19, s[8:11], s70 offen offset:3072 lds
    s_add_u32 s70, s70, 114688
    ds_read_b64_tr_b16 a[80:81], v20 offset:16384
    ds_read_b64_tr_b16 a[82:83], v20 offset:16896
    ds_read_b64_tr_b16 a[84:85], v20 offset:16392
    ds_read_b64_tr_b16 a[86:87], v20 offset:16904
    ds_read_b64_tr_b16 a[88:89], v20 offset:24576
    ds_read_b64_tr_b16 a[90:91], v20 offset:25088
    ds_read_b64_tr_b16 a[92:93], v20 offset:24584
    ds_read_b64_tr_b16 a[94:95], v20 offset:25096
    s_waitcnt lgkmcnt(0)
    v_mfma_f32_16x16x32_bf16 v[32:35], a[80:83], v[12:15], v[32:35]
    v_mfma_f32_16x16x32_bf16 v[36:39], a[84:87], v[12:15], v[36:39]
    v_mfma_f32_16x16x32_bf16 v[40:43], a[88:91], v[12:15], v[40:43]
    v_mfma_f32_16x16x32_bf16 v[44:47], a[92:95], v[12:15], v[44:47]
    s_waitcnt vmcnt(8)
    s_barrier
    s_add_u32 m0, s62, 16384
    s_nop 0
    buffer_load_dwordx4 v16, s[8:11], s70 offen offset:0 lds
    buffer_load_dwordx4 v17, s[8:11], s70 offen offset:1024 lds
    buffer_load_dwordx4 v18, s[8:11], s70 offen offset:2048 lds
    buffer_load_dwordx4 v19, s[8:11], s70 offen offset:3072 lds
    s_add_u32 s70, s70, 114688
    ds_read_b64_tr_b16 a[96:97], v20 offset:32768
    ds_read_b64_tr_b16 a[98:99], v20 offset:33280
    ds_read_b64_tr_b16 a[100:101], v20 offset:32776
    ds_read_b64_tr_b16 a[102:103], v20 offset:33288
    ds_read_b64_tr_b16 a[104:105], v20 offset:40960
    ds_read_b64_tr_b16 a[106:107], v20 offset:41472
    ds_read_b64_tr_b16 a[108:109], v20 offset:40968
    ds_read_b64_tr_b16 a[110:111], v20 offset:41480
    s_waitcnt lgkmcnt(0)
    v_mfma_f32_16x16x32_bf16 v[32:35], a[96:99], v[12:15], v[32:35]
    v_mfma_f32_16x16x32_bf16 v[36:39], a[100:103], v[12:15], v[36:39]
    v_mfma_f32_16x16x32_bf16 v[40:43], a[104:107], v[12:15], v[40:43]
    v_mfma_f32_16x16x32_bf16 v[44:47], a[108:111], v[12:15], v[44:47]
    s_waitcnt vmcnt(8)
    s_barrier
    s_add_u32 m0, s62, 32768
    s_nop 0
    buffer_load_dwordx4 v16, s[8:11], s70 offen offset:0 lds
    buffer_load_dwordx4 v17, s[8:11], s70 offen offset:1024 lds
    buffer_load_dwordx4 v18, s[8:11], s70 offen offset:2048 lds
    buffer_load_dwordx4 v19, s[8:11], s70 offen offset:3072 lds
    s_add_u32 s70, s70, 114688
    ds_read_b64_tr_b16 a[112:113], v20 offset:49152
    ds_read_b64_tr_b16 a[114:115], v20 offset:49664
    ds_read_b64_tr_b16 a[116:117], v20 offset:49160
    ds_read_b64_tr_b16 a[118:119], v20 offset:49672
    ds_read_b64_tr_b16 a[120:121], v20 offset:57344
    ds_read_b64_tr_b16 a[122:123], v20 offset:57856
    ds_read_b64_tr_b16 a[124:125], v20 offset:57352
    ds_read_b64_tr_b16 a[126:127], v20 offset:57864
    s_waitcnt lgkmcnt(0)
    v_mfma_f32_16x16x32_bf16 v[32:35], a[112:115], v[12:15], v[32:35]
    v_mfma_f32_16x16x32_bf16 v[36:39], a[116:119], v[12:15], v[36:39]
    v_mfma_f32_16x16x32_bf16 v[40:43], a[120:123], v[12:15], v[40:43]
    v_mfma_f32_16x16x32_bf16 v[44:47], a[124:127], v[12:15], v[44:47]
    s_waitcnt vmcnt(8)
    s_barrier
    s_add_u32 m0, s62, 49152
    s_nop 0
    buffer_load_dwordx4 v16, s[8:11], s70 offen offset:0 lds
    buffer_load_dwordx4 v17, s[8:11], s70 offen offset:1024 lds
    buffer_load_dwordx4 v18, s[8:11], s70 offen offset:2048 lds
    buffer_load_dwordx4 v19, s[8:11], s70 offen offset:3072 lds
    s_add_u32 s70, s70, 114688
    ds_read_b64_tr_b16 a[128:129], v20 offset:0
    ds_read_b64_tr_b16 a[130:131], v20 offset:512
    ds_read_b64_tr_b16 a[132:133], v20 offset:8
    ds_read_b64_tr_b16 a[134:135], v20 offset:520
    ds_read_b64_tr_b16 a[136:137], v20 offset:8192
    ds_read_b64_tr_b16 a[138:139], v20 offset:8704
    ds_read_b64_tr_b16 a[140:141], v20 offset:8200
    ds_read_b64_tr_b16 a[142:143], v20 offset:8712
    s_waitcnt lgkmcnt(0)
    v_mfma_f32_16x16x32_bf16 v[32:35], a[128:131], v[12:15], v[32:35]
    v_mfma_f32_16x16x32_bf16 v[36:39], a[132:135], v[12:15], v[36:39]
    v_mfma_f32_16x16x32_bf16 v[40:43], a[136:139], v[12:15], v[40:43]
    v_mfma_f32_16x16x32_bf16 v[44:47], a[140:143], v[12:15], v[44:47]
    s_waitcnt vmcnt(8)
    s_barrier
    s_add_u32 m0, s62, 0
    s_nop 0
    buffer_load_dwordx4 v16, s[8:11], s70 offen offset:0 lds
    buffer_load_dwordx4 v17, s[8:11], s70 offen offset:1024 lds
    buffer_load_dwordx4 v18, s[8:11], s70 offen offset:2048 lds
    buffer_load_dwordx4 v19, s[8:11], s70 offen offset:3072 lds
    s_add_u32 s70, s70, 114688
    ds_read_b64_tr_b16 a[144:145], v20 offset:16384
    ds_read_b64_tr_b16 a[146:147], v20 offset:16896
    ds_read_b64_tr_b16 a[148:149], v20 offset:16392
    ds_read_b64_tr_b16 a[150:151], v20 offset:16904
    ds_read_b64_tr_b16 a[152:153], v20 offset:24576
    ds_read_b64_tr_b16 a[154:155], v20 offset:25088
    ds_read_b64_tr_b16 a[156:157], v20 offset:24584
    ds_read_b64_tr_b16 a[158:159], v20 offset:25096
    s_waitcnt lgkmcnt(0)
    v_mfma_f32_16x16x32_bf16 v[32:35], a[144:147], v[12:15], v[32:35]
    v_mfma_f32_16x16x32_bf16 v[36:39], a[148:151], v[12:15], v[36:39]
    v_mfma_f32_16x16x32_bf16 v[40:43], a[152:155], v[12:15], v[40:43]
    v_mfma_f32_16x16x32_bf16 v[44:47], a[156:159], v[12:15], v[44:47]
    s_waitcnt vmcnt(8)
    s_barrier
    v_mov_b32 v7, 1
    s_cmp_lg_u32 s74, 0
    s_cbranch_scc1 L_gu_gos
    buffer_store_dword v7, v6, s[4:7], s65 offen
L_gu_god:
    s_add_u32 m0, s62, 16384
    s_nop 0
    buffer_load_dwordx4 v16, s[8:11], s70 offen offset:0 lds
    buffer_load_dwordx4 v17, s[8:11], s70 offen offset:1024 lds
    buffer_load_dwordx4 v18, s[8:11], s70 offen offset:2048 lds
    buffer_load_dwordx4 v19, s[8:11], s70 offen offset:3072 lds
    s_add_u32 s70, s70, 114688
    buffer_load_dword v252, v250, s[4:7], 0 offen sc1
    v_lshlrev_b32 v11, 7, v0
    v_mov_b32 v9, 0x80000000
    v_cmp_gt_u32 vcc, 28, v0
    s_nop 1
    v_cndmask_b32 v11, v9, v11, vcc
    s_add_u32 s16, s50, s82
    s_addc_u32 s17, s51, 0
    s_mov_b32 s18, 262144
    s_mov_b32 s19, 0x20000
    s_mul_i32 s63, s68, 3584
    s_add_u32 s63, s63, 65536
    buffer_load_dword v252, v11, s[16:19], s63 offen
    s_add_u32 s63, s63, 200704
    s_add_u32 s75, s3, 1
    s_and_b32 s75, s75, 7
    s_lshl_b32 s75, s75, 18
    s_lshr_b32 s75, s75, 4
    s_add_u32 s75, s75, 0x2200000
    s_lshl_b32 s61, s3, 14
    s_add_u32 s61, s61, 0x2200000
    v_lshlrev_b32 v11, 7, v0
    v_mov_b32 v9, 0x80000000
    v_cmp_gt_u32 vcc, 3, v0
    s_nop 1
    v_cndmask_b32 v11, v9, v11, vcc
    s_add_u32 s16, s54, s75
    s_addc_u32 s17, s55, 0
    s_mov_b32 s18, 1024
    s_mov_b32 s19, 0x20000
    s_mul_i32 s63, s68, 384
    s_add_u32 s63, s63, 0
    buffer_load_dword v252, v11, s[16:19], s63 offen sc1
    s_add_u32 s63, s63, 21504
    s_add_u32 s16, s54, s61
    s_addc_u32 s17, s55, 0
    s_mov_b32 s18, 16384
    s_mov_b32 s19, 0x20000
    s_mul_i32 s63, s68, 384
    s_add_u32 s63, s63, 1024
    buffer_load_dword v252, v11, s[16:19], s63 offen sc1
    s_add_u32 s63, s63, 21504
    ds_read_b64_tr_b16 a[160:161], v20 offset:32768
    ds_read_b64_tr_b16 a[162:163], v20 offset:33280
    ds_read_b64_tr_b16 a[164:165], v20 offset:32776
    ds_read_b64_tr_b16 a[166:167], v20 offset:33288
    ds_read_b64_tr_b16 a[168:169], v20 offset:40960
    ds_read_b64_tr_b16 a[170:171], v20 offset:41472
    ds_read_b64_tr_b16 a[172:173], v20 offset:40968
    ds_read_b64_tr_b16 a[174:175], v20 offset:41480
    s_waitcnt lgkmcnt(0)
    v_mfma_f32_16x16x32_bf16 v[32:35], a[160:163], v[12:15], v[32:35]
    v_mfma_f32_16x16x32_bf16 v[36:39], a[164:167], v[12:15], v[36:39]
    v_mfma_f32_16x16x32_bf16 v[40:43], a[168:171], v[12:15], v[40:43]
    v_mfma_f32_16x16x32_bf16 v[44:47], a[172:175], v[12:15], v[44:47]
    s_waitcnt vmcnt(13)
    s_barrier
    s_add_u32 m0, s62, 32768
    s_nop 0
    buffer_load_dwordx4 v16, s[8:11], s70 offen offset:0 lds
    buffer_load_dwordx4 v17, s[8:11], s70 offen offset:1024 lds
    buffer_load_dwordx4 v18, s[8:11], s70 offen offset:2048 lds
    buffer_load_dwordx4 v19, s[8:11], s70 offen offset:3072 lds
    s_add_u32 s70, s70, 114688
    ds_read_b64_tr_b16 a[176:177], v20 offset:49152
    ds_read_b64_tr_b16 a[178:179], v20 offset:49664
    ds_read_b64_tr_b16 a[180:181], v20 offset:49160
    ds_read_b64_tr_b16 a[182:183], v20 offset:49672
    ds_read_b64_tr_b16 a[184:185], v20 offset:57344
    ds_read_b64_tr_b16 a[186:187], v20 offset:57856
    ds_read_b64_tr_b16 a[188:189], v20 offset:57352
    ds_read_b64_tr_b16 a[190:191], v20 offset:57864
    s_waitcnt lgkmcnt(0)
    v_mfma_f32_16x16x32_bf16 v[32:35], a[176:179], v[12:15], v[32:35]
    v_mfma_f32_16x16x32_bf16 v[36:39], a[180:183], v[12:15], v[36:39]
    v_mfma_f32_16x16x32_bf16 v[40:43], a[184:187], v[12:15], v[40:43]
    v_mfma_f32_16x16x32_bf16 v[44:47], a[188:191], v[12:15], v[44:47]
    s_waitcnt vmcnt(13)
    s_barrier
    s_add_u32 m0, s62, 49152
    s_nop 0
    buffer_load_dwordx4 v16, s[8:11], s70 offen offset:0 lds
    buffer_load_dwordx4 v17, s[8:11], s70 offen offset:1024 lds
    buffer_load_dwordx4 v18, s[8:11], s70 offen offset:2048 lds
    buffer_load_dwordx4 v19, s[8:11], s70 offen offset:3072 lds
    s_add_u32 s70, s70, 114688
    ds_read_b64_tr_b16 a[192:193], v20 offset:0
    ds_read_b64_tr_b16 a[194:195], v20 offset:512
    ds_read_b64_tr_b16 a[196:197], v20 offset:8
    ds_read_b64_tr_b16 a[198:199], v20 offset:520
    ds_read_b64_tr_b16 a[200:201], v20 offset:8192
    ds_read_b64_tr_b16 a[202:203], v20 offset:8704
    ds_read_b64_tr_b16 a[204:205], v20 offset:8200
    ds_read_b64_tr_b16 a[206:207], v20 offset:8712
    s_waitcnt lgkmcnt(0)
    v_mfma_f32_16x16x32_bf16 v[32:35], a[192:195], v[12:15], v[32:35]
    v_mfma_f32_16x16x32_bf16 v[36:39], a[196:199], v[12:15], v[36:39]
    v_mfma_f32_16x16x32_bf16 v[40:43], a[200:203], v[12:15], v[40:43]
    v_mfma_f32_16x16x32_bf16 v[44:47], a[204:207], v[12:15], v[44:47]
    s_waitcnt vmcnt(12)
    s_barrier
    buffer_load_dword v4, v5, s[4:7], s65 offen sc1
    ds_read_b64_tr_b16 a[208:209], v20 offset:16384
    ds_read_b64_tr_b16 a[210:211], v20 offset:16896
    ds_read_b64_tr_b16 a[212:213], v20 offset:16392
    ds_read_b64_tr_b16 a[214:215], v20 offset:16904
    ds_read_b64_tr_b16 a[216:217], v20 offset:24576
    ds_read_b64_tr_b16 a[218:219], v20 offset:25088
    ds_read_b64_tr_b16 a[220:221], v20 offset:24584
    ds_read_b64_tr_b16 a[222:223], v20 offset:25096
    s_waitcnt lgkmcnt(0)
    v_mfma_f32_16x16x32_bf16 v[32:35], a[208:211], v[12:15], v[32:35]
    v_mfma_f32_16x16x32_bf16 v[36:39], a[212:215], v[12:15], v[36:39]
    v_mfma_f32_16x16x32_bf16 v[40:43], a[216:219], v[12:15], v[40:43]
    v_mfma_f32_16x16x32_bf16 v[44:47], a[220:223], v[12:15], v[44:47]
    s_waitcnt vmcnt(5)
    s_barrier
    ds_read_b64_tr_b16 a[224:225], v20 offset:32768
    ds_read_b64_tr_b16 a[226:227], v20 offset:33280
    ds_read_b64_tr_b16 a[228:229], v20 offset:32776
    ds_read_b64_tr_b16 a[230:231], v20 offset:33288
    ds_read_b64_tr_b16 a[232:233], v20 offset:40960
    ds_read_b64_tr_b16 a[234:235], v20 offset:41472
    ds_read_b64_tr_b16 a[236:237], v20 offset:40968
    ds_read_b64_tr_b16 a[238:239], v20 offset:41480
    s_waitcnt lgkmcnt(0)
    v_mfma_f32_16x16x32_bf16 v[32:35], a[224:227], v[12:15], v[32:35]
    v_mfma_f32_16x16x32_bf16 v[36:39], a[228:231], v[12:15], v[36:39]
    v_mfma_f32_16x16x32_bf16 v[40:43], a[232:235], v[12:15], v[40:43]
    v_mfma_f32_16x16x32_bf16 v[44:47], a[236:239], v[12:15], v[44:47]
    s_waitcnt vmcnt(1)
    s_barrier
    s_waitcnt vmcnt(0)
    v_cmp_gt_i32 vcc, s58, v4
    s_cbranch_vccnz L_spin_gu_pro
L_ret_gu_pro:
    s_add_u32 s66, s3, 1
    s_and_b32 s66, s66, 7
    s_lshl_b32 s66, s66, 18
    s_add_u32 m0, s78, 0
    s_add_u32 s58, s58, 1
    buffer_load_dwordx4 v84, s[12:15], s66 offen offset:256 sc1 lds
    buffer_load_dwordx4 v85, s[12:15], s66 offen offset:1280 sc1 lds
    buffer_load_dwordx4 v86, s[12:15], s66 offen offset:2304 sc1 lds
    buffer_load_dwordx4 v87, s[12:15], s66 offen offset:3328 sc1 lds
    s_lshr_b32 s67, s66, 4
    buffer_load_dword v22, s[24:27], s67 offen sc1 lds
    s_add_u32 s66, s66, 16384
    s_and_b32 s66, s66, 0x1fffff
    s_mov_b32 s66, s77
    ds_read_b64_tr_b16 a[240:241], v20 offset:49152
    ds_read_b64_tr_b16 a[242:243], v20 offset:49664
    ds_read_b64_tr_b16 a[244:245], v20 offset:49160
    ds_read_b64_tr_b16 a[246:247], v20 offset:49672
    ds_read_b64_tr_b16 a[248:249], v20 offset:57344
    ds_read_b64_tr_b16 a[250:251], v20 offset:57856
    ds_read_b64_tr_b16 a[252:253], v20 offset:57352
    ds_read_b64_tr_b16 a[254:255], v20 offset:57864
    s_waitcnt lgkmcnt(0)
    v_mfma_f32_16x16x32_bf16 v[32:35], a[240:243], v[12:15], v[32:35]
    v_mfma_f32_16x16x32_bf16 v[36:39], a[244:247], v[12:15], v[36:39]
    v_mfma_f32_16x16x32_bf16 v[40:43], a[248:251], v[12:15], v[40:43]
    v_mfma_f32_16x16x32_bf16 v[44:47], a[252:255], v[12:15], v[44:47]
    buffer_load_dword v4, v5, s[4:7], s65 offen sc1
    s_waitcnt vmcnt(1)
    s_barrier
    ds_read2st64_b64 v[144:147], v81 offset0:0 offset1:1
    ds_read2st64_b64 v[148:151], v81 offset0:2 offset1:3
    ds_read2st64_b64 v[152:155], v81 offset0:4 offset1:5
    s_waitcnt lgkmcnt(2)
    v_mfma_f32_16x16x32_bf16 v[48:51], a[0:3], v[144:147], 0
    ds_read2_b32 v[136:137], v24 offset0:0 offset1:32
    ds_read2_b32 v[138:139], v24 offset0:16 offset1:48
    v_mfma_f32_16x16x32_bf16 v[52:55], a[4:7], v[144:147], 0
    v_mfma_f32_16x16x32_bf16 v[56:59], a[8:11], v[144:147], 0
    s_waitcnt vmcnt(0)
    v_cmp_gt_i32 vcc, s58, v4
    v_mfma_f32_16x16x32_bf16 v[60:63], a[12:15], v[144:147], 0
    s_waitcnt lgkmcnt(3)
    v_mfma_f32_16x16x32_bf16 v[48:51], a[16:19], v[148:151], v[48:51]
    s_cbranch_vccnz L_spin_gu1_pro
L_ret_gu1_pro:
    ds_read2st64_b64 v[156:159], v81 offset0:6 offset1:7
    s_add_u32 m0, s78, 17408
    v_mfma_f32_16x16x32_bf16 v[52:55], a[20:23], v[148:151], v[52:55]
    s_add_u32 s58, s58, 1
    buffer_load_dwordx4 v84, s[12:15], s66 offen offset:256 sc1 lds
    v_mfma_f32_16x16x32_bf16 v[56:59], a[24:27], v[148:151], v[56:59]
    buffer_load_dwordx4 v85, s[12:15], s66 offen offset:1280 sc1 lds
    v_mfma_f32_16x16x32_bf16 v[60:63], a[28:31], v[148:151], v[60:63]
    s_waitcnt lgkmcnt(3)
    v_mfma_f32_16x16x32_bf16 v[48:51], a[32:35], v[152:155], v[48:51]
    buffer_load_dwordx4 v86, s[12:15], s66 offen offset:2304 sc1 lds
    v_mfma_f32_16x16x32_bf16 v[52:55], a[36:39], v[152:155], v[52:55]
    ds_read2st64_b64 v[160:163], v80 offset0:9 offset1:10
    v_mfma_f32_16x16x32_bf16 v[56:59], a[40:43], v[152:155], v[56:59]
    buffer_load_dwordx4 v87, s[12:15], s66 offen offset:3328 sc1 lds
    v_mfma_f32_16x16x32_bf16 v[60:63], a[44:47], v[152:155], v[60:63]
    s_waitcnt lgkmcnt(1)
    s_lshr_b32 s67, s66, 4
    v_mfma_f32_16x16x32_bf16 v[48:51], a[48:51], v[156:159], v[48:51]
    buffer_load_dword v22, s[24:27], s67 offen sc1 lds
    v_mfma_f32_16x16x32_bf16 v[52:55], a[52:55], v[156:159], v[52:55]
    s_add_u32 s66, s66, 16384
    ds_read2st64_b64 v[164:167], v80 offset0:11 offset1:12
    s_and_b32 s66, s66, 0x1fffff
    v_mfma_f32_16x16x32_bf16 v[56:59], a[56:59], v[156:159], v[56:59]
    s_cmp_eq_u32 s58, 29
    s_cselect_b32 s66, s77, s66
    s_cmp_eq_u32 s58, 45
    s_cselect_b32 s66, 0x40000000, s66
    v_mfma_f32_16x16x32_bf16 v[60:63], a[60:63], v[156:159], v[60:63]
    s_waitcnt lgkmcnt(1)
    v_mfma_f32_16x16x32_bf16 v[48:51], a[64:67], v[160:163], v[48:51]
    ds_read2st64_b64 v[168:171], v80 offset0:13 offset1:14
    v_mfma_f32_16x16x32_bf16 v[52:55], a[68:71], v[160:163], v[52:55]
    v_mfma_f32_16x16x32_bf16 v[56:59], a[72:75], v[160:163], v[56:59]
    v_mfma_f32_16x16x32_bf16 v[60:63], a[76:79], v[160:163], v[60:63]
    s_waitcnt lgkmcnt(1)
    v_mfma_f32_16x16x32_bf16 v[48:51], a[80:83], v[164:167], v[48:51]
    ds_read2st64_b64 v[172:175], v80 offset0:15 offset1:16
    v_mfma_f32_16x16x32_bf16 v[52:55], a[84:87], v[164:167], v[52:55]
    v_mfma_f32_16x16x32_bf16 v[56:59], a[88:91], v[164:167], v[56:59]
    v_mfma_f32_16x16x32_bf16 v[60:63], a[92:95], v[164:167], v[60:63]
    s_waitcnt lgkmcnt(1)
    v_mfma_f32_16x16x32_bf16 v[48:51], a[96:99], v[168:171], v[48:51]
    ds_read2st64_b64 v[176:179], v81 offset0:17 offset1:18
    v_mfma_f32_16x16x32_bf16 v[52:55], a[100:103], v[168:171], v[52:55]
    v_mfma_f32_16x16x32_bf16 v[56:59], a[104:107], v[168:171], v[56:59]
    v_mfma_f32_16x16x32_bf16 v[60:63], a[108:111], v[168:171], v[60:63]
    s_waitcnt lgkmcnt(1)
    v_mfma_f32_16x16x32_bf16 v[48:51], a[112:115], v[172:175], v[48:51]
    ds_read2st64_b64 v[180:183], v81 offset0:19 offset1:20
    v_mfma_f32_16x16x32_bf16 v[52:55], a[116:119], v[172:175], v[52:55]
    v_mfma_f32_16x16x32_bf16 v[56:59], a[120:123], v[172:175], v[56:59]
    v_add_f32 v136, v136, v137
    v_add_f32 v138, v138, v139
    v_mfma_f32_16x16x32_bf16 v[60:63], a[124:127], v[172:175], v[60:63]
    s_waitcnt lgkmcnt(1)
    v_mfma_f32_16x16x32_bf16 v[48:51], a[128:131], v[176:179], v[48:51]
    ds_read2st64_b64 v[184:187], v81 offset0:21 offset1:22
    v_mfma_f32_16x16x32_bf16 v[52:55], a[132:135], v[176:179], v[52:55]
    v_permlane16_swap_b32 v136, v138
    v_mfma_f32_16x16x32_bf16 v[56:59], a[136:139], v[176:179], v[56:59]
    ds_read2st64_b64 v[188:191], v81 offset0:23 offset1:24
    v_add_f32 v137, v136, v138
    v_mfma_f32_16x16x32_bf16 v[60:63], a[140:143], v[176:179], v[60:63]
    s_waitcnt lgkmcnt(2)
    v_add_f32 v136, v136, v138
    v_mfma_f32_16x16x32_bf16 v[48:51], a[144:147], v[180:183], v[48:51]
    ds_read2st64_b64 v[192:195], v80 offset0:26 offset1:27
    v_mfma_f32_16x16x32_bf16 v[52:55], a[148:151], v[180:183], v[52:55]
    v_permlane32_swap_b32 v136, v137
    v_mfma_f32_16x16x32_bf16 v[56:59], a[152:155], v[180:183], v[56:59]
    ds_read2st64_b64 v[196:199], v80 offset0:28 offset1:29
    v_add_f32 v136, v136, v137
    v_mfma_f32_16x16x32_bf16 v[60:63], a[156:159], v[180:183], v[60:63]
    s_waitcnt lgkmcnt(3)
    v_mul_f32 v138, 0x3b000000, v136
    v_mul_f32 v26, 0x3b000000, v136
    v_mfma_f32_16x16x32_bf16 v[48:51], a[160:163], v[184:187], v[48:51]
    ds_read2st64_b64 v[200:203], v80 offset0:30 offset1:31
    v_mfma_f32_16x16x32_bf16 v[52:55], a[164:167], v[184:187], v[52:55]
    v_permlane16_swap_b32 v26, v138
    v_mfma_f32_16x16x32_bf16 v[56:59], a[168:171], v[184:187], v[56:59]
    ds_read2st64_b64 v[204:207], v80 offset0:32 offset1:33
    v_fma_f32 v138, -v26, v26, v138
    v_mfma_f32_16x16x32_bf16 v[60:63], a[172:175], v[184:187], v[60:63]
    s_waitcnt lgkmcnt(4)
    v_max_f32 v138, 0, v138
    v_add_f32 v138, 0x3727c5ac, v138
    v_mfma_f32_16x16x32_bf16 v[48:51], a[176:179], v[188:191], v[48:51]
    v_rcp_f32 v30, v138
    v_mfma_f32_16x16x32_bf16 v[52:55], a[180:183], v[188:191], v[52:55]
    v_mfma_f32_16x16x32_bf16 v[56:59], a[184:187], v[188:191], v[56:59]
    v_mfma_f32_16x16x32_bf16 v[60:63], a[188:191], v[188:191], v[60:63]
    s_waitcnt lgkmcnt(3)
    v_mfma_f32_16x16x32_bf16 v[48:51], a[192:195], v[192:195], v[48:51]
    v_mfma_f32_16x16x32_bf16 v[52:55], a[196:199], v[192:195], v[52:55]
    v_mfma_f32_16x16x32_bf16 v[56:59], a[200:203], v[192:195], v[56:59]
    v_mfma_f32_16x16x32_bf16 v[60:63], a[204:207], v[192:195], v[60:63]
    s_waitcnt lgkmcnt(2)
    v_mfma_f32_16x16x32_bf16 v[48:51], a[208:211], v[196:199], v[48:51]
    v_mfma_f32_16x16x32_bf16 v[52:55], a[212:215], v[196:199], v[52:55]
    v_mfma_f32_16x16x32_bf16 v[56:59], a[216:219], v[196:199], v[56:59]
    v_mfma_f32_16x16x32_bf16 v[60:63], a[220:223], v[196:199], v[60:63]
    s_waitcnt lgkmcnt(1)
    v_mfma_f32_16x16x32_bf16 v[48:51], a[224:227], v[200:203], v[48:51]
    buffer_load_dword v4, v5, s[4:7], s65 offen sc1
    v_mfma_f32_16x16x32_bf16 v[52:55], a[228:231], v[200:203], v[52:55]
    s_waitcnt vmcnt(1) lgkmcnt(0)
    s_barrier
    v_mfma_f32_16x16x32_bf16 v[56:59], a[232:235], v[200:203], v[56:59]
    ds_read2st64_b64 v[144:147], v81 offset0:34 offset1:35
    v_mfma_f32_16x16x32_bf16 v[60:63], a[236:239], v[200:203], v[60:63]
    v_mfma_f32_16x16x32_bf16 v[48:51], a[240:243], v[204:207], v[48:51]
    ds_read2st64_b64 v[148:151], v81 offset0:36 offset1:37
    v_mfma_f32_16x16x32_bf16 v[52:55], a[244:247], v[204:207], v[52:55]
    v_mfma_f32_16x16x32_bf16 v[56:59], a[248:251], v[204:207], v[56:59]
    ds_read2st64_b64 v[152:155], v81 offset0:38 offset1:39
    v_mfma_f32_16x16x32_bf16 v[60:63], a[252:255], v[204:207], v[60:63]
    s_mov_b32 s61, 16
    s_cmp_lg_u32 s74, 0
    s_cbranch_scc1 L_gu_loop_slow_in
    s_branch L_gu_loop_fast_in
.p2align 4
L_gu_loop_fast:
    s_waitcnt lgkmcnt(2)
    v_mfma_f32_16x16x32_bf16 v[48:51], a[0:3], v[144:147], 0
    ds_read2_b32 v[136:137], v24 offset0:0 offset1:32
    ds_read2_b32 v[138:139], v24 offset0:16 offset1:48
    v_mfma_f32_16x16x32_bf16 v[52:55], a[4:7], v[144:147], 0
    v_fma_f32 v112, -v27, v32, v64
    v_fma_f32 v113, -v27, v33, v65
    v_mfma_f32_16x16x32_bf16 v[56:59], a[8:11], v[144:147], 0
    v_fma_f32 v114, -v27, v34, v66
    v_fma_f32 v115, -v27, v35, v67
    v_mfma_f32_16x16x32_bf16 v[60:63], a[12:15], v[144:147], 0
    s_waitcnt lgkmcnt(3)
    v_fma_f32 v116, -v27, v36, v68
    v_fma_f32 v117, -v27, v37, v69
    v_mfma_f32_16x16x32_bf16 v[48:51], a[16:19], v[148:151], v[48:51]
    ds_read2st64_b64 v[156:159], v81 offset0:6 offset1:7
    v_fma_f32 v118, -v27, v38, v70
    v_mfma_f32_16x16x32_bf16 v[52:55], a[20:23], v[148:151], v[52:55]
    v_fma_f32 v119, -v27, v39, v71
    v_fma_f32 v120, -v27, v40, v72
    v_mfma_f32_16x16x32_bf16 v[56:59], a[24:27], v[148:151], v[56:59]
    v_max_f32 v112, 0, v112
    v_fma_f32 v121, -v27, v41, v73
    v_mfma_f32_16x16x32_bf16 v[60:63], a[28:31], v[148:151], v[60:63]
    s_waitcnt lgkmcnt(3)
    v_max_f32 v113, 0, v113
    v_fma_f32 v122, -v27, v42, v74
    v_mfma_f32_16x16x32_bf16 v[48:51], a[32:35], v[152:155], v[48:51]
    ds_read2st64_b64 v[160:163], v80 offset0:9 offset1:10
    v_max_f32 v114, 0, v114
    v_mfma_f32_16x16x32_bf16 v[52:55], a[36:39], v[152:155], v[52:55]
    s_waitcnt vmcnt(0)
    v_cmp_gt_i32 vcc, s58, v4
    v_fma_f32 v123, -v27, v43, v75
    v_mfma_f32_16x16x32_bf16 v[56:59], a[40:43], v[152:155], v[56:59]
    v_max_f32 v115, 0, v115
    v_fma_f32 v124, -v27, v44, v76
    v_mfma_f32_16x16x32_bf16 v[60:63], a[44:47], v[152:155], v[60:63]
    s_waitcnt lgkmcnt(1)
    v_max_f32 v116, 0, v116
    v_fma_f32 v125, -v27, v45, v77
    v_mfma_f32_16x16x32_bf16 v[48:51], a[48:51], v[156:159], v[48:51]
    s_cbranch_vccnz L_spin_gueven_fast
L_ret_gueven_fast:
    ds_read2st64_b64 v[164:167], v80 offset0:11 offset1:12
    v_max_f32 v117, 0, v117
    v_mfma_f32_16x16x32_bf16 v[52:55], a[52:55], v[156:159], v[52:55]
    s_add_u32 m0, s78, 17408
    v_fma_f32 v126, -v27, v46, v78
    v_max_f32 v118, 0, v118
    v_mfma_f32_16x16x32_bf16 v[56:59], a[56:59], v[156:159], v[56:59]
    s_add_u32 s58, s58, 1
    buffer_load_dwordx4 v84, s[12:15], s66 offen offset:256 sc1 lds
    v_mfma_f32_16x16x32_bf16 v[60:63], a[60:63], v[156:159], v[60:63]
    s_waitcnt lgkmcnt(1)
    buffer_load_dwordx4 v85, s[12:15], s66 offen offset:1280 sc1 lds
    v_mfma_f32_16x16x32_bf16 v[48:51], a[64:67], v[160:163], v[48:51]
    ds_read2st64_b64 v[168:171], v80 offset0:13 offset1:14
    v_fma_f32 v127, -v27, v47, v79
    v_mfma_f32_16x16x32_bf16 v[52:55], a[68:71], v[160:163], v[52:55]
    v_max_f32 v119, 0, v119
    v_mul_f32 v120, v120, v31
    v_mfma_f32_16x16x32_bf16 v[56:59], a[72:75], v[160:163], v[56:59]
    v_mul_f32 v121, v121, v31
    v_mul_f32 v122, v122, v31
    v_mfma_f32_16x16x32_bf16 v[60:63], a[76:79], v[160:163], v[60:63]
    s_waitcnt lgkmcnt(1)
    buffer_load_dwordx4 v86, s[12:15], s66 offen offset:2304 sc1 lds
    v_mfma_f32_16x16x32_bf16 v[48:51], a[80:83], v[164:167], v[48:51]
    ds_read2st64_b64 v[172:175], v80 offset0:15 offset1:16
    v_mul_f32 v123, v123, v31
    v_mfma_f32_16x16x32_bf16 v[52:55], a[84:87], v[164:167], v[52:55]
    v_mul_f32 v124, v124, v31
    v_mul_f32 v125, v125, v31
    v_mfma_f32_16x16x32_bf16 v[56:59], a[88:91], v[164:167], v[56:59]
    v_mul_f32 v126, v126, v31
    v_mul_f32 v127, v127, v31
    v_mfma_f32_16x16x32_bf16 v[60:63], a[92:95], v[164:167], v[60:63]
    s_waitcnt lgkmcnt(1)
    buffer_load_dwordx4 v87, s[12:15], s66 offen offset:3328 sc1 lds
    v_mfma_f32_16x16x32_bf16 v[48:51], a[96:99], v[168:171], v[48:51]
    s_lshr_b32 s67, s66, 4
    ds_read2st64_b64 v[176:179], v81 offset0:17 offset1:18
    v_mul_f32 v112, v112, v120
    v_mfma_f32_16x16x32_bf16 v[52:55], a[100:103], v[168:171], v[52:55]
    v_mul_f32 v113, v113, v121
    v_mul_f32 v114, v114, v122
    v_mfma_f32_16x16x32_bf16 v[56:59], a[104:107], v[168:171], v[56:59]
    v_mul_f32 v115, v115, v123
    v_mul_f32 v116, v116, v124
    v_mfma_f32_16x16x32_bf16 v[60:63], a[108:111], v[168:171], v[60:63]
    s_waitcnt lgkmcnt(1)
    buffer_load_dword v22, s[24:27], s67 offen sc1 lds
    v_mfma_f32_16x16x32_bf16 v[48:51], a[112:115], v[172:175], v[48:51]
    s_add_u32 s66, s66, 16384
    ds_read2st64_b64 v[180:183], v81 offset0:19 offset1:20
    v_mul_f32 v117, v117, v125
    v_mfma_f32_16x16x32_bf16 v[52:55], a[116:119], v[172:175], v[52:55]
    s_and_b32 s66, s66, 0x1fffff
    v_mul_f32 v118, v118, v126
    v_mul_f32 v119, v119, v127
    v_mfma_f32_16x16x32_bf16 v[56:59], a[120:123], v[172:175], v[56:59]
    s_cmp_eq_u32 s58, 29
    s_cselect_b32 s66, s77, s66
    v_cvt_pk_bf16_f32 v128, v112, v113
    v_cvt_pk_bf16_f32 v129, v114, v115
    v_mfma_f32_16x16x32_bf16 v[60:63], a[124:127], v[172:175], v[60:63]
    s_waitcnt lgkmcnt(1)
    v_cvt_pk_bf16_f32 v130, v116, v117
    v_cvt_pk_bf16_f32 v131, v118, v119
    v_mfma_f32_16x16x32_bf16 v[48:51], a[128:131], v[176:179], v[48:51]
    s_cmp_eq_u32 s58, 45
    s_cselect_b32 s66, 0x40000000, s66
    buffer_store_dwordx4 v[128:131], v28, s[4:7], s60 offen
    v_mfma_f32_16x16x32_bf16 v[52:55], a[132:135], v[176:179], v[52:55]
    s_add_u32 s60, s60, 65536
    ds_read2st64_b64 v[184:187], v81 offset0:21 offset1:22
    v_add_u32 v7, 1, v7
    v_mfma_f32_16x16x32_bf16 v[56:59], a[136:139], v[176:179], v[56:59]
    s_andn2_b32 s60, s60, 262144
    ds_read2st64_b64 v[188:191], v81 offset0:23 offset1:24
    v_mfma_f32_16x16x32_bf16 v[60:63], a[140:143], v[176:179], v[60:63]
    s_waitcnt lgkmcnt(2)
    v_add_f32 v136, v136, v137
    v_mfma_f32_16x16x32_bf16 v[48:51], a[144:147], v[180:183], v[48:51]
    ds_read2st64_b64 v[192:195], v80 offset0:26 offset1:27
    v_add_f32 v138, v138, v139
    v_mfma_f32_16x16x32_bf16 v[52:55], a[148:151], v[180:183], v[52:55]
    v_mfma_f32_16x16x32_bf16 v[56:59], a[152:155], v[180:183], v[56:59]
    ds_read2st64_b64 v[196:199], v80 offset0:28 offset1:29
    v_mfma_f32_16x16x32_bf16 v[60:63], a[156:159], v[180:183], v[60:63]
    s_waitcnt lgkmcnt(3)
    v_permlane16_swap_b32 v136, v138
    v_mfma_f32_16x16x32_bf16 v[48:51], a[160:163], v[184:187], v[48:51]
    ds_read2st64_b64 v[200:203], v80 offset0:30 offset1:31
    v_add_f32 v137, v136, v138
    v_mfma_f32_16x16x32_bf16 v[52:55], a[164:167], v[184:187], v[52:55]
    v_add_f32 v136, v136, v138
    v_mfma_f32_16x16x32_bf16 v[56:59], a[168:171], v[184:187], v[56:59]
    ds_read2st64_b64 v[204:207], v80 offset0:32 offset1:33
    v_mfma_f32_16x16x32_bf16 v[60:63], a[172:175], v[184:187], v[60:63]
    s_waitcnt lgkmcnt(4)
    v_permlane32_swap_b32 v136, v137
    v_mfma_f32_16x16x32_bf16 v[48:51], a[176:179], v[188:191], v[48:51]
    v_add_u32 v248, 1, v248
    v_add_f32 v136, v136, v137
    v_mfma_f32_16x16x32_bf16 v[52:55], a[180:183], v[188:191], v[52:55]
    v_mul_f32 v138, 0x3b000000, v136
    v_mul_f32 v26, 0x3b000000, v136
    v_mfma_f32_16x16x32_bf16 v[56:59], a[184:187], v[188:191], v[56:59]
    v_mfma_f32_16x16x32_bf16 v[60:63], a[188:191], v[188:191], v[60:63]
    s_waitcnt lgkmcnt(3)
    v_permlane16_swap_b32 v26, v138
    v_mfma_f32_16x16x32_bf16 v[48:51], a[192:195], v[192:195], v[48:51]
    s_waitcnt vmcnt(1) lgkmcnt(0)
    ds_write_b32 v246, v248
    v_mfma_f32_16x16x32_bf16 v[52:55], a[196:199], v[192:195], v[52:55]
    v_fma_f32 v138, -v26, v26, v138
    v_max_f32 v138, 0, v138
    v_mfma_f32_16x16x32_bf16 v[56:59], a[200:203], v[192:195], v[56:59]
    v_add_f32 v138, 0x3727c5ac, v138
    v_mfma_f32_16x16x32_bf16 v[60:63], a[204:207], v[192:195], v[60:63]
    v_rcp_f32 v30, v138
    v_mfma_f32_16x16x32_bf16 v[48:51], a[208:211], v[196:199], v[48:51]
    ds_read_b32 v249, v247
    v_mfma_f32_16x16x32_bf16 v[52:55], a[212:215], v[196:199], v[52:55]
    v_mfma_f32_16x16x32_bf16 v[56:59], a[216:219], v[196:199], v[56:59]
    s_waitcnt vmcnt(0)
    buffer_store_dword v7, v6, s[4:7], s65 offen
    v_mfma_f32_16x16x32_bf16 v[60:63], a[220:223], v[196:199], v[60:63]
    v_mfma_f32_16x16x32_bf16 v[48:51], a[224:227], v[200:203], v[48:51]
    s_waitcnt lgkmcnt(0)
    buffer_load_dword v4, v5, s[4:7], s65 offen sc1
    v_mfma_f32_16x16x32_bf16 v[52:55], a[228:231], v[200:203], v[52:55]
    v_cmp_gt_i32 vcc, v248, v249
    v_mfma_f32_16x16x32_bf16 v[56:59], a[232:235], v[200:203], v[56:59]
    v_mfma_f32_16x16x32_bf16 v[60:63], a[236:239], v[200:203], v[60:63]
    s_cbranch_vccnz L_meet_gu_even_fast
L_ret_meet_gu_even_fast:
    ds_read2st64_b64 v[144:147], v81 offset0:34 offset1:35
    v_mfma_f32_16x16x32_bf16 v[48:51], a[240:243], v[204:207], v[48:51]
    v_mfma_f32_16x16x32_bf16 v[52:55], a[244:247], v[204:207], v[52:55]
    ds_read2st64_b64 v[148:151], v81 offset0:36 offset1:37
    v_mfma_f32_16x16x32_bf16 v[56:59], a[248:251], v[204:207], v[56:59]
    v_mfma_f32_16x16x32_bf16 v[60:63], a[252:255], v[204:207], v[60:63]
    ds_read2st64_b64 v[152:155], v81 offset0:38 offset1:39
L_gu_loop_fast_in:
    s_waitcnt lgkmcnt(2)
    v_mfma_f32_16x16x32_bf16 v[64:67], a[0:3], v[144:147], 0
    ds_read2_b32 v[136:137], v25 offset0:0 offset1:32
    ds_read2_b32 v[138:139], v25 offset0:16 offset1:48
    v_mfma_f32_16x16x32_bf16 v[68:71], a[4:7], v[144:147], 0
    v_fma_f32 v112, -v26, v32, v48
    v_fma_f32 v113, -v26, v33, v49
    v_mfma_f32_16x16x32_bf16 v[72:75], a[8:11], v[144:147], 0
    v_fma_f32 v114, -v26, v34, v50
    v_fma_f32 v115, -v26, v35, v51
    v_mfma_f32_16x16x32_bf16 v[76:79], a[12:15], v[144:147], 0
    s_waitcnt lgkmcnt(3)
    v_fma_f32 v116, -v26, v36, v52
    v_fma_f32 v117, -v26, v37, v53
    v_mfma_f32_16x16x32_bf16 v[64:67], a[16:19], v[148:151], v[64:67]
    ds_read2st64_b64 v[156:159], v81 offset0:40 offset1:41
    v_fma_f32 v118, -v26, v38, v54
    v_mfma_f32_16x16x32_bf16 v[68:71], a[20:23], v[148:151], v[68:71]
    v_fma_f32 v119, -v26, v39, v55
    v_fma_f32 v120, -v26, v40, v56
    v_mfma_f32_16x16x32_bf16 v[72:75], a[24:27], v[148:151], v[72:75]
    v_max_f32 v112, 0, v112
    v_fma_f32 v121, -v26, v41, v57
    v_mfma_f32_16x16x32_bf16 v[76:79], a[28:31], v[148:151], v[76:79]
    s_waitcnt lgkmcnt(3)
    v_max_f32 v113, 0, v113
    v_fma_f32 v122, -v26, v42, v58
    v_mfma_f32_16x16x32_bf16 v[64:67], a[32:35], v[152:155], v[64:67]
    ds_read2st64_b64 v[160:163], v80 offset0:43 offset1:44
    v_max_f32 v114, 0, v114
    v_mfma_f32_16x16x32_bf16 v[68:71], a[36:39], v[152:155], v[68:71]
    s_waitcnt vmcnt(0)
    v_cmp_gt_i32 vcc, s58, v4
    v_fma_f32 v123, -v26, v43, v59
    v_mfma_f32_16x16x32_bf16 v[72:75], a[40:43], v[152:155], v[72:75]
    v_max_f32 v115, 0, v115
    v_fma_f32 v124, -v26, v44, v60
    v_mfma_f32_16x16x32_bf16 v[76:79], a[44:47], v[152:155], v[76:79]
    s_waitcnt lgkmcnt(1)
    v_max_f32 v116, 0, v116
    v_fma_f32 v125, -v26, v45, v61
    v_mfma_f32_16x16x32_bf16 v[64:67], a[48:51], v[156:159], v[64:67]
    s_cbranch_vccnz L_spin_guodd_fast
L_ret_guodd_fast:
    ds_read2st64_b64 v[164:167], v80 offset0:45 offset1:46
    v_max_f32 v117, 0, v117
    v_mfma_f32_16x16x32_bf16 v[68:71], a[52:55], v[156:159], v[68:71]
    s_add_u32 m0, s78, 0
    v_fma_f32 v126, -v26, v46, v62
    v_max_f32 v118, 0, v118
    v_mfma_f32_16x16x32_bf16 v[72:75], a[56:59], v[156:159], v[72:75]
    s_add_u32 s58, s58, 1
    buffer_load_dwordx4 v84, s[12:15], s66 offen offset:256 sc1 lds
    v_mfma_f32_16x16x32_bf16 v[76:79], a[60:63], v[156:159], v[76:79]
    s_waitcnt lgkmcnt(1)
    buffer_load_dwordx4 v85, s[12:15], s66 offen offset:1280 sc1 lds
    v_mfma_f32_16x16x32_bf16 v[64:67], a[64:67], v[160:163], v[64:67]
    ds_read2st64_b64 v[168:171], v80 offset0:47 offset1:48
    v_fma_f32 v127, -v26, v47, v63
    v_mfma_f32_16x16x32_bf16 v[68:71], a[68:71], v[160:163], v[68:71]
    v_max_f32 v119, 0, v119
    v_mul_f32 v120, v120, v30
    v_mfma_f32_16x16x32_bf16 v[72:75], a[72:75], v[160:163], v[72:75]
    v_mul_f32 v121, v121, v30
    v_mul_f32 v122, v122, v30
    v_mfma_f32_16x16x32_bf16 v[76:79], a[76:79], v[160:163], v[76:79]
    s_waitcnt lgkmcnt(1)
    buffer_load_dwordx4 v86, s[12:15], s66 offen offset:2304 sc1 lds
    v_mfma_f32_16x16x32_bf16 v[64:67], a[80:83], v[164:167], v[64:67]
    ds_read2st64_b64 v[172:175], v80 offset0:49 offset1:50
    v_mul_f32 v123, v123, v30
    v_mfma_f32_16x16x32_bf16 v[68:71], a[84:87], v[164:167], v[68:71]
    v_mul_f32 v124, v124, v30
    v_mul_f32 v125, v125, v30
    v_mfma_f32_16x16x32_bf16 v[72:75], a[88:91], v[164:167], v[72:75]
    v_mul_f32 v126, v126, v30
    v_mul_f32 v127, v127, v30
    v_mfma_f32_16x16x32_bf16 v[76:79], a[92:95], v[164:167], v[76:79]
    s_waitcnt lgkmcnt(1)
    buffer_load_dwordx4 v87, s[12:15], s66 offen offset:3328 sc1 lds
    v_mfma_f32_16x16x32_bf16 v[64:67], a[96:99], v[168:171], v[64:67]
    s_lshr_b32 s67, s66, 4
    ds_read2st64_b64 v[176:179], v81 offset0:51 offset1:52
    v_mul_f32 v112, v112, v120
    v_mfma_f32_16x16x32_bf16 v[68:71], a[100:103], v[168:171], v[68:71]
    v_mul_f32 v113, v113, v121
    v_mul_f32 v114, v114, v122
    v_mfma_f32_16x16x32_bf16 v[72:75], a[104:107], v[168:171], v[72:75]
    v_mul_f32 v115, v115, v123
    v_mul_f32 v116, v116, v124
    v_mfma_f32_16x16x32_bf16 v[76:79], a[108:111], v[168:171], v[76:79]
    s_waitcnt lgkmcnt(1)
    buffer_load_dword v22, s[24:27], s67 offen sc1 lds
    v_mfma_f32_16x16x32_bf16 v[64:67], a[112:115], v[172:175], v[64:67]
    s_add_u32 s66, s66, 16384
    ds_read2st64_b64 v[180:183], v81 offset0:53 offset1:54
    v_mul_f32 v117, v117, v125
    v_mfma_f32_16x16x32_bf16 v[68:71], a[116:119], v[172:175], v[68:71]
    s_and_b32 s66, s66, 0x1fffff
    v_mul_f32 v118, v118, v126
    v_mul_f32 v119, v119, v127
    v_mfma_f32_16x16x32_bf16 v[72:75], a[120:123], v[172:175], v[72:75]
    v_cvt_pk_bf16_f32 v128, v112, v113
    v_cvt_pk_bf16_f32 v129, v114, v115
    v_mfma_f32_16x16x32_bf16 v[76:79], a[124:127], v[172:175], v[76:79]
    s_waitcnt lgkmcnt(1)
    v_cvt_pk_bf16_f32 v130, v116, v117
    v_cvt_pk_bf16_f32 v131, v118, v119
    v_mfma_f32_16x16x32_bf16 v[64:67], a[128:131], v[176:179], v[64:67]
    buffer_store_dwordx4 v[128:131], v28, s[4:7], s60 offen
    v_mfma_f32_16x16x32_bf16 v[68:71], a[132:135], v[176:179], v[68:71]
    s_add_u32 s60, s60, 65536
    ds_read2st64_b64 v[184:187], v81 offset0:55 offset1:56
    v_add_u32 v7, 1, v7
    v_mfma_f32_16x16x32_bf16 v[72:75], a[136:139], v[176:179], v[72:75]
    s_andn2_b32 s60, s60, 262144
    ds_read2st64_b64 v[188:191], v81 offset0:57 offset1:58
    v_add_f32 v136, v136, v137
    v_mfma_f32_16x16x32_bf16 v[76:79], a[140:143], v[176:179], v[76:79]
    s_waitcnt lgkmcnt(2)
    v_add_f32 v138, v138, v139
    v_mfma_f32_16x16x32_bf16 v[64:67], a[144:147], v[180:183], v[64:67]
    ds_read2st64_b64 v[192:195], v80 offset0:60 offset1:61
    v_mfma_f32_16x16x32_bf16 v[68:71], a[148:151], v[180:183], v[68:71]
    v_permlane16_swap_b32 v136, v138
    v_mfma_f32_16x16x32_bf16 v[72:75], a[152:155], v[180:183], v[72:75]
    ds_read2st64_b64 v[196:199], v80 offset0:62 offset1:63
    v_add_f32 v137, v136, v138
    v_mfma_f32_16x16x32_bf16 v[76:79], a[156:159], v[180:183], v[76:79]
    s_waitcnt lgkmcnt(3)
    v_add_f32 v136, v136, v138
    v_mfma_f32_16x16x32_bf16 v[64:67], a[160:163], v[184:187], v[64:67]
    ds_read2st64_b64 v[200:203], v80 offset0:64 offset1:65
    v_mfma_f32_16x16x32_bf16 v[68:71], a[164:167], v[184:187], v[68:71]
    v_permlane32_swap_b32 v136, v137
    v_mfma_f32_16x16x32_bf16 v[72:75], a[168:171], v[184:187], v[72:75]
    ds_read2st64_b64 v[204:207], v80 offset0:66 offset1:67
    v_add_f32 v136, v136, v137
    v_mfma_f32_16x16x32_bf16 v[76:79], a[172:175], v[184:187], v[76:79]
    s_waitcnt lgkmcnt(4)
    v_mul_f32 v138, 0x3b000000, v136
    v_mul_f32 v27, 0x3b000000, v136
    v_mfma_f32_16x16x32_bf16 v[64:67], a[176:179], v[188:191], v[64:67]
    v_add_u32 v248, 1, v248
    v_mfma_f32_16x16x32_bf16 v[68:71], a[180:183], v[188:191], v[68:71]
    v_permlane16_swap_b32 v27, v138
    v_mfma_f32_16x16x32_bf16 v[72:75], a[184:187], v[188:191], v[72:75]
    v_fma_f32 v138, -v27, v27, v138
    v_max_f32 v138, 0, v138
    v_mfma_f32_16x16x32_bf16 v[76:79], a[188:191], v[188:191], v[76:79]
    s_waitcnt lgkmcnt(3)
    v_add_f32 v138, 0x3727c5ac, v138
    v_mfma_f32_16x16x32_bf16 v[64:67], a[192:195], v[192:195], v[64:67]
    s_waitcnt vmcnt(1) lgkmcnt(0)
    ds_write_b32 v246, v248
    v_mfma_f32_16x16x32_bf16 v[68:71], a[196:199], v[192:195], v[68:71]
    v_rcp_f32 v31, v138
    v_mfma_f32_16x16x32_bf16 v[72:75], a[200:203], v[192:195], v[72:75]
    v_mfma_f32_16x16x32_bf16 v[76:79], a[204:207], v[192:195], v[76:79]
    v_mfma_f32_16x16x32_bf16 v[64:67], a[208:211], v[196:199], v[64:67]
    ds_read_b32 v249, v247
    v_mfma_f32_16x16x32_bf16 v[68:71], a[212:215], v[196:199], v[68:71]
    v_mfma_f32_16x16x32_bf16 v[72:75], a[216:219], v[196:199], v[72:75]
    s_waitcnt vmcnt(0)
    buffer_store_dword v7, v6, s[4:7], s65 offen
    v_mfma_f32_16x16x32_bf16 v[76:79], a[220:223], v[196:199], v[76:79]
    v_mfma_f32_16x16x32_bf16 v[64:67], a[224:227], v[200:203], v[64:67]
    s_waitcnt lgkmcnt(0)
    buffer_load_dword v4, v5, s[4:7], s65 offen sc1
    v_mfma_f32_16x16x32_bf16 v[68:71], a[228:231], v[200:203], v[68:71]
    v_cmp_gt_i32 vcc, v248, v249
    v_mfma_f32_16x16x32_bf16 v[72:75], a[232:235], v[200:203], v[72:75]
    v_mfma_f32_16x16x32_bf16 v[76:79], a[236:239], v[200:203], v[76:79]
    s_cbranch_vccnz L_meet_gu_odd_fast
L_ret_meet_gu_odd_fast:
    ds_read2st64_b64 v[144:147], v81 offset0:0 offset1:1
    v_mfma_f32_16x16x32_bf16 v[64:67], a[240:243], v[204:207], v[64:67]
    v_mfma_f32_16x16x32_bf16 v[68:71], a[244:247], v[204:207], v[68:71]
    s_sub_u32 s61, s61, 1
    ds_read2st64_b64 v[148:151], v81 offset0:2 offset1:3
    v_mfma_f32_16x16x32_bf16 v[72:75], a[248:251], v[204:207], v[72:75]
    s_cmp_lg_u32 s61, 0
    v_mfma_f32_16x16x32_bf16 v[76:79], a[252:255], v[204:207], v[76:79]
    ds_read2st64_b64 v[152:155], v81 offset0:4 offset1:5
    s_cbranch_scc1 L_gu_loop_fast
    v_fma_f32 v112, -v27, v32, v64
    v_fma_f32 v113, -v27, v33, v65
    v_fma_f32 v114, -v27, v34, v66
    v_fma_f32 v115, -v27, v35, v67
    v_fma_f32 v116, -v27, v36, v68
    v_fma_f32 v117, -v27, v37, v69
    v_fma_f32 v118, -v27, v38, v70
    v_fma_f32 v119, -v27, v39, v71
    v_fma_f32 v120, -v27, v40, v72
    v_max_f32 v112, 0, v112
    v_fma_f32 v121, -v27, v41, v73
    v_max_f32 v113, 0, v113
    v_fma_f32 v122, -v27, v42, v74
    v_max_f32 v114, 0, v114
    v_fma_f32 v123, -v27, v43, v75
    v_max_f32 v115, 0, v115
    v_fma_f32 v124, -v27, v44, v76
    v_max_f32 v116, 0, v116
    v_fma_f32 v125, -v27, v45, v77
    v_max_f32 v117, 0, v117
    v_fma_f32 v126, -v27, v46, v78
    v_max_f32 v118, 0, v118
    v_fma_f32 v127, -v27, v47, v79
    v_max_f32 v119, 0, v119
    v_mul_f32 v120, v120, v31
    v_mul_f32 v121, v121, v31
    v_mul_f32 v122, v122, v31
    v_mul_f32 v123, v123, v31
    v_mul_f32 v124, v124, v31
    v_mul_f32 v125, v125, v31
    v_mul_f32 v126, v126, v31
    v_mul_f32 v127, v127, v31
    v_mul_f32 v112, v112, v120
    v_mul_f32 v113, v113, v121
    v_mul_f32 v114, v114, v122
    v_mul_f32 v115, v115, v123
    v_mul_f32 v116, v116, v124
    v_mul_f32 v117, v117, v125
    v_mul_f32 v118, v118, v126
    v_mul_f32 v119, v119, v127
    v_cvt_pk_bf16_f32 v128, v112, v113
    v_cvt_pk_bf16_f32 v129, v114, v115
    v_cvt_pk_bf16_f32 v130, v116, v117
    v_cvt_pk_bf16_f32 v131, v118, v119
    s_waitcnt vmcnt(0)
    v_cmp_gt_i32 vcc, s58, v4
    s_cbranch_vccnz L_spin_gudr_fast
L_ret_gudr_fast:
    buffer_store_dwordx4 v[128:131], v28, s[4:7], s60 offen
    v_mov_b32 v7, 64
    s_waitcnt vmcnt(0)
    buffer_store_dword v7, v6, s[4:7], s65 offen
    s_endpgm
L_dn:
    s_sub_u32 s57, s33, 24
    s_or_b32 s64, s57, s34
    s_cmp_eq_u32 s64, 0
    s_cselect_b32 s64, 0, 0x80000000
    v_add_u32 v8, s64, v3
    v_mov_b32 v9, 0x7fffffff
    v_cmp_eq_u32 vcc, 56, v0
    s_nop 1
    v_cndmask_b32 v152, v7, v9, vcc
    v_lshrrev_b32 v9, 1, v0
    v_cmp_eq_u32 vcc, 4, v9
    v_mov_b32 v9, 10
    s_nop 0
    v_cndmask_b32 v152, v152, v9, vcc
    v_mov_b32 v153, v152
    v_mov_b32 v154, v152
    v_mov_b32 v155, v152
    buffer_store_dwordx4 v[152:155], v8, s[4:7], s65 offen sc1
    buffer_store_dwordx4 v[152:155], v8, s[4:7], s65 offen offset:1024 sc1
    s_mov_b32 s8, s48
    s_mov_b32 s9, s49
    s_mov_b32 s10, 1835008
    s_mov_b32 s11, 0x20000
    s_mov_b32 s12, s36
    s_mov_b32 s13, s37
    s_mov_b32 s14, 2097152
    s_mov_b32 s15, 0x20000
    s_lshl_b32 s63, s34, 12
    v_add_u32 v24, s63, v3
    s_lshl_b32 s66, s3, 4
    s_add_u32 s66, s66, s57
    s_add_u32 s66, s66, 127
    s_lshl_b32 s67, s66, 10
    s_lshl_b32 s66, s66, 14
    s_and_b32 s63, s66, 0x1fffff
    buffer_load_dwordx4 v[168:171], v24, s[12:15], s63 offen offset:0
    buffer_load_dwordx4 v[172:175], v24, s[12:15], s63 offen offset:1024
    buffer_load_dwordx4 v[176:179], v24, s[12:15], s63 offen offset:2048
    buffer_load_dwordx4 v[180:183], v24, s[12:15], s63 offen offset:3072
    s_add_u32 s66, s66, 131072
    v_lshrrev_b32 v8, 1, v0
    v_lshl_add_u32 v250, v8, 13, s67
    v_and_b32 v250, 0x1ffff, v250
    v_and_b32 v8, 1, v0
    v_lshl_add_u32 v250, v8, 7, v250
    s_mul_i32 s68, s3, 0x20000
    s_add_u32 s68, s68, 0x2300000
    s_lshl_b32 s63, s34, 8
    s_add_u32 s63, s63, s68
    v_add_u32 v250, s63, v250
    v_mov_b32 v9, 0x80000000
    v_cmp_gt_u32 vcc, 6, v0
    s_nop 1
    v_cndmask_b32 v250, v9, v250, vcc
    buffer_load_dword v252, v250, s[4:7], 0 offen sc1
    s_lshl_b32 s63, s3, 2
    s_add_u32 s63, s63, s64
    v_mov_b32 v8, s63
    v_mov_b32 v9, 0x80000000
    v_cmp_eq_u32 vcc, 0, v0
    s_nop 1
    v_cndmask_b32 v8, v9, v8, vcc
    v_mov_b32 v9, s35
    s_waitcnt vmcnt(5)
    buffer_store_dword v9, v8, s[20:23], 0 offen sc1
    s_lshr_b32 s63, s48, 7
    s_sub_u32 s63, 3, s63
    s_and_b32 s63, s63, 7
    s_cmp_eq_u32 s57, s63
    s_cselect_b32 s78, 1, 0
    s_cmp_gt_u32 s57, s63
    s_subb_u32 s76, s57, 0
    s_lshl_b32 s76, s76, 2
    s_add_u32 s76, s76, s34
    s_lshl_b32 s76, s76, 3
    s_add_u32 s76, s76, s3
    v_lshrrev_b32 v8, 3, v0
    v_lshlrev_b32 v16, 10, v8
    v_and_b32 v8, 2, v8
    v_lshlrev_b32 v8, 1, v8
    v_and_b32 v9, 7, v0
    v_xor_b32 v8, v8, v9
    v_lshl_add_u32 v16, v8, 4, v16
    s_lshl_b32 s63, s57, 7
    v_add_u32 v16, s63, v16
    v_add_u32 v17, 7168, v16
    v_add_u32 v18, 14336, v16
    v_add_u32 v19, 21504, v16
    s_lshl_b32 s62, s34, 14
    s_add_u32 s62, s62, 49152
    s_mul_i32 s70, s34, 458752
    v_lshrrev_b32 v8, 3, v0
    v_and_b32 v9, 7, v0
    v_lshlrev_b32 v34, 7, v8
    v_lshl_add_u32 v34, v9, 4, v34
    s_lshl_b32 s63, s34, 5
    v_add_u32 v34, s63, v34
    v_cmp_gt_u32 vcc, 2, v9
    v_mov_b32 v8, 0x80000000
    s_nop 0
    v_cndmask_b32 v34, v8, v34, vcc
    v_and_b32 v8, 1, v0
    v_cmp_eq_u32 s[28:29], 1, v8
    s_lshl_b32 s64, s57, 2
    s_add_u32 s64, s64, s34
    s_lshl_b32 s63, s64, 2
    s_add_u32 s63, s63, 512
    v_mov_b32 v6, s63
    v_mov_b32 v9, 0x80000000
    v_cmp_eq_u32 vcc, 0, v0
    s_nop 1
    v_cndmask_b32 v6, v9, v6, vcc
    s_waitcnt vmcnt(2)
    s_lshl_b32 s63, s3, 2
    v_mov_b32 v8, s63
    buffer_load_dword v4, v8, s[20:23], 0 offen sc1
    v_dot2_f32_bf16 v152, v168, v12, 0
    v_dot2_f32_bf16 v153, v168, v168, 0
    v_dot2_f32_bf16 v152, v169, v12, v152
    v_dot2_f32_bf16 v153, v169, v169, v153
    v_dot2_f32_bf16 v152, v170, v12, v152
    v_dot2_f32_bf16 v153, v170, v170, v153
    v_dot2_f32_bf16 v152, v171, v12, v152
    v_dot2_f32_bf16 v153, v171, v171, v153
    v_dot2_f32_bf16 v154, v172, v12, 0
    v_dot2_f32_bf16 v155, v172, v172, 0
    v_dot2_f32_bf16 v154, v173, v12, v154
    v_dot2_f32_bf16 v155, v173, v173, v155
    v_dot2_f32_bf16 v154, v174, v12, v154
    v_dot2_f32_bf16 v155, v174, v174, v155
    v_dot2_f32_bf16 v154, v175, v12, v154
    v_dot2_f32_bf16 v155, v175, v175, v155
    v_dot2_f32_bf16 v156, v176, v12, 0
    v_dot2_f32_bf16 v157, v176, v176, 0
    v_dot2_f32_bf16 v156, v177, v12, v156
    v_dot2_f32_bf16 v157, v177, v177, v157
    v_dot2_f32_bf16 v156, v178, v12, v156
    v_dot2_f32_bf16 v157, v178, v178, v157
    v_dot2_f32_bf16 v156, v179, v12, v156
    v_dot2_f32_bf16 v157, v179, v179, v157
    v_dot2_f32_bf16 v158, v180, v12, 0
    v_dot2_f32_bf16 v159, v180, v180, 0
    v_dot2_f32_bf16 v158, v181, v12, v158
    v_dot2_f32_bf16 v159, v181, v181, v159
    v_dot2_f32_bf16 v158, v182, v12, v158
    v_dot2_f32_bf16 v159, v182, v182, v159
    v_dot2_f32_bf16 v158, v183, v12, v158
    v_dot2_f32_bf16 v159, v183, v183, v159
    v_add_f32_dpp v152, v152, v152 quad_perm:[1,0,3,2] row_mask:0xf bank_mask:0xf
    v_add_f32_dpp v153, v153, v153 quad_perm:[1,0,3,2] row_mask:0xf bank_mask:0xf
    v_add_f32_dpp v154, v154, v154 quad_perm:[1,0,3,2] row_mask:0xf bank_mask:0xf
    v_add_f32_dpp v155, v155, v155 quad_perm:[1,0,3,2] row_mask:0xf bank_mask:0xf
    v_add_f32_dpp v156, v156, v156 quad_perm:[1,0,3,2] row_mask:0xf bank_mask:0xf
    v_add_f32_dpp v157, v157, v157 quad_perm:[1,0,3,2] row_mask:0xf bank_mask:0xf
    v_add_f32_dpp v158, v158, v158 quad_perm:[1,0,3,2] row_mask:0xf bank_mask:0xf
    v_add_f32_dpp v159, v159, v159 quad_perm:[1,0,3,2] row_mask:0xf bank_mask:0xf
    v_cndmask_b32 v152, v152, v156, s[28:29]
    v_cndmask_b32 v153, v153, v157, s[28:29]
    v_cndmask_b32 v154, v154, v158, s[28:29]
    v_cndmask_b32 v155, v155, v159, s[28:29]
    v_add_f32_dpp v152, v152, v152 quad_perm:[2,3,0,1] row_mask:0xf bank_mask:0xf
    v_add_f32_dpp v153, v153, v153 quad_perm:[2,3,0,1] row_mask:0xf bank_mask:0xf
    v_add_f32_dpp v154, v154, v154 quad_perm:[2,3,0,1] row_mask:0xf bank_mask:0xf
    v_add_f32_dpp v155, v155, v155 quad_perm:[2,3,0,1] row_mask:0xf bank_mask:0xf
    v_add_f32_dpp v168, v152, v152 row_shl:4 row_mask:0xf bank_mask:0xf
    v_add_f32_dpp v169, v153, v153 row_shl:4 row_mask:0xf bank_mask:0xf
    v_add_f32_dpp v170, v154, v154 row_shl:4 row_mask:0xf bank_mask:0xf
    v_add_f32_dpp v171, v155, v155 row_shl:4 row_mask:0xf bank_mask:0xf
    s_waitcnt vmcnt(0)
    v_cmp_eq_u32 vcc, 0, v4
    s_cbranch_vccnz L_hs_14
L_hsret_15:
    v_cmp_ne_u32 vcc, s35, v4
    s_cbranch_vccnz L_hsmm_16
L_hsok_17:
    s_cmp_lg_u32 s74, 0
    s_cbranch_scc1 L_dn_s0slowa
    s_and_b32 s63, s67, 0x1ffff
    s_add_u32 s63, s63, s68
    buffer_store_dwordx4 v[168:171], v34, s[4:7], s63 offen
    s_add_u32 s67, s67, 8192
    v_mov_b32 v7, 8
    s_waitcnt vmcnt(0)
    buffer_store_dword v7, v6, s[4:7], s65 offen
L_dn_s0donea:
    s_lshl_b32 s77, s3, 18
    s_mul_i32 s59, s3, 0x80000
    s_add_u32 s59, s59, 0x100000
    v_min_u32 v5, 13, v0
    s_mul_i32 s63, s34, 56
    s_add_u32 s63, s63, 256
    v_lshl_add_u32 v5, v5, 2, s63
    s_mov_b32 s73, s59
    s_mov_b32 s86, s77
    s_mul_i32 s87, s3, 0x200000
    s_add_u32 s87, s87, 0x1000000
    s_cmp_eq_u32 s78, 1
    s_cbranch_scc1 L_ns_18
    v_lshlrev_b32 v11, 7, v0
    v_mov_b32 v9, 0x80000000
    v_cmp_gt_u32 vcc, 32, v0
    s_nop 1
    v_cndmask_b32 v11, v9, v11, vcc
    s_mov_b32 s16, s44
    s_mov_b32 s17, s45
    s_mov_b32 s18, 917504
    s_mov_b32 s19, 0x20000
    s_mul_i32 s63, s76, 4096
    s_add_u32 s63, s63, 0
    buffer_load_dword v252, v11, s[16:19], s63 offen
    s_add_u32 s63, s63, 917504
    s_mov_b32 s16, s46
    s_mov_b32 s17, s47
    s_mov_b32 s18, 917504
    s_mov_b32 s19, 0x20000
    s_mul_i32 s63, s76, 4096
    s_add_u32 s63, s63, 0
    buffer_load_dword v252, v11, s[16:19], s63 offen
    s_add_u32 s63, s63, 917504
L_ns_18:
    v_lshlrev_b32 v11, 7, v0
    v_mov_b32 v9, 0x80000000
    v_cmp_gt_u32 vcc, 16, v0
    s_nop 1
    v_cndmask_b32 v11, v9, v11, vcc
    s_add_u32 s16, s54, s73
    s_addc_u32 s17, s55, 0
    s_mov_b32 s18, 65536
    s_mov_b32 s19, 0x20000
    s_mul_i32 s63, s64, 2048
    s_add_u32 s63, s63, 0
    buffer_load_dword v252, v11, s[16:19], s63 offen
    s_add_u32 s63, s63, 65536
    s_cmp_eq_u32 s78, 1
    s_cbranch_scc1 L_ns_19
    v_lshlrev_b32 v11, 7, v0
    v_mov_b32 v9, 0x80000000
    v_cmp_gt_u32 vcc, 32, v0
    s_nop 1
    v_cndmask_b32 v11, v9, v11, vcc
    s_mov_b32 s16, s44
    s_mov_b32 s17, s45
    s_mov_b32 s18, 1835008
    s_mov_b32 s19, 0x20000
    s_mul_i32 s63, s76, 4096
    s_add_u32 s63, s63, 917504
    buffer_load_dword v252, v11, s[16:19], s63 offen
    s_add_u32 s63, s63, 917504
    s_mov_b32 s16, s46
    s_mov_b32 s17, s47
    s_mov_b32 s18, 1835008
    s_mov_b32 s19, 0x20000
    s_mul_i32 s63, s76, 4096
    s_add_u32 s63, s63, 917504
    buffer_load_dword v252, v11, s[16:19], s63 offen
    s_add_u32 s63, s63, 917504
L_ns_19:
    s_add_u32 s75, s3, 1
    s_and_b32 s75, s75, 7
    s_lshl_b32 s75, s75, 18
    v_lshlrev_b32 v11, 7, v0
    v_mov_b32 v9, 0x80000000
    v_cmp_gt_u32 vcc, 4, v0
    s_nop 1
    v_cndmask_b32 v11, v9, v11, vcc
    s_add_u32 s16, s50, s75
    s_addc_u32 s17, s51, 0
    s_mov_b32 s18, 16384
    s_mov_b32 s19, 0x20000
    s_mul_i32 s63, s64, 512
    s_add_u32 s63, s63, 0
    buffer_load_dword v252, v11, s[16:19], s63 offen sc1
    s_add_u32 s63, s63, 16384
    v_lshlrev_b32 v11, 7, v0
    v_mov_b32 v9, 0x80000000
    v_cmp_gt_u32 vcc, 12, v0
    s_nop 1
    v_cndmask_b32 v11, v9, v11, vcc
    s_add_u32 s16, s50, s86
    s_addc_u32 s17, s51, 0
    s_mov_b32 s18, 65536
    s_mov_b32 s19, 0x20000
    s_mul_i32 s63, s64, 1536
    s_add_u32 s63, s63, 16384
    buffer_load_dword v252, v11, s[16:19], s63 offen sc1
    s_add_u32 s63, s63, 49152
    s_add_u32 s75, s3, 1
    s_and_b32 s75, s75, 7
    s_lshl_b32 s75, s75, 18
    s_lshr_b32 s75, s75, 4
    s_add_u32 s75, s75, 0x2200000
    s_lshl_b32 s61, s3, 14
    s_add_u32 s61, s61, 0x2200000
    v_lshlrev_b32 v11, 7, v0
    v_mov_b32 v9, 0x80000000
    v_cmp_gt_u32 vcc, 4, v0
    s_nop 1
    v_cndmask_b32 v11, v9, v11, vcc
    s_add_u32 s16, s54, s75
    s_addc_u32 s17, s55, 0
    s_mov_b32 s18, 1024
    s_mov_b32 s19, 0x20000
    s_mul_i32 s63, s64, 512
    s_add_u32 s63, s63, 0
    buffer_load_dword v252, v11, s[16:19], s63 offen sc1
    s_add_u32 s63, s63, 16384
    s_add_u32 s16, s54, s61
    s_addc_u32 s17, s55, 0
    s_mov_b32 s18, 16384
    s_mov_b32 s19, 0x20000
    s_mul_i32 s63, s64, 512
    s_add_u32 s63, s63, 1024
    buffer_load_dword v252, v11, s[16:19], s63 offen sc1
    s_add_u32 s63, s63, 16384
    v_lshlrev_b32 v11, 7, v0
    v_mov_b32 v9, 0x80000000
    v_cmp_gt_u32 vcc, 32, v0
    s_nop 1
    v_cndmask_b32 v11, v9, v11, vcc
    s_add_u32 s16, s36, s77
    s_addc_u32 s17, s37, 0
    s_mov_b32 s18, 131072
    s_mov_b32 s19, 0x20000
    s_mul_i32 s63, s64, 4096
    s_add_u32 s63, s63, 0
    buffer_load_dword v252, v11, s[16:19], s63 offen sc1
    s_add_u32 s63, s63, 131072
    buffer_load_dword v252, v250, s[4:7], 0 offen sc1
    s_and_b32 s63, s66, 0x1fffff
    buffer_load_dwordx4 v[184:187], v24, s[12:15], s63 offen offset:0
    buffer_load_dwordx4 v[188:191], v24, s[12:15], s63 offen offset:1024
    buffer_load_dwordx4 v[192:195], v24, s[12:15], s63 offen offset:2048
    buffer_load_dwordx4 v[196:199], v24, s[12:15], s63 offen offset:3072
    s_add_u32 s66, s66, 131072
    s_and_b32 s63, s66, 0x1fffff
    s_cmp_eq_u32 s57, 0
    s_cselect_b32 s63, s63, 0x40000000
    buffer_load_dwordx4 v[200:203], v24, s[12:15], s63 offen offset:0
    buffer_load_dwordx4 v[204:207], v24, s[12:15], s63 offen offset:1024
    buffer_load_dwordx4 v[208:211], v24, s[12:15], s63 offen offset:2048
    buffer_load_dwordx4 v[212:215], v24, s[12:15], s63 offen offset:3072
    s_add_u32 s66, s66, 131072
    s_waitcnt vmcnt(4)
    v_dot2_f32_bf16 v152, v184, v12, 0
    v_dot2_f32_bf16 v153, v184, v184, 0
    v_dot2_f32_bf16 v152, v185, v12, v152
    v_dot2_f32_bf16 v153, v185, v185, v153
    v_dot2_f32_bf16 v152, v186, v12, v152
    v_dot2_f32_bf16 v153, v186, v186, v153
    v_dot2_f32_bf16 v152, v187, v12, v152
    v_dot2_f32_bf16 v153, v187, v187, v153
    v_dot2_f32_bf16 v154, v188, v12, 0
    v_dot2_f32_bf16 v155, v188, v188, 0
    v_dot2_f32_bf16 v154, v189, v12, v154
    v_dot2_f32_bf16 v155, v189, v189, v155
    v_dot2_f32_bf16 v154, v190, v12, v154
    v_dot2_f32_bf16 v155, v190, v190, v155
    v_dot2_f32_bf16 v154, v191, v12, v154
    v_dot2_f32_bf16 v155, v191, v191, v155
    v_dot2_f32_bf16 v156, v192, v12, 0
    v_dot2_f32_bf16 v157, v192, v192, 0
    v_dot2_f32_bf16 v156, v193, v12, v156
    v_dot2_f32_bf16 v157, v193, v193, v157
    v_dot2_f32_bf16 v156, v194, v12, v156
    v_dot2_f32_bf16 v157, v194, v194, v157
    v_dot2_f32_bf16 v156, v195, v12, v156
    v_dot2_f32_bf16 v157, v195, v195, v157
    v_dot2_f32_bf16 v158, v196, v12, 0
    v_dot2_f32_bf16 v159, v196, v196, 0
    v_dot2_f32_bf16 v158, v197, v12, v158
    v_dot2_f32_bf16 v159, v197, v197, v159
    v_dot2_f32_bf16 v158, v198, v12, v158
    v_dot2_f32_bf16 v159, v198, v198, v159
    v_dot2_f32_bf16 v158, v199, v12, v158
    v_dot2_f32_bf16 v159, v199, v199, v159
    v_add_f32_dpp v152, v152, v152 quad_perm:[1,0,3,2] row_mask:0xf bank_mask:0xf
    v_add_f32_dpp v153, v153, v153 quad_perm:[1,0,3,2] row_mask:0xf bank_mask:0xf
    v_add_f32_dpp v154, v154, v154 quad_perm:[1,0,3,2] row_mask:0xf bank_mask:0xf
    v_add_f32_dpp v155, v155, v155 quad_perm:[1,0,3,2] row_mask:0xf bank_mask:0xf
    v_add_f32_dpp v156, v156, v156 quad_perm:[1,0,3,2] row_mask:0xf bank_mask:0xf
    v_add_f32_dpp v157, v157, v157 quad_perm:[1,0,3,2] row_mask:0xf bank_mask:0xf
    v_add_f32_dpp v158, v158, v158 quad_perm:[1,0,3,2] row_mask:0xf bank_mask:0xf
    v_add_f32_dpp v159, v159, v159 quad_perm:[1,0,3,2] row_mask:0xf bank_mask:0xf
    v_cndmask_b32 v152, v152, v156, s[28:29]
    v_cndmask_b32 v153, v153, v157, s[28:29]
    v_cndmask_b32 v154, v154, v158, s[28:29]
    v_cndmask_b32 v155, v155, v159, s[28:29]
    v_add_f32_dpp v152, v152, v152 quad_perm:[2,3,0,1] row_mask:0xf bank_mask:0xf
    v_add_f32_dpp v153, v153, v153 quad_perm:[2,3,0,1] row_mask:0xf bank_mask:0xf
    v_add_f32_dpp v154, v154, v154 quad_perm:[2,3,0,1] row_mask:0xf bank_mask:0xf
    v_add_f32_dpp v155, v155, v155 quad_perm:[2,3,0,1] row_mask:0xf bank_mask:0xf
    v_add_f32_dpp v184, v152, v152 row_shl:4 row_mask:0xf bank_mask:0xf
    v_add_f32_dpp v185, v153, v153 row_shl:4 row_mask:0xf bank_mask:0xf
    v_add_f32_dpp v186, v154, v154 row_shl:4 row_mask:0xf bank_mask:0xf
    v_add_f32_dpp v187, v155, v155 row_shl:4 row_mask:0xf bank_mask:0xf
    s_waitcnt vmcnt(0)
    v_dot2_f32_bf16 v152, v200, v12, 0
    v_dot2_f32_bf16 v153, v200, v200, 0
    v_dot2_f32_bf16 v152, v201, v12, v152
    v_dot2_f32_bf16 v153, v201, v201, v153
    v_dot2_f32_bf16 v152, v202, v12, v152
    v_dot2_f32_bf16 v153, v202, v202, v153
    v_dot2_f32_bf16 v152, v203, v12, v152
    v_dot2_f32_bf16 v153, v203, v203, v153
    v_dot2_f32_bf16 v154, v204, v12, 0
    v_dot2_f32_bf16 v155, v204, v204, 0
    v_dot2_f32_bf16 v154, v205, v12, v154
    v_dot2_f32_bf16 v155, v205, v205, v155
    v_dot2_f32_bf16 v154, v206, v12, v154
    v_dot2_f32_bf16 v155, v206, v206, v155
    v_dot2_f32_bf16 v154, v207, v12, v154
    v_dot2_f32_bf16 v155, v207, v207, v155
    v_dot2_f32_bf16 v156, v208, v12, 0
    v_dot2_f32_bf16 v157, v208, v208, 0
    v_dot2_f32_bf16 v156, v209, v12, v156
    v_dot2_f32_bf16 v157, v209, v209, v157
    v_dot2_f32_bf16 v156, v210, v12, v156
    v_dot2_f32_bf16 v157, v210, v210, v157
    v_dot2_f32_bf16 v156, v211, v12, v156
    v_dot2_f32_bf16 v157, v211, v211, v157
    v_dot2_f32_bf16 v158, v212, v12, 0
    v_dot2_f32_bf16 v159, v212, v212, 0
    v_dot2_f32_bf16 v158, v213, v12, v158
    v_dot2_f32_bf16 v159, v213, v213, v159
    v_dot2_f32_bf16 v158, v214, v12, v158
    v_dot2_f32_bf16 v159, v214, v214, v159
    v_dot2_f32_bf16 v158, v215, v12, v158
    v_dot2_f32_bf16 v159, v215, v215, v159
    v_add_f32_dpp v152, v152, v152 quad_perm:[1,0,3,2] row_mask:0xf bank_mask:0xf
    v_add_f32_dpp v153, v153, v153 quad_perm:[1,0,3,2] row_mask:0xf bank_mask:0xf
    v_add_f32_dpp v154, v154, v154 quad_perm:[1,0,3,2] row_mask:0xf bank_mask:0xf
    v_add_f32_dpp v155, v155, v155 quad_perm:[1,0,3,2] row_mask:0xf bank_mask:0xf
    v_add_f32_dpp v156, v156, v156 quad_perm:[1,0,3,2] row_mask:0xf bank_mask:0xf
    v_add_f32_dpp v157, v157, v157 quad_perm:[1,0,3,2] row_mask:0xf bank_mask:0xf
    v_add_f32_dpp v158, v158, v158 quad_perm:[1,0,3,2] row_mask:0xf bank_mask:0xf
    v_add_f32_dpp v159, v159, v159 quad_perm:[1,0,3,2] row_mask:0xf bank_mask:0xf
    v_cndmask_b32 v152, v152, v156, s[28:29]
    v_cndmask_b32 v153, v153, v157, s[28:29]
    v_cndmask_b32 v154, v154, v158, s[28:29]
    v_cndmask_b32 v155, v155, v159, s[28:29]
    v_add_f32_dpp v152, v152, v152 quad_perm:[2,3,0,1] row_mask:0xf bank_mask:0xf
    v_add_f32_dpp v153, v153, v153 quad_perm:[2,3,0,1] row_mask:0xf bank_mask:0xf
    v_add_f32_dpp v154, v154, v154 quad_perm:[2,3,0,1] row_mask:0xf bank_mask:0xf
    v_add_f32_dpp v155, v155, v155 quad_perm:[2,3,0,1] row_mask:0xf bank_mask:0xf
    v_add_f32_dpp v200, v152, v152 row_shl:4 row_mask:0xf bank_mask:0xf
    v_add_f32_dpp v201, v153, v153 row_shl:4 row_mask:0xf bank_mask:0xf
    v_add_f32_dpp v202, v154, v154 row_shl:4 row_mask:0xf bank_mask:0xf
    v_add_f32_dpp v203, v155, v155 row_shl:4 row_mask:0xf bank_mask:0xf
    s_cmp_lg_u32 s74, 0
    s_cbranch_scc1 L_dn_s0slowb
    s_and_b32 s63, s67, 0x1ffff
    s_add_u32 s63, s63, s68
    buffer_store_dwordx4 v[184:187], v34, s[4:7], s63 offen
    s_add_u32 s67, s67, 8192
    s_and_b32 s63, s67, 0x1ffff
    s_add_u32 s63, s63, s68
    buffer_store_dwordx4 v[200:203], v34, s[4:7], s63 offen
    s_add_u32 s67, s67, 8192
    v_mov_b32 v7, 17
    s_waitcnt vmcnt(0)
    buffer_store_dword v7, v6, s[4:7], s65 offen
L_dn_s0doneb:
    s_cmp_eq_u32 s78, 1
    s_cbranch_scc1 L_ns_20
    v_lshlrev_b32 v11, 7, v0
    s_mov_b32 s16, s48
    s_mov_b32 s17, s49
    s_mov_b32 s18, 1835008
    s_mov_b32 s19, 0x20000
    s_mul_i32 s63, s76, 8192
    s_add_u32 s63, s63, 0
    buffer_load_dword v252, v11, s[16:19], s63 offen
    s_add_u32 s63, s63, 1835008
L_ns_20:
    v_lshlrev_b32 v11, 7, v0
    v_mov_b32 v9, 0x80000000
    v_cmp_gt_u32 vcc, 32, v0
    s_nop 1
    v_cndmask_b32 v11, v9, v11, vcc
    s_add_u32 s16, s36, s77
    s_addc_u32 s17, s37, 0
    s_mov_b32 s18, 262144
    s_mov_b32 s19, 0x20000
    s_mul_i32 s63, s64, 4096
    s_add_u32 s63, s63, 131072
    buffer_load_dword v252, v11, s[16:19], s63 offen sc1
    s_add_u32 s63, s63, 131072
    buffer_load_dword v252, v250, s[4:7], 0 offen sc1
    v_lshrrev_b32 v8, 2, v1
    v_lshl_add_u32 v20, v2, 3, v8
    v_lshlrev_b32 v20, 7, v20
    v_lshrrev_b32 v8, 1, v8
    v_lshl_add_u32 v20, v8, 6, v20
    v_and_b32 v8, 3, v0
    v_lshl_add_u32 v20, v8, 4, v20
    v_add_u32 v20, s62, v20
    s_xor_b32 s63, s34, 3
    s_lshr_b32 s75, s63, 1
    s_lshl_b32 s75, s75, 6
    s_and_b32 s63, s63, 1
    s_lshl_b32 s63, s63, 3
    s_or_b32 s63, s63, s75
    v_xor_b32 v20, s63, v20
    v_xor_b32 v21, 8, v20
    v_xor_b32 v22, 64, v20
    v_xor_b32 v23, 72, v20
    s_mul_i32 s63, s34, 14336
    v_add_u32 v24, s63, v3
    v_add_u32 v25, 4096, v24
    v_add_u32 v26, 8192, v24
    v_add_u32 v27, 12288, v24
    s_mul_i32 s63, s34, 4352
    v_mul_u32_u24 v29, 272, v1
    v_lshl_add_u32 v29, v2, 4, v29
    v_add_u32 v29, s63, v29
    v_and_b32 v152, 2, v1
    v_lshrrev_b32 v8, 2, v1
    v_lshl_add_u32 v152, v152, 1, v8
    s_lshl_b32 s63, s34, 2
    v_add_u32 v11, s63, v2
    v_mul_u32_u24 v9, 272, v11
    v_and_b32 v8, 1, v1
    v_lshl_add_u32 v9, v8, 3, v9
    v_xor_b32 v8, 4, v152
    v_lshl_add_u32 v8, v8, 4, v9
    v_add_u32 v220, 0, v8
    v_add_u32 v224, 17408, v8
    v_xor_b32 v8, 0, v152
    v_lshl_add_u32 v8, v8, 4, v9
    v_add_u32 v221, 4352, v8
    v_add_u32 v225, 21760, v8
    v_xor_b32 v8, 4, v152
    v_lshl_add_u32 v8, v8, 4, v9
    v_add_u32 v222, 8704, v8
    v_add_u32 v226, 26112, v8
    v_xor_b32 v8, 0, v152
    v_lshl_add_u32 v8, v8, 4, v9
    v_add_u32 v223, 13056, v8
    v_add_u32 v227, 30464, v8
    v_lshrrev_b32 v8, 5, v0
    v_add_u32 v8, s63, v8
    v_lshlrev_b32 v31, 10, v8
    v_and_b32 v8, 31, v0
    v_lshl_add_u32 v31, v8, 2, v31
    s_lshl_b32 s68, s34, 9
    s_add_u32 s68, s68, 34816
    v_lshl_add_u32 v28, v0, 3, s68
    v_lshlrev_b32 v33, 10, v11
    v_lshl_add_u32 v33, v1, 2, v33
    s_lshl_b32 s63, s57, 7
    v_add_u32 v33, s63, v33
    v_add_u32 v31, s63, v31
    v_add_u32 v32, 1792, v31
    s_lshl_b32 s75, s34, 5
    s_add_u32 s63, s63, s75
    v_lshl_add_u32 v34, v0, 2, s63
    v_mov_b32 v9, 0x80000000
    v_cmp_gt_u32 vcc, 8, v0
    s_nop 1
    v_cndmask_b32 v34, v9, v34, vcc
    v_and_b32 v8, 6, v0
    v_lshlrev_b32 v30, 5, v8
    v_and_b32 v8, 1, v0
    v_lshl_add_u32 v30, v8, 2, v30
    s_mov_b32 s12, s50
    s_mov_b32 s13, s51
    s_mov_b32 s14, 2097152
    s_mov_b32 s15, 0x20000
    s_add_u32 s66, s3, 1
    s_and_b32 s66, s66, 7
    s_lshl_b32 s66, s66, 18
    s_add_u32 s77, s77, 16384
    s_mov_b32 s83, 0x40000000
    s_mov_b32 s67, 0x40000000
    s_mul_i32 s59, s3, 0x200000
    s_add_u32 s59, s59, 0x1000000
    s_add_u32 s32, s59, 262144
    s_add_u32 s60, s59, 65536
    s_sub_u32 s58, 1, s78
    buffer_load_dword v4, v5, s[4:7], s65 offen sc1
    s_waitcnt vmcnt(0)
    v_cmp_gt_i32 vcc, s58, v4
    s_cbranch_vccnz L_spin_dnw_pro
L_ret_dnw_pro:
    s_add_u32 s16, s54, 35651584
    s_addc_u32 s17, s55, 0
    s_mov_b32 s18, 131072
    s_mov_b32 s19, 0x20000
    s_add_u32 m0, s62, 0
    s_nop 0
    buffer_load_dwordx4 v16, s[8:11], s70 offen offset:0 lds
    buffer_load_dwordx4 v17, s[8:11], s70 offen offset:1024 lds
    buffer_load_dwordx4 v18, s[8:11], s70 offen offset:2048 lds
    buffer_load_dwordx4 v19, s[8:11], s70 offen offset:3072 lds
    s_add_u32 s70, s70, 32768
    s_add_u32 m0, s62, 4096
    s_nop 0
    buffer_load_dwordx4 v16, s[8:11], s70 offen offset:0 lds
    buffer_load_dwordx4 v17, s[8:11], s70 offen offset:1024 lds
    buffer_load_dwordx4 v18, s[8:11], s70 offen offset:2048 lds
    buffer_load_dwordx4 v19, s[8:11], s70 offen offset:3072 lds
    s_add_u32 s70, s70, 32768
    s_add_u32 m0, s62, 8192
    s_nop 0
    buffer_load_dwordx4 v16, s[8:11], s70 offen offset:0 lds
    buffer_load_dwordx4 v17, s[8:11], s70 offen offset:1024 lds
    buffer_load_dwordx4 v18, s[8:11], s70 offen offset:2048 lds
    buffer_load_dwordx4 v19, s[8:11], s70 offen offset:3072 lds
    s_add_u32 s70, s70, 32768
    s_waitcnt vmcnt(8)
    s_add_u32 m0, s62, 12288
    s_nop 0
    buffer_load_dwordx4 v16, s[8:11], s70 offen offset:0 lds
    buffer_load_dwordx4 v17, s[8:11], s70 offen offset:1024 lds
    buffer_load_dwordx4 v18, s[8:11], s70 offen offset:2048 lds
    buffer_load_dwordx4 v19, s[8:11], s70 offen offset:3072 lds
    s_add_u32 s70, s70, 32768
    ds_read_b64_tr_b16 a[0:1], v20 offset:0
    ds_read_b64_tr_b16 a[2:3], v20 offset:512
    ds_read_b64_tr_b16 a[4:5], v21 offset:0
    ds_read_b64_tr_b16 a[6:7], v21 offset:512
    ds_read_b64_tr_b16 a[8:9], v22 offset:0
    ds_read_b64_tr_b16 a[10:11], v22 offset:512
    ds_read_b64_tr_b16 a[12:13], v23 offset:0
    ds_read_b64_tr_b16 a[14:15], v23 offset:512
    s_waitcnt lgkmcnt(0)
    s_waitcnt vmcnt(8)
    s_add_u32 m0, s62, 0
    s_nop 0
    buffer_load_dwordx4 v16, s[8:11], s70 offen offset:0 lds
    buffer_load_dwordx4 v17, s[8:11], s70 offen offset:1024 lds
    buffer_load_dwordx4 v18, s[8:11], s70 offen offset:2048 lds
    buffer_load_dwordx4 v19, s[8:11], s70 offen offset:3072 lds
    s_add_u32 s70, s70, 32768
    ds_read_b64_tr_b16 a[16:17], v20 offset:4096
    ds_read_b64_tr_b16 a[18:19], v20 offset:4608
    ds_read_b64_tr_b16 a[20:21], v21 offset:4096
    ds_read_b64_tr_b16 a[22:23], v21 offset:4608
    ds_read_b64_tr_b16 a[24:25], v22 offset:4096
    ds_read_b64_tr_b16 a[26:27], v22 offset:4608
    ds_read_b64_tr_b16 a[28:29], v23 offset:4096
    ds_read_b64_tr_b16 a[30:31], v23 offset:4608
    s_waitcnt lgkmcnt(0)
    s_waitcnt vmcnt(8)
    s_add_u32 m0, s62, 4096
    s_nop 0
    buffer_load_dwordx4 v16, s[8:11], s70 offen offset:0 lds
    buffer_load_dwordx4 v17, s[8:11], s70 offen offset:1024 lds
    buffer_load_dwordx4 v18, s[8:11], s70 offen offset:2048 lds
    buffer_load_dwordx4 v19, s[8:11], s70 offen offset:3072 lds
    s_add_u32 s70, s70, 32768
    ds_read_b64_tr_b16 a[32:33], v20 offset:8192
    ds_read_b64_tr_b16 a[34:35], v20 offset:8704
    ds_read_b64_tr_b16 a[36:37], v21 offset:8192
    ds_read_b64_tr_b16 a[38:39], v21 offset:8704
    ds_read_b64_tr_b16 a[40:41], v22 offset:8192
    ds_read_b64_tr_b16 a[42:43], v22 offset:8704
    ds_read_b64_tr_b16 a[44:45], v23 offset:8192
    ds_read_b64_tr_b16 a[46:47], v23 offset:8704
    s_waitcnt lgkmcnt(0)
    s_waitcnt vmcnt(8)
    s_add_u32 m0, s62, 8192
    s_nop 0
    buffer_load_dwordx4 v16, s[8:11], s70 offen offset:0 lds
    buffer_load_dwordx4 v17, s[8:11], s70 offen offset:1024 lds
    buffer_load_dwordx4 v18, s[8:11], s70 offen offset:2048 lds
    buffer_load_dwordx4 v19, s[8:11], s70 offen offset:3072 lds
    s_add_u32 s70, s70, 32768
    ds_read_b64_tr_b16 a[48:49], v20 offset:12288
    ds_read_b64_tr_b16 a[50:51], v20 offset:12800
    ds_read_b64_tr_b16 a[52:53], v21 offset:12288
    ds_read_b64_tr_b16 a[54:55], v21 offset:12800
    ds_read_b64_tr_b16 a[56:57], v22 offset:12288
    ds_read_b64_tr_b16 a[58:59], v22 offset:12800
    ds_read_b64_tr_b16 a[60:61], v23 offset:12288
    ds_read_b64_tr_b16 a[62:63], v23 offset:12800
    s_waitcnt lgkmcnt(0)
    s_waitcnt vmcnt(8)
    s_add_u32 m0, s62, 12288
    s_nop 0
    buffer_load_dwordx4 v16, s[8:11], s70 offen offset:0 lds
    buffer_load_dwordx4 v17, s[8:11], s70 offen offset:1024 lds
    buffer_load_dwordx4 v18, s[8:11], s70 offen offset:2048 lds
    buffer_load_dwordx4 v19, s[8:11], s70 offen offset:3072 lds
    s_add_u32 s70, s70, 32768
    ds_read_b64_tr_b16 a[64:65], v20 offset:0
    ds_read_b64_tr_b16 a[66:67], v20 offset:512
    ds_read_b64_tr_b16 a[68:69], v21 offset:0
    ds_read_b64_tr_b16 a[70:71], v21 offset:512
    ds_read_b64_tr_b16 a[72:73], v22 offset:0
    ds_read_b64_tr_b16 a[74:75], v22 offset:512
    ds_read_b64_tr_b16 a[76:77], v23 offset:0
    ds_read_b64_tr_b16 a[78:79], v23 offset:512
    s_waitcnt lgkmcnt(0)
    s_waitcnt vmcnt(8)
    s_add_u32 m0, s62, 0
    s_nop 0
    buffer_load_dwordx4 v16, s[8:11], s70 offen offset:0 lds
    buffer_load_dwordx4 v17, s[8:11], s70 offen offset:1024 lds
    buffer_load_dwordx4 v18, s[8:11], s70 offen offset:2048 lds
    buffer_load_dwordx4 v19, s[8:11], s70 offen offset:3072 lds
    s_add_u32 s70, s70, 32768
    ds_read_b64_tr_b16 a[80:81], v20 offset:4096
    ds_read_b64_tr_b16 a[82:83], v20 offset:4608
    ds_read_b64_tr_b16 a[84:85], v21 offset:4096
    ds_read_b64_tr_b16 a[86:87], v21 offset:4608
    ds_read_b64_tr_b16 a[88:89], v22 offset:4096
    ds_read_b64_tr_b16 a[90:91], v22 offset:4608
    ds_read_b64_tr_b16 a[92:93], v23 offset:4096
    ds_read_b64_tr_b16 a[94:95], v23 offset:4608
    s_waitcnt lgkmcnt(0)
    s_waitcnt vmcnt(8)
    s_add_u32 m0, s62, 4096
    s_nop 0
    buffer_load_dwordx4 v16, s[8:11], s70 offen offset:0 lds
    buffer_load_dwordx4 v17, s[8:11], s70 offen offset:1024 lds
    buffer_load_dwordx4 v18, s[8:11], s70 offen offset:2048 lds
    buffer_load_dwordx4 v19, s[8:11], s70 offen offset:3072 lds
    s_add_u32 s70, s70, 32768
    ds_read_b64_tr_b16 a[96:97], v20 offset:8192
    ds_read_b64_tr_b16 a[98:99], v20 offset:8704
    ds_read_b64_tr_b16 a[100:101], v21 offset:8192
    ds_read_b64_tr_b16 a[102:103], v21 offset:8704
    ds_read_b64_tr_b16 a[104:105], v22 offset:8192
    ds_read_b64_tr_b16 a[106:107], v22 offset:8704
    ds_read_b64_tr_b16 a[108:109], v23 offset:8192
    ds_read_b64_tr_b16 a[110:111], v23 offset:8704
    s_waitcnt lgkmcnt(0)
    s_waitcnt vmcnt(8)
    s_add_u32 m0, s62, 8192
    s_nop 0
    buffer_load_dwordx4 v16, s[8:11], s70 offen offset:0 lds
    buffer_load_dwordx4 v17, s[8:11], s70 offen offset:1024 lds
    buffer_load_dwordx4 v18, s[8:11], s70 offen offset:2048 lds
    buffer_load_dwordx4 v19, s[8:11], s70 offen offset:3072 lds
    s_add_u32 s70, s70, 32768
    ds_read_b64_tr_b16 a[112:113], v20 offset:12288
    ds_read_b64_tr_b16 a[114:115], v20 offset:12800
    ds_read_b64_tr_b16 a[116:117], v21 offset:12288
    ds_read_b64_tr_b16 a[118:119], v21 offset:12800
    ds_read_b64_tr_b16 a[120:121], v22 offset:12288
    ds_read_b64_tr_b16 a[122:123], v22 offset:12800
    ds_read_b64_tr_b16 a[124:125], v23 offset:12288
    ds_read_b64_tr_b16 a[126:127], v23 offset:12800
    s_waitcnt lgkmcnt(0)
    s_waitcnt vmcnt(8)
    s_add_u32 m0, s62, 12288
    s_nop 0
    buffer_load_dwordx4 v16, s[8:11], s70 offen offset:0 lds
    buffer_load_dwordx4 v17, s[8:11], s70 offen offset:1024 lds
    buffer_load_dwordx4 v18, s[8:11], s70 offen offset:2048 lds
    buffer_load_dwordx4 v19, s[8:11], s70 offen offset:3072 lds
    s_add_u32 s70, s70, 32768
    ds_read_b64_tr_b16 a[128:129], v20 offset:0
    ds_read_b64_tr_b16 a[130:131], v20 offset:512
    ds_read_b64_tr_b16 a[132:133], v21 offset:0
    ds_read_b64_tr_b16 a[134:135], v21 offset:512
    ds_read_b64_tr_b16 a[136:137], v22 offset:0
    ds_read_b64_tr_b16 a[138:139], v22 offset:512
    ds_read_b64_tr_b16 a[140:141], v23 offset:0
    ds_read_b64_tr_b16 a[142:143], v23 offset:512
    s_waitcnt lgkmcnt(0)
    s_waitcnt vmcnt(8)
    s_add_u32 m0, s62, 0
    s_nop 0
    buffer_load_dwordx4 v16, s[8:11], s70 offen offset:0 lds
    buffer_load_dwordx4 v17, s[8:11], s70 offen offset:1024 lds
    buffer_load_dwordx4 v18, s[8:11], s70 offen offset:2048 lds
    buffer_load_dwordx4 v19, s[8:11], s70 offen offset:3072 lds
    s_add_u32 s70, s70, 32768
    ds_read_b64_tr_b16 a[144:145], v20 offset:4096
    ds_read_b64_tr_b16 a[146:147], v20 offset:4608
    ds_read_b64_tr_b16 a[148:149], v21 offset:4096
    ds_read_b64_tr_b16 a[150:151], v21 offset:4608
    ds_read_b64_tr_b16 a[152:153], v22 offset:4096
    ds_read_b64_tr_b16 a[154:155], v22 offset:4608
    ds_read_b64_tr_b16 a[156:157], v23 offset:4096
    ds_read_b64_tr_b16 a[158:159], v23 offset:4608
    s_waitcnt lgkmcnt(0)
    s_waitcnt vmcnt(8)
    s_add_u32 m0, s62, 4096
    s_nop 0
    buffer_load_dwordx4 v16, s[8:11], s70 offen offset:0 lds
    buffer_load_dwordx4 v17, s[8:11], s70 offen offset:1024 lds
    buffer_load_dwordx4 v18, s[8:11], s70 offen offset:2048 lds
    buffer_load_dwordx4 v19, s[8:11], s70 offen offset:3072 lds
    s_add_u32 s70, s70, 32768
    ds_read_b64_tr_b16 a[160:161], v20 offset:8192
    ds_read_b64_tr_b16 a[162:163], v20 offset:8704
    ds_read_b64_tr_b16 a[164:165], v21 offset:8192
    ds_read_b64_tr_b16 a[166:167], v21 offset:8704
    ds_read_b64_tr_b16 a[168:169], v22 offset:8192
    ds_read_b64_tr_b16 a[170:171], v22 offset:8704
    ds_read_b64_tr_b16 a[172:173], v23 offset:8192
    ds_read_b64_tr_b16 a[174:175], v23 offset:8704
    s_waitcnt lgkmcnt(0)
    s_waitcnt vmcnt(8)
    ds_read_b64_tr_b16 a[176:177], v20 offset:12288
    ds_read_b64_tr_b16 a[178:179], v20 offset:12800
    ds_read_b64_tr_b16 a[180:181], v21 offset:12288
    ds_read_b64_tr_b16 a[182:183], v21 offset:12800
    ds_read_b64_tr_b16 a[184:185], v22 offset:12288
    ds_read_b64_tr_b16 a[186:187], v22 offset:12800
    ds_read_b64_tr_b16 a[188:189], v23 offset:12288
    ds_read_b64_tr_b16 a[190:191], v23 offset:12800
    s_waitcnt lgkmcnt(0)
    s_waitcnt vmcnt(4)
    ds_read_b64_tr_b16 a[192:193], v20 offset:0
    ds_read_b64_tr_b16 a[194:195], v20 offset:512
    ds_read_b64_tr_b16 a[196:197], v21 offset:0
    ds_read_b64_tr_b16 a[198:199], v21 offset:512
    ds_read_b64_tr_b16 a[200:201], v22 offset:0
    ds_read_b64_tr_b16 a[202:203], v22 offset:512
    ds_read_b64_tr_b16 a[204:205], v23 offset:0
    ds_read_b64_tr_b16 a[206:207], v23 offset:512
    s_waitcnt lgkmcnt(0)
    s_waitcnt vmcnt(0)
    ds_read_b64_tr_b16 a[208:209], v20 offset:4096
    ds_read_b64_tr_b16 a[210:211], v20 offset:4608
    ds_read_b64_tr_b16 a[212:213], v21 offset:4096
    ds_read_b64_tr_b16 a[214:215], v21 offset:4608
    ds_read_b64_tr_b16 a[216:217], v22 offset:4096
    ds_read_b64_tr_b16 a[218:219], v22 offset:4608
    ds_read_b64_tr_b16 a[220:221], v23 offset:4096
    ds_read_b64_tr_b16 a[222:223], v23 offset:4608
    s_waitcnt lgkmcnt(0)
    s_mov_b32 s58, 2
    s_mov_b32 m0, s68
    buffer_load_dword v4, v5, s[4:7], s65 offen sc1
    s_waitcnt vmcnt(0)
    v_cmp_gt_i32 vcc, s58, v4
    s_cbranch_vccnz L_spin_dn_pro
L_ret_dn_pro:
    buffer_load_dword v31, s[12:15], s66 offen offset:0 sc1 lds
    buffer_load_dword v32, s[12:15], s66 offen offset:256 sc1 lds
    s_add_u32 s58, s58, 1
    s_mov_b32 s82, s66
    s_add_u32 s66, s66, 16384
    s_and_b32 s66, s66, 0x1fffff
    s_mov_b32 s66, s77
    buffer_load_dwordx4 v[80:83], v24, s[4:7], s59 offen offset:0 sc1
    buffer_load_dwordx4 v[84:87], v24, s[4:7], s59 offen offset:1024 sc1
    buffer_load_dwordx4 v[88:91], v24, s[4:7], s59 offen offset:2048 sc1
    buffer_load_dwordx4 v[92:95], v24, s[4:7], s59 offen offset:3072 sc1
    buffer_load_dwordx4 v[96:99], v25, s[4:7], s59 offen offset:0 sc1
    buffer_load_dwordx4 v[100:103], v25, s[4:7], s59 offen offset:1024 sc1
    buffer_load_dwordx4 v[104:107], v25, s[4:7], s59 offen offset:2048 sc1
    buffer_load_dword v4, v5, s[4:7], s65 offen sc1
    buffer_load_dword v4, v5, s[4:7], s65 offen sc1
    buffer_load_dword v4, v5, s[4:7], s65 offen sc1
    s_mov_b32 s61, 9
    s_cmp_lg_u32 s74, 0
    s_cbranch_scc1 L_dn_loop_slow
.p2align 4
L_dn_loop_fast:
    s_waitcnt vmcnt(9)
    v_mfma_f32_16x16x32_bf16 v[48:51], a[0:3], v[80:83], 0
    ds_read_b64 v[40:41], v28
    v_mfma_f32_16x16x32_bf16 v[52:55], a[4:7], v[80:83], 0
    ds_write_b128 v29, v[64:67] offset:17408
    v_mfma_f32_16x16x32_bf16 v[56:59], a[8:11], v[80:83], 0
    s_waitcnt vmcnt(8)
    buffer_load_dword v4, v5, s[4:7], s65 offen sc1
    v_mfma_f32_16x16x32_bf16 v[48:51], a[16:19], v[84:87], v[48:51]
    buffer_load_dwordx4 v[108:111], v25, s[4:7], s59 offen offset:3072 sc1
    v_mfma_f32_16x16x32_bf16 v[52:55], a[20:23], v[84:87], v[52:55]
    v_mfma_f32_16x16x32_bf16 v[56:59], a[24:27], v[84:87], v[56:59]
    s_waitcnt vmcnt(9)
    ds_write_b128 v29, v[68:71] offset:17472
    v_mfma_f32_16x16x32_bf16 v[48:51], a[32:35], v[88:91], v[48:51]
    s_waitcnt lgkmcnt(2)
    v_lshlrev_b32 v60, 16, v40
    v_and_b32 v61, 0xffff0000, v40
    v_mfma_f32_16x16x32_bf16 v[52:55], a[36:39], v[88:91], v[52:55]
    v_lshlrev_b32 v62, 16, v41
    v_and_b32 v63, 0xffff0000, v41
    v_mfma_f32_16x16x32_bf16 v[56:59], a[40:43], v[88:91], v[56:59]
    buffer_load_dwordx4 v[112:115], v26, s[4:7], s59 offen offset:0 sc1
    v_mfma_f32_16x16x32_bf16 v[60:63], a[12:15], v[80:83], v[60:63]
    buffer_load_dwordx4 v[116:119], v26, s[4:7], s59 offen offset:1024 sc1
    v_mfma_f32_16x16x32_bf16 v[60:63], a[28:31], v[84:87], v[60:63]
    ds_write_b128 v29, v[72:75] offset:17536
    v_mfma_f32_16x16x32_bf16 v[60:63], a[44:47], v[88:91], v[60:63]
    s_waitcnt vmcnt(10)
    v_mfma_f32_16x16x32_bf16 v[48:51], a[48:51], v[92:95], v[48:51]
    buffer_load_dwordx4 v[120:123], v26, s[4:7], s59 offen offset:2048 sc1
    v_mfma_f32_16x16x32_bf16 v[52:55], a[52:55], v[92:95], v[52:55]
    ds_write_b128 v29, v[76:79] offset:17600
    v_mfma_f32_16x16x32_bf16 v[56:59], a[56:59], v[92:95], v[56:59]
    s_waitcnt vmcnt(5)
    v_add_u32 v7, 1, v7
    v_mfma_f32_16x16x32_bf16 v[60:63], a[60:63], v[92:95], v[60:63]
    buffer_store_dword v7, v6, s[4:7], s65 offen
    v_mfma_f32_16x16x32_bf16 v[48:51], a[64:67], v[96:99], v[48:51]
    buffer_load_dwordx4 v[124:127], v26, s[4:7], s59 offen offset:3072 sc1
    v_mfma_f32_16x16x32_bf16 v[52:55], a[68:71], v[96:99], v[52:55]
    v_mfma_f32_16x16x32_bf16 v[56:59], a[72:75], v[96:99], v[56:59]
    v_mfma_f32_16x16x32_bf16 v[60:63], a[76:79], v[96:99], v[60:63]
    s_waitcnt lgkmcnt(0)
    s_barrier
    v_mfma_f32_16x16x32_bf16 v[48:51], a[80:83], v[100:103], v[48:51]
    buffer_load_dwordx4 v[128:131], v27, s[4:7], s59 offen offset:0 sc1
    v_mfma_f32_16x16x32_bf16 v[52:55], a[84:87], v[100:103], v[52:55]
    ds_read2_b64 v[136:139], v224 offset0:16 offset1:0
    ds_read2_b64 v[140:143], v225 offset0:16 offset1:0
    v_mfma_f32_16x16x32_bf16 v[56:59], a[88:91], v[100:103], v[56:59]
    buffer_load_dwordx4 v[132:135], v27, s[4:7], s59 offen offset:1024 sc1
    v_mfma_f32_16x16x32_bf16 v[60:63], a[92:95], v[100:103], v[60:63]
    ds_read2_b64 v[144:147], v226 offset0:0 offset1:16
    ds_read2_b64 v[148:151], v227 offset0:0 offset1:16
    v_mfma_f32_16x16x32_bf16 v[48:51], a[96:99], v[104:107], v[48:51]
    s_waitcnt vmcnt(8)
    v_cmp_gt_i32 vcc, s58, v4
    s_add_u32 s59, s59, 131072
    v_mfma_f32_16x16x32_bf16 v[52:55], a[100:103], v[104:107], v[52:55]
    s_andn2_b32 s59, s59, 262144
    v_mfma_f32_16x16x32_bf16 v[56:59], a[104:107], v[104:107], v[56:59]
    s_cbranch_vccnz L_spin_dneven_fast
L_ret_dneven_fast:
    buffer_load_dword v31, s[12:15], s66 offen offset:0 sc1 lds
    v_mfma_f32_16x16x32_bf16 v[60:63], a[108:111], v[104:107], v[60:63]
    s_waitcnt vmcnt(8)
    buffer_load_dword v32, s[12:15], s66 offen offset:256 sc1 lds
    v_mfma_f32_16x16x32_bf16 v[48:51], a[112:115], v[108:111], v[48:51]
    s_add_u32 s58, s58, 1
    buffer_load_dwordx4 v[80:83], v24, s[4:7], s60 offen offset:0 sc1
    v_mfma_f32_16x16x32_bf16 v[52:55], a[116:119], v[108:111], v[52:55]
    s_mov_b32 s76, s66
    s_waitcnt lgkmcnt(2)
    v_add_f32 v136, v136, v140
    v_mfma_f32_16x16x32_bf16 v[56:59], a[120:123], v[108:111], v[56:59]
    s_add_u32 s66, s66, 16384
    v_add_f32 v137, v137, v141
    v_add_f32 v138, v138, v142
    v_mfma_f32_16x16x32_bf16 v[60:63], a[124:127], v[108:111], v[60:63]
    s_waitcnt vmcnt(9)
    buffer_load_dwordx4 v[84:87], v24, s[4:7], s60 offen offset:1024 sc1
    v_mfma_f32_16x16x32_bf16 v[48:51], a[128:131], v[112:115], v[48:51]
    s_and_b32 s66, s66, 0x1fffff
    v_add_f32 v139, v139, v143
    s_cmp_eq_u32 s58, 18
    s_cselect_b32 s66, s77, s66
    v_mfma_f32_16x16x32_bf16 v[52:55], a[132:135], v[112:115], v[52:55]
    s_waitcnt lgkmcnt(0)
    v_add_f32 v144, v144, v148
    v_add_f32 v145, v145, v149
    v_mfma_f32_16x16x32_bf16 v[56:59], a[136:139], v[112:115], v[56:59]
    buffer_load_dwordx4 v[88:91], v24, s[4:7], s60 offen offset:2048 sc1
    v_mfma_f32_16x16x32_bf16 v[60:63], a[140:143], v[112:115], v[60:63]
    s_waitcnt vmcnt(10)
    v_add_f32 v146, v146, v150
    v_add_f32 v147, v147, v151
    v_mfma_f32_16x16x32_bf16 v[48:51], a[144:147], v[116:119], v[48:51]
    v_add_f32 v136, v136, v144
    v_add_f32 v137, v137, v145
    v_mfma_f32_16x16x32_bf16 v[52:55], a[148:151], v[116:119], v[52:55]
    v_add_f32 v138, v138, v146
    v_add_f32 v139, v139, v147
    v_mfma_f32_16x16x32_bf16 v[56:59], a[152:155], v[116:119], v[56:59]
    buffer_load_dwordx4 v[92:95], v24, s[4:7], s60 offen offset:3072 sc1
    v_mfma_f32_16x16x32_bf16 v[60:63], a[156:159], v[116:119], v[60:63]
    s_waitcnt vmcnt(10)
    v_add_f32 v144, v136, v137
    v_mul_f32 v145, v136, v136
    v_mfma_f32_16x16x32_bf16 v[48:51], a[160:163], v[120:123], v[48:51]
    v_fmac_f32 v145, v137, v137
    v_add_f32 v144, v144, v138
    v_mfma_f32_16x16x32_bf16 v[52:55], a[164:167], v[120:123], v[52:55]
    buffer_load_dwordx4 v[96:99], v25, s[4:7], s60 offen offset:0 sc1
    v_mfma_f32_16x16x32_bf16 v[56:59], a[168:171], v[120:123], v[56:59]
    v_fmac_f32 v145, v138, v138
    v_add_f32 v144, v144, v139
    v_mfma_f32_16x16x32_bf16 v[60:63], a[172:175], v[120:123], v[60:63]
    s_waitcnt vmcnt(9)
    v_fmac_f32 v145, v139, v139
    v_add_f32_dpp v144, v144, v144 quad_perm:[1,0,3,2] row_mask:0xf bank_mask:0xf
    v_mfma_f32_16x16x32_bf16 v[48:51], a[176:179], v[124:127], v[48:51]
    v_add_f32_dpp v145, v145, v145 quad_perm:[1,0,3,2] row_mask:0xf bank_mask:0xf
    v_cndmask_b32 v144, v144, v145, s[28:29]
    v_mfma_f32_16x16x32_bf16 v[52:55], a[180:183], v[124:127], v[52:55]
    buffer_load_dwordx4 v[100:103], v25, s[4:7], s60 offen offset:1024 sc1
    v_mfma_f32_16x16x32_bf16 v[56:59], a[184:187], v[124:127], v[56:59]
    v_add_f32_dpp v144, v144, v144 row_ror:2 row_mask:0xf bank_mask:0xf
    v_cvt_pk_bf16_f32 v140, v136, v137
    v_mfma_f32_16x16x32_bf16 v[60:63], a[188:191], v[124:127], v[60:63]
    s_waitcnt vmcnt(9)
    v_cvt_pk_bf16_f32 v141, v138, v139
    v_mfma_f32_16x16x32_bf16 v[48:51], a[192:195], v[128:131], v[48:51]
    v_add_f32_dpp v144, v144, v144 row_ror:4 row_mask:0xf bank_mask:0xf
    v_mfma_f32_16x16x32_bf16 v[52:55], a[196:199], v[128:131], v[52:55]
    buffer_store_dword v140, v33, s[12:15], s83 offen offset:0
    v_mfma_f32_16x16x32_bf16 v[56:59], a[200:203], v[128:131], v[56:59]
    buffer_store_dword v141, v33, s[12:15], s83 offen offset:64
    v_mfma_f32_16x16x32_bf16 v[60:63], a[204:207], v[128:131], v[60:63]
    s_waitcnt vmcnt(10)
    v_add_f32_dpp v144, v144, v144 row_ror:8 row_mask:0xf bank_mask:0xf
    ds_bpermute_b32 v145, v30, v144
    v_mfma_f32_16x16x32_bf16 v[48:51], a[208:211], v[132:135], v[48:51]
    s_mov_b32 s83, s82
    buffer_load_dwordx4 v[104:107], v25, s[4:7], s60 offen offset:2048 sc1
    v_mfma_f32_16x16x32_bf16 v[52:55], a[212:215], v[132:135], v[52:55]
    v_mfma_f32_16x16x32_bf16 v[56:59], a[216:219], v[132:135], v[56:59]
    v_mfma_f32_16x16x32_bf16 v[60:63], a[220:223], v[132:135], v[60:63]
    s_waitcnt lgkmcnt(0)
    buffer_store_dword v145, v34, s[16:19], s67 offen
    s_lshr_b32 s67, s82, 4
    s_waitcnt vmcnt(9)
    v_mfma_f32_16x16x32_bf16 v[64:67], a[0:3], v[80:83], 0
    ds_read_b64 v[40:41], v28
    v_mfma_f32_16x16x32_bf16 v[68:71], a[4:7], v[80:83], 0
    ds_write_b128 v29, v[48:51] offset:0
    v_mfma_f32_16x16x32_bf16 v[72:75], a[8:11], v[80:83], 0
    s_waitcnt vmcnt(8)
    buffer_load_dword v4, v5, s[4:7], s65 offen sc1
    v_mfma_f32_16x16x32_bf16 v[64:67], a[16:19], v[84:87], v[64:67]
    buffer_load_dwordx4 v[108:111], v25, s[4:7], s60 offen offset:3072 sc1
    v_mfma_f32_16x16x32_bf16 v[68:71], a[20:23], v[84:87], v[68:71]
    v_mfma_f32_16x16x32_bf16 v[72:75], a[24:27], v[84:87], v[72:75]
    s_waitcnt vmcnt(9)
    ds_write_b128 v29, v[52:55] offset:64
    v_mfma_f32_16x16x32_bf16 v[64:67], a[32:35], v[88:91], v[64:67]
    s_waitcnt lgkmcnt(2)
    v_lshlrev_b32 v76, 16, v40
    v_and_b32 v77, 0xffff0000, v40
    v_mfma_f32_16x16x32_bf16 v[68:71], a[36:39], v[88:91], v[68:71]
    v_lshlrev_b32 v78, 16, v41
    v_and_b32 v79, 0xffff0000, v41
    v_mfma_f32_16x16x32_bf16 v[72:75], a[40:43], v[88:91], v[72:75]
    buffer_load_dwordx4 v[112:115], v26, s[4:7], s60 offen offset:0 sc1
    v_mfma_f32_16x16x32_bf16 v[76:79], a[12:15], v[80:83], v[76:79]
    buffer_load_dwordx4 v[116:119], v26, s[4:7], s60 offen offset:1024 sc1
    v_mfma_f32_16x16x32_bf16 v[76:79], a[28:31], v[84:87], v[76:79]
    ds_write_b128 v29, v[56:59] offset:128
    v_mfma_f32_16x16x32_bf16 v[76:79], a[44:47], v[88:91], v[76:79]
    s_waitcnt vmcnt(10)
    v_mfma_f32_16x16x32_bf16 v[64:67], a[48:51], v[92:95], v[64:67]
    buffer_load_dwordx4 v[120:123], v26, s[4:7], s60 offen offset:2048 sc1
    v_mfma_f32_16x16x32_bf16 v[68:71], a[52:55], v[92:95], v[68:71]
    ds_write_b128 v29, v[60:63] offset:192
    v_mfma_f32_16x16x32_bf16 v[72:75], a[56:59], v[92:95], v[72:75]
    s_waitcnt vmcnt(5)
    v_add_u32 v7, 1, v7
    v_mfma_f32_16x16x32_bf16 v[76:79], a[60:63], v[92:95], v[76:79]
    buffer_store_dword v7, v6, s[4:7], s65 offen
    v_mfma_f32_16x16x32_bf16 v[64:67], a[64:67], v[96:99], v[64:67]
    buffer_load_dwordx4 v[124:127], v26, s[4:7], s60 offen offset:3072 sc1
    v_mfma_f32_16x16x32_bf16 v[68:71], a[68:71], v[96:99], v[68:71]
    v_mfma_f32_16x16x32_bf16 v[72:75], a[72:75], v[96:99], v[72:75]
    v_mfma_f32_16x16x32_bf16 v[76:79], a[76:79], v[96:99], v[76:79]
    s_waitcnt lgkmcnt(0)
    s_barrier
    v_mfma_f32_16x16x32_bf16 v[64:67], a[80:83], v[100:103], v[64:67]
    buffer_load_dwordx4 v[128:131], v27, s[4:7], s60 offen offset:0 sc1
    v_mfma_f32_16x16x32_bf16 v[68:71], a[84:87], v[100:103], v[68:71]
    ds_read2_b64 v[136:139], v220 offset0:16 offset1:0
    ds_read2_b64 v[140:143], v221 offset0:16 offset1:0
    v_mfma_f32_16x16x32_bf16 v[72:75], a[88:91], v[100:103], v[72:75]
    buffer_load_dwordx4 v[132:135], v27, s[4:7], s60 offen offset:1024 sc1
    v_mfma_f32_16x16x32_bf16 v[76:79], a[92:95], v[100:103], v[76:79]
    ds_read2_b64 v[144:147], v222 offset0:0 offset1:16
    ds_read2_b64 v[148:151], v223 offset0:0 offset1:16
    v_mfma_f32_16x16x32_bf16 v[64:67], a[96:99], v[104:107], v[64:67]
    s_waitcnt vmcnt(8)
    v_cmp_gt_i32 vcc, s58, v4
    s_add_u32 s60, s60, 131072
    v_mfma_f32_16x16x32_bf16 v[68:71], a[100:103], v[104:107], v[68:71]
    s_andn2_b32 s60, s60, 262144
    v_mfma_f32_16x16x32_bf16 v[72:75], a[104:107], v[104:107], v[72:75]
    s_cbranch_vccnz L_spin_dnodd_fast
L_ret_dnodd_fast:
    buffer_load_dword v31, s[12:15], s66 offen offset:0 sc1 lds
    v_mfma_f32_16x16x32_bf16 v[76:79], a[108:111], v[104:107], v[76:79]
    s_waitcnt vmcnt(8)
    buffer_load_dword v32, s[12:15], s66 offen offset:256 sc1 lds
    v_mfma_f32_16x16x32_bf16 v[64:67], a[112:115], v[108:111], v[64:67]
    s_add_u32 s58, s58, 1
    buffer_load_dwordx4 v[80:83], v24, s[4:7], s59 offen offset:0 sc1
    v_mfma_f32_16x16x32_bf16 v[68:71], a[116:119], v[108:111], v[68:71]
    s_mov_b32 s82, s66
    s_waitcnt lgkmcnt(2)
    v_add_f32 v136, v136, v140
    v_mfma_f32_16x16x32_bf16 v[72:75], a[120:123], v[108:111], v[72:75]
    s_add_u32 s66, s66, 16384
    v_add_f32 v137, v137, v141
    v_add_f32 v138, v138, v142
    v_mfma_f32_16x16x32_bf16 v[76:79], a[124:127], v[108:111], v[76:79]
    s_waitcnt vmcnt(9)
    buffer_load_dwordx4 v[84:87], v24, s[4:7], s59 offen offset:1024 sc1
    v_mfma_f32_16x16x32_bf16 v[64:67], a[128:131], v[112:115], v[64:67]
    s_and_b32 s66, s66, 0x1fffff
    v_add_f32 v139, v139, v143
    v_mfma_f32_16x16x32_bf16 v[68:71], a[132:135], v[112:115], v[68:71]
    s_waitcnt lgkmcnt(0)
    v_add_f32 v144, v144, v148
    v_add_f32 v145, v145, v149
    v_mfma_f32_16x16x32_bf16 v[72:75], a[136:139], v[112:115], v[72:75]
    buffer_load_dwordx4 v[88:91], v24, s[4:7], s59 offen offset:2048 sc1
    v_mfma_f32_16x16x32_bf16 v[76:79], a[140:143], v[112:115], v[76:79]
    s_waitcnt vmcnt(10)
    v_add_f32 v146, v146, v150
    v_add_f32 v147, v147, v151
    v_mfma_f32_16x16x32_bf16 v[64:67], a[144:147], v[116:119], v[64:67]
    v_add_f32 v136, v136, v144
    v_add_f32 v137, v137, v145
    v_mfma_f32_16x16x32_bf16 v[68:71], a[148:151], v[116:119], v[68:71]
    v_add_f32 v138, v138, v146
    v_add_f32 v139, v139, v147
    v_mfma_f32_16x16x32_bf16 v[72:75], a[152:155], v[116:119], v[72:75]
    buffer_load_dwordx4 v[92:95], v24, s[4:7], s59 offen offset:3072 sc1
    v_mfma_f32_16x16x32_bf16 v[76:79], a[156:159], v[116:119], v[76:79]
    s_waitcnt vmcnt(10)
    v_add_f32 v144, v136, v137
    v_mul_f32 v145, v136, v136
    v_mfma_f32_16x16x32_bf16 v[64:67], a[160:163], v[120:123], v[64:67]
    v_fmac_f32 v145, v137, v137
    v_add_f32 v144, v144, v138
    v_mfma_f32_16x16x32_bf16 v[68:71], a[164:167], v[120:123], v[68:71]
    buffer_load_dwordx4 v[96:99], v25, s[4:7], s59 offen offset:0 sc1
    v_mfma_f32_16x16x32_bf16 v[72:75], a[168:171], v[120:123], v[72:75]
    v_fmac_f32 v145, v138, v138
    v_add_f32 v144, v144, v139
    v_mfma_f32_16x16x32_bf16 v[76:79], a[172:175], v[120:123], v[76:79]
    s_waitcnt vmcnt(9)
    v_fmac_f32 v145, v139, v139
    v_add_f32_dpp v144, v144, v144 quad_perm:[1,0,3,2] row_mask:0xf bank_mask:0xf
    v_mfma_f32_16x16x32_bf16 v[64:67], a[176:179], v[124:127], v[64:67]
    v_add_f32_dpp v145, v145, v145 quad_perm:[1,0,3,2] row_mask:0xf bank_mask:0xf
    v_cndmask_b32 v144, v144, v145, s[28:29]
    v_mfma_f32_16x16x32_bf16 v[68:71], a[180:183], v[124:127], v[68:71]
    buffer_load_dwordx4 v[100:103], v25, s[4:7], s59 offen offset:1024 sc1
    v_mfma_f32_16x16x32_bf16 v[72:75], a[184:187], v[124:127], v[72:75]
    v_add_f32_dpp v144, v144, v144 row_ror:2 row_mask:0xf bank_mask:0xf
    v_cvt_pk_bf16_f32 v140, v136, v137
    v_mfma_f32_16x16x32_bf16 v[76:79], a[188:191], v[124:127], v[76:79]
    s_waitcnt vmcnt(9)
    v_cvt_pk_bf16_f32 v141, v138, v139
    v_mfma_f32_16x16x32_bf16 v[64:67], a[192:195], v[128:131], v[64:67]
    v_add_f32_dpp v144, v144, v144 row_ror:4 row_mask:0xf bank_mask:0xf
    v_mfma_f32_16x16x32_bf16 v[68:71], a[196:199], v[128:131], v[68:71]
    buffer_store_dword v140, v33, s[12:15], s83 offen offset:0
    v_mfma_f32_16x16x32_bf16 v[72:75], a[200:203], v[128:131], v[72:75]
    buffer_store_dword v141, v33, s[12:15], s83 offen offset:64
    v_mfma_f32_16x16x32_bf16 v[76:79], a[204:207], v[128:131], v[76:79]
    s_waitcnt vmcnt(10)
    v_add_f32_dpp v144, v144, v144 row_ror:8 row_mask:0xf bank_mask:0xf
    ds_bpermute_b32 v145, v30, v144
    v_mfma_f32_16x16x32_bf16 v[64:67], a[208:211], v[132:135], v[64:67]
    s_mov_b32 s83, s76
    buffer_load_dwordx4 v[104:107], v25, s[4:7], s59 offen offset:2048 sc1
    v_mfma_f32_16x16x32_bf16 v[68:71], a[212:215], v[132:135], v[68:71]
    v_mfma_f32_16x16x32_bf16 v[72:75], a[216:219], v[132:135], v[72:75]
    v_mfma_f32_16x16x32_bf16 v[76:79], a[220:223], v[132:135], v[76:79]
    s_waitcnt lgkmcnt(0)
    buffer_store_dword v145, v34, s[16:19], s67 offen
    s_lshr_b32 s67, s76, 4
    s_sub_u32 s61, s61, 1
    s_cmp_lg_u32 s61, 0
    s_cbranch_scc1 L_dn_loop_fast
    s_mov_b32 s61, 7
.p2align 4
L_dn_loop2_fast:
    s_waitcnt vmcnt(8)
    v_mfma_f32_16x16x32_bf16 v[48:51], a[0:3], v[80:83], 0
    ds_read_b64 v[40:41], v28
    v_mfma_f32_16x16x32_bf16 v[52:55], a[4:7], v[80:83], 0
    ds_write_b128 v29, v[64:67] offset:17408
    v_mfma_f32_16x16x32_bf16 v[56:59], a[8:11], v[80:83], 0
    s_waitcnt vmcnt(7)
    buffer_load_dword v4, v5, s[4:7], s65 offen sc1
    v_mfma_f32_16x16x32_bf16 v[48:51], a[16:19], v[84:87], v[48:51]
    buffer_load_dwordx4 v[108:111], v25, s[4:7], s59 offen offset:3072 sc1
    v_mfma_f32_16x16x32_bf16 v[52:55], a[20:23], v[84:87], v[52:55]
    v_mfma_f32_16x16x32_bf16 v[56:59], a[24:27], v[84:87], v[56:59]
    s_waitcnt vmcnt(8)
    ds_write_b128 v29, v[68:71] offset:17472
    v_mfma_f32_16x16x32_bf16 v[48:51], a[32:35], v[88:91], v[48:51]
    s_waitcnt lgkmcnt(2)
    v_lshlrev_b32 v60, 16, v40
    v_and_b32 v61, 0xffff0000, v40
    v_mfma_f32_16x16x32_bf16 v[52:55], a[36:39], v[88:91], v[52:55]
    v_lshlrev_b32 v62, 16, v41
    v_and_b32 v63, 0xffff0000, v41
    v_mfma_f32_16x16x32_bf16 v[56:59], a[40:43], v[88:91], v[56:59]
    buffer_load_dwordx4 v[112:115], v26, s[4:7], s59 offen offset:0 sc1
    v_mfma_f32_16x16x32_bf16 v[60:63], a[12:15], v[80:83], v[60:63]
    buffer_load_dwordx4 v[116:119], v26, s[4:7], s59 offen offset:1024 sc1
    v_mfma_f32_16x16x32_bf16 v[60:63], a[28:31], v[84:87], v[60:63]
    v_add_u32 v7, 1, v7
    v_mfma_f32_16x16x32_bf16 v[60:63], a[44:47], v[88:91], v[60:63]
    s_waitcnt vmcnt(7)
    ds_write_b128 v29, v[72:75] offset:17536
    v_mfma_f32_16x16x32_bf16 v[48:51], a[48:51], v[92:95], v[48:51]
    buffer_store_dword v7, v6, s[4:7], s65 offen
    v_mfma_f32_16x16x32_bf16 v[52:55], a[52:55], v[92:95], v[52:55]
    ds_write_b128 v29, v[76:79] offset:17600
    v_mfma_f32_16x16x32_bf16 v[56:59], a[56:59], v[92:95], v[56:59]
    buffer_load_dwordx4 v[120:123], v26, s[4:7], s59 offen offset:2048 sc1
    v_mfma_f32_16x16x32_bf16 v[60:63], a[60:63], v[92:95], v[60:63]
    s_waitcnt vmcnt(8)
    v_mfma_f32_16x16x32_bf16 v[48:51], a[64:67], v[96:99], v[48:51]
    v_mfma_f32_16x16x32_bf16 v[52:55], a[68:71], v[96:99], v[52:55]
    buffer_load_dwordx4 v[124:127], v26, s[4:7], s59 offen offset:3072 sc1
    v_mfma_f32_16x16x32_bf16 v[56:59], a[72:75], v[96:99], v[56:59]
    v_mfma_f32_16x16x32_bf16 v[60:63], a[76:79], v[96:99], v[60:63]
    s_waitcnt vmcnt(8)
    s_waitcnt lgkmcnt(0)
    s_barrier
    v_mfma_f32_16x16x32_bf16 v[48:51], a[80:83], v[100:103], v[48:51]
    buffer_load_dwordx4 v[128:131], v27, s[4:7], s59 offen offset:0 sc1
    v_mfma_f32_16x16x32_bf16 v[52:55], a[84:87], v[100:103], v[52:55]
    ds_read2_b64 v[136:139], v224 offset0:16 offset1:0
    ds_read2_b64 v[140:143], v225 offset0:16 offset1:0
    v_mfma_f32_16x16x32_bf16 v[56:59], a[88:91], v[100:103], v[56:59]
    buffer_load_dwordx4 v[132:135], v27, s[4:7], s59 offen offset:1024 sc1
    v_mfma_f32_16x16x32_bf16 v[60:63], a[92:95], v[100:103], v[60:63]
    s_waitcnt vmcnt(9)
    ds_read2_b64 v[144:147], v226 offset0:0 offset1:16
    ds_read2_b64 v[148:151], v227 offset0:0 offset1:16
    v_mfma_f32_16x16x32_bf16 v[48:51], a[96:99], v[104:107], v[48:51]
    s_waitcnt vmcnt(8)
    v_cmp_gt_i32 vcc, s58, v4
    s_add_u32 s59, s59, 131072
    v_mfma_f32_16x16x32_bf16 v[52:55], a[100:103], v[104:107], v[52:55]
    s_andn2_b32 s59, s59, 262144
    v_mfma_f32_16x16x32_bf16 v[56:59], a[104:107], v[104:107], v[56:59]
    s_cbranch_vccnz L_spin_dneven2_fast
L_ret_dneven2_fast:
    buffer_load_dword v31, s[12:15], s66 offen offset:0 sc1 lds
    v_mfma_f32_16x16x32_bf16 v[60:63], a[108:111], v[104:107], v[60:63]
    s_waitcnt vmcnt(8)
    buffer_load_dword v32, s[12:15], s66 offen offset:256 sc1 lds
    v_mfma_f32_16x16x32_bf16 v[48:51], a[112:115], v[108:111], v[48:51]
    s_add_u32 s58, s58, 1
    buffer_load_dwordx4 v[80:83], v24, s[4:7], s60 offen offset:0 sc1
    v_mfma_f32_16x16x32_bf16 v[52:55], a[116:119], v[108:111], v[52:55]
    s_mov_b32 s76, s66
    s_waitcnt lgkmcnt(2)
    v_add_f32 v136, v136, v140
    v_mfma_f32_16x16x32_bf16 v[56:59], a[120:123], v[108:111], v[56:59]
    s_add_u32 s66, s66, 16384
    v_add_f32 v137, v137, v141
    v_add_f32 v138, v138, v142
    v_mfma_f32_16x16x32_bf16 v[60:63], a[124:127], v[108:111], v[60:63]
    s_waitcnt vmcnt(9)
    v_add_f32 v139, v139, v143
    s_and_b32 s66, s66, 0x1fffff
    v_mfma_f32_16x16x32_bf16 v[48:51], a[128:131], v[112:115], v[48:51]
    s_cmp_eq_u32 s58, 34
    s_cselect_b32 s66, 0x40000000, s66
    buffer_load_dwordx4 v[84:87], v24, s[4:7], s60 offen offset:1024 sc1
    v_mfma_f32_16x16x32_bf16 v[52:55], a[132:135], v[112:115], v[52:55]
    s_waitcnt lgkmcnt(0)
    v_add_f32 v144, v144, v148
    v_add_f32 v145, v145, v149
    v_mfma_f32_16x16x32_bf16 v[56:59], a[136:139], v[112:115], v[56:59]
    v_add_f32 v146, v146, v150
    v_add_f32 v147, v147, v151
    v_mfma_f32_16x16x32_bf16 v[60:63], a[140:143], v[112:115], v[60:63]
    s_waitcnt vmcnt(9)
    buffer_load_dwordx4 v[88:91], v24, s[4:7], s60 offen offset:2048 sc1
    v_mfma_f32_16x16x32_bf16 v[48:51], a[144:147], v[116:119], v[48:51]
    v_add_f32 v136, v136, v144
    v_add_f32 v137, v137, v145
    v_mfma_f32_16x16x32_bf16 v[52:55], a[148:151], v[116:119], v[52:55]
    v_add_f32 v138, v138, v146
    v_add_f32 v139, v139, v147
    v_mfma_f32_16x16x32_bf16 v[56:59], a[152:155], v[116:119], v[56:59]
    v_cvt_pk_bf16_f32 v140, v136, v137
    v_cvt_pk_bf16_f32 v141, v138, v139
    v_mfma_f32_16x16x32_bf16 v[60:63], a[156:159], v[116:119], v[60:63]
    s_waitcnt vmcnt(8)
    buffer_store_dword v140, v33, s[12:15], s83 offen offset:0
    v_mfma_f32_16x16x32_bf16 v[48:51], a[160:163], v[120:123], v[48:51]
    v_mfma_f32_16x16x32_bf16 v[52:55], a[164:167], v[120:123], v[52:55]
    buffer_store_dword v141, v33, s[12:15], s83 offen offset:64
    v_mfma_f32_16x16x32_bf16 v[56:59], a[168:171], v[120:123], v[56:59]
    s_mov_b32 s83, s82
    v_mfma_f32_16x16x32_bf16 v[60:63], a[172:175], v[120:123], v[60:63]
    s_waitcnt vmcnt(9)
    buffer_load_dwordx4 v[92:95], v24, s[4:7], s60 offen offset:3072 sc1
    v_mfma_f32_16x16x32_bf16 v[48:51], a[176:179], v[124:127], v[48:51]
    v_mfma_f32_16x16x32_bf16 v[52:55], a[180:183], v[124:127], v[52:55]
    v_mfma_f32_16x16x32_bf16 v[56:59], a[184:187], v[124:127], v[56:59]
    v_mfma_f32_16x16x32_bf16 v[60:63], a[188:191], v[124:127], v[60:63]
    s_waitcnt vmcnt(9)
    buffer_load_dwordx4 v[96:99], v25, s[4:7], s60 offen offset:0 sc1
    v_mfma_f32_16x16x32_bf16 v[48:51], a[192:195], v[128:131], v[48:51]
    v_mfma_f32_16x16x32_bf16 v[52:55], a[196:199], v[128:131], v[52:55]
    v_mfma_f32_16x16x32_bf16 v[56:59], a[200:203], v[128:131], v[56:59]
    buffer_load_dwordx4 v[100:103], v25, s[4:7], s60 offen offset:1024 sc1
    v_mfma_f32_16x16x32_bf16 v[60:63], a[204:207], v[128:131], v[60:63]
    s_waitcnt vmcnt(10)
    v_mfma_f32_16x16x32_bf16 v[48:51], a[208:211], v[132:135], v[48:51]
    v_mfma_f32_16x16x32_bf16 v[52:55], a[212:215], v[132:135], v[52:55]
    v_mfma_f32_16x16x32_bf16 v[56:59], a[216:219], v[132:135], v[56:59]
    buffer_load_dwordx4 v[104:107], v25, s[4:7], s60 offen offset:2048 sc1
    v_mfma_f32_16x16x32_bf16 v[60:63], a[220:223], v[132:135], v[60:63]
    s_waitcnt vmcnt(8)
    v_mfma_f32_16x16x32_bf16 v[64:67], a[0:3], v[80:83], 0
    ds_read_b64 v[40:41], v28
    v_mfma_f32_16x16x32_bf16 v[68:71], a[4:7], v[80:83], 0
    ds_write_b128 v29, v[48:51] offset:0
    v_mfma_f32_16x16x32_bf16 v[72:75], a[8:11], v[80:83], 0
    s_waitcnt vmcnt(7)
    buffer_load_dword v4, v5, s[4:7], s65 offen sc1
    v_mfma_f32_16x16x32_bf16 v[64:67], a[16:19], v[84:87], v[64:67]
    buffer_load_dwordx4 v[108:111], v25, s[4:7], s60 offen offset:3072 sc1
    v_mfma_f32_16x16x32_bf16 v[68:71], a[20:23], v[84:87], v[68:71]
    v_mfma_f32_16x16x32_bf16 v[72:75], a[24:27], v[84:87], v[72:75]
    s_waitcnt vmcnt(8)
    ds_write_b128 v29, v[52:55] offset:64
    v_mfma_f32_16x16x32_bf16 v[64:67], a[32:35], v[88:91], v[64:67]
    s_waitcnt lgkmcnt(2)
    v_lshlrev_b32 v76, 16, v40
    v_and_b32 v77, 0xffff0000, v40
    v_mfma_f32_16x16x32_bf16 v[68:71], a[36:39], v[88:91], v[68:71]
    v_lshlrev_b32 v78, 16, v41
    v_and_b32 v79, 0xffff0000, v41
    v_mfma_f32_16x16x32_bf16 v[72:75], a[40:43], v[88:91], v[72:75]
    buffer_load_dwordx4 v[112:115], v26, s[4:7], s60 offen offset:0 sc1
    v_mfma_f32_16x16x32_bf16 v[76:79], a[12:15], v[80:83], v[76:79]
    buffer_load_dwordx4 v[116:119], v26, s[4:7], s60 offen offset:1024 sc1
    v_mfma_f32_16x16x32_bf16 v[76:79], a[28:31], v[84:87], v[76:79]
    v_add_u32 v7, 1, v7
    v_mfma_f32_16x16x32_bf16 v[76:79], a[44:47], v[88:91], v[76:79]
    s_waitcnt vmcnt(7)
    ds_write_b128 v29, v[56:59] offset:128
    v_mfma_f32_16x16x32_bf16 v[64:67], a[48:51], v[92:95], v[64:67]
    buffer_store_dword v7, v6, s[4:7], s65 offen
    v_mfma_f32_16x16x32_bf16 v[68:71], a[52:55], v[92:95], v[68:71]
    ds_write_b128 v29, v[60:63] offset:192
    v_mfma_f32_16x16x32_bf16 v[72:75], a[56:59], v[92:95], v[72:75]
    buffer_load_dwordx4 v[120:123], v26, s[4:7], s60 offen offset:2048 sc1
    v_mfma_f32_16x16x32_bf16 v[76:79], a[60:63], v[92:95], v[76:79]
    s_waitcnt vmcnt(8)
    v_mfma_f32_16x16x32_bf16 v[64:67], a[64:67], v[96:99], v[64:67]
    v_mfma_f32_16x16x32_bf16 v[68:71], a[68:71], v[96:99], v[68:71]
    buffer_load_dwordx4 v[124:127], v26, s[4:7], s60 offen offset:3072 sc1
    v_mfma_f32_16x16x32_bf16 v[72:75], a[72:75], v[96:99], v[72:75]
    v_mfma_f32_16x16x32_bf16 v[76:79], a[76:79], v[96:99], v[76:79]
    s_waitcnt vmcnt(8)
    s_waitcnt lgkmcnt(0)
    s_barrier
    v_mfma_f32_16x16x32_bf16 v[64:67], a[80:83], v[100:103], v[64:67]
    buffer_load_dwordx4 v[128:131], v27, s[4:7], s60 offen offset:0 sc1
    v_mfma_f32_16x16x32_bf16 v[68:71], a[84:87], v[100:103], v[68:71]
    ds_read2_b64 v[136:139], v220 offset0:16 offset1:0
    ds_read2_b64 v[140:143], v221 offset0:16 offset1:0
    v_mfma_f32_16x16x32_bf16 v[72:75], a[88:91], v[100:103], v[72:75]
    buffer_load_dwordx4 v[132:135], v27, s[4:7], s60 offen offset:1024 sc1
    v_mfma_f32_16x16x32_bf16 v[76:79], a[92:95], v[100:103], v[76:79]
    s_waitcnt vmcnt(9)
    ds_read2_b64 v[144:147], v222 offset0:0 offset1:16
    ds_read2_b64 v[148:151], v223 offset0:0 offset1:16
    v_mfma_f32_16x16x32_bf16 v[64:67], a[96:99], v[104:107], v[64:67]
    s_waitcnt vmcnt(8)
    v_cmp_gt_i32 vcc, s58, v4
    s_add_u32 s60, s60, 131072
    v_mfma_f32_16x16x32_bf16 v[68:71], a[100:103], v[104:107], v[68:71]
    s_andn2_b32 s60, s60, 262144
    v_mfma_f32_16x16x32_bf16 v[72:75], a[104:107], v[104:107], v[72:75]
    s_cbranch_vccnz L_spin_dnodd2_fast
L_ret_dnodd2_fast:
    buffer_load_dword v31, s[12:15], s66 offen offset:0 sc1 lds
    v_mfma_f32_16x16x32_bf16 v[76:79], a[108:111], v[104:107], v[76:79]
    s_waitcnt vmcnt(8)
    buffer_load_dword v32, s[12:15], s66 offen offset:256 sc1 lds
    v_mfma_f32_16x16x32_bf16 v[64:67], a[112:115], v[108:111], v[64:67]
    s_add_u32 s58, s58, 1
    buffer_load_dwordx4 v[80:83], v24, s[4:7], s59 offen offset:0 sc1
    v_mfma_f32_16x16x32_bf16 v[68:71], a[116:119], v[108:111], v[68:71]
    s_mov_b32 s82, s66
    s_waitcnt lgkmcnt(2)
    v_add_f32 v136, v136, v140
    v_mfma_f32_16x16x32_bf16 v[72:75], a[120:123], v[108:111], v[72:75]
    s_add_u32 s66, s66, 16384
    v_add_f32 v137, v137, v141
    v_add_f32 v138, v138, v142
    v_mfma_f32_16x16x32_bf16 v[76:79], a[124:127], v[108:111], v[76:79]
    s_waitcnt vmcnt(9)
    v_add_f32 v139, v139, v143
    s_and_b32 s66, s66, 0x1fffff
    v_mfma_f32_16x16x32_bf16 v[64:67], a[128:131], v[112:115], v[64:67]
    s_waitcnt lgkmcnt(0)
    buffer_load_dwordx4 v[84:87], v24, s[4:7], s59 offen offset:1024 sc1
    v_mfma_f32_16x16x32_bf16 v[68:71], a[132:135], v[112:115], v[68:71]
    v_add_f32 v144, v144, v148
    v_add_f32 v145, v145, v149
    v_mfma_f32_16x16x32_bf16 v[72:75], a[136:139], v[112:115], v[72:75]
    v_add_f32 v146, v146, v150
    v_add_f32 v147, v147, v151
    v_mfma_f32_16x16x32_bf16 v[76:79], a[140:143], v[112:115], v[76:79]
    s_waitcnt vmcnt(9)
    buffer_load_dwordx4 v[88:91], v24, s[4:7], s59 offen offset:2048 sc1
    v_mfma_f32_16x16x32_bf16 v[64:67], a[144:147], v[116:119], v[64:67]
    v_add_f32 v136, v136, v144
    v_add_f32 v137, v137, v145
    v_mfma_f32_16x16x32_bf16 v[68:71], a[148:151], v[116:119], v[68:71]
    v_add_f32 v138, v138, v146
    v_add_f32 v139, v139, v147
    v_mfma_f32_16x16x32_bf16 v[72:75], a[152:155], v[116:119], v[72:75]
    v_cvt_pk_bf16_f32 v140, v136, v137
    v_cvt_pk_bf16_f32 v141, v138, v139
    v_mfma_f32_16x16x32_bf16 v[76:79], a[156:159], v[116:119], v[76:79]
    s_waitcnt vmcnt(8)
    buffer_store_dword v140, v33, s[12:15], s83 offen offset:0
    v_mfma_f32_16x16x32_bf16 v[64:67], a[160:163], v[120:123], v[64:67]
    v_mfma_f32_16x16x32_bf16 v[68:71], a[164:167], v[120:123], v[68:71]
    buffer_store_dword v141, v33, s[12:15], s83 offen offset:64
    v_mfma_f32_16x16x32_bf16 v[72:75], a[168:171], v[120:123], v[72:75]
    s_mov_b32 s83, s76
    v_mfma_f32_16x16x32_bf16 v[76:79], a[172:175], v[120:123], v[76:79]
    s_waitcnt vmcnt(9)
    buffer_load_dwordx4 v[92:95], v24, s[4:7], s59 offen offset:3072 sc1
    v_mfma_f32_16x16x32_bf16 v[64:67], a[176:179], v[124:127], v[64:67]
    v_mfma_f32_16x16x32_bf16 v[68:71], a[180:183], v[124:127], v[68:71]
    v_mfma_f32_16x16x32_bf16 v[72:75], a[184:187], v[124:127], v[72:75]
    v_mfma_f32_16x16x32_bf16 v[76:79], a[188:191], v[124:127], v[76:79]
    s_waitcnt vmcnt(9)
    buffer_load_dwordx4 v[96:99], v25, s[4:7], s59 offen offset:0 sc1
    v_mfma_f32_16x16x32_bf16 v[64:67], a[192:195], v[128:131], v[64:67]
    v_mfma_f32_16x16x32_bf16 v[68:71], a[196:199], v[128:131], v[68:71]
    v_mfma_f32_16x16x32_bf16 v[72:75], a[200:203], v[128:131], v[72:75]
    buffer_load_dwordx4 v[100:103], v25, s[4:7], s59 offen offset:1024 sc1
    v_mfma_f32_16x16x32_bf16 v[76:79], a[204:207], v[128:131], v[76:79]
    s_waitcnt vmcnt(10)
    v_mfma_f32_16x16x32_bf16 v[64:67], a[208:211], v[132:135], v[64:67]
    v_mfma_f32_16x16x32_bf16 v[68:71], a[212:215], v[132:135], v[68:71]
    s_sub_u32 s61, s61, 1
    v_mfma_f32_16x16x32_bf16 v[72:75], a[216:219], v[132:135], v[72:75]
    s_cmp_lg_u32 s61, 0
    buffer_load_dwordx4 v[104:107], v25, s[4:7], s59 offen offset:2048 sc1
    v_mfma_f32_16x16x32_bf16 v[76:79], a[220:223], v[132:135], v[76:79]
    s_cbranch_scc1 L_dn_loop2_fast
    s_nop 0
    ds_write_b128 v29, v[64:67] offset:17408
    ds_write_b128 v29, v[68:71] offset:17472
    s_nop 0
    ds_write_b128 v29, v[72:75] offset:17536
    s_nop 1
    ds_write_b128 v29, v[76:79] offset:17600
    s_waitcnt lgkmcnt(0)
    s_barrier
    ds_read2_b64 v[136:139], v224 offset0:16 offset1:0
    ds_read2_b64 v[140:143], v225 offset0:16 offset1:0
    ds_read2_b64 v[144:147], v226 offset0:0 offset1:16
    ds_read2_b64 v[148:151], v227 offset0:0 offset1:16
    s_waitcnt lgkmcnt(2)
    v_add_f32 v136, v136, v140
    v_add_f32 v137, v137, v141
    v_add_f32 v138, v138, v142
    v_add_f32 v139, v139, v143
    s_waitcnt lgkmcnt(0)
    v_add_f32 v144, v144, v148
    v_add_f32 v145, v145, v149
    v_add_f32 v146, v146, v150
    v_add_f32 v147, v147, v151
    v_add_f32 v136, v136, v144
    v_add_f32 v137, v137, v145
    v_add_f32 v138, v138, v146
    v_add_f32 v139, v139, v147
    v_cvt_pk_bf16_f32 v140, v136, v137
    v_cvt_pk_bf16_f32 v141, v138, v139
    buffer_store_dword v140, v33, s[12:15], s83 offen offset:0
    buffer_store_dword v141, v33, s[12:15], s83 offen offset:64
    s_endpgm
L_hs_2:
    s_sub_u32 s56, s56, 1
    s_cbranch_scc1 L_exit
    s_sleep 1
    s_lshl_b32 s63, s3, 2
    v_mov_b32 v8, s63
    buffer_load_dword v4, v8, s[20:23], 0 offen sc1
    s_waitcnt vmcnt(0)
    v_cmp_eq_u32 vcc, 0, v4
    s_cbranch_vccnz L_hs_2
    s_branch L_hsret_3
L_hsmm_4:
    s_mov_b32 s63, 896
    v_mov_b32 v8, s63
    v_mov_b32 v9, 0x80000000
    v_cmp_eq_u32 vcc, 0, v0
    s_nop 1
    v_cndmask_b32 v8, v9, v8, vcc
    v_mov_b32 v9, 0
    buffer_store_dword v9, v8, s[4:7], s79 offen sc1
    s_waitcnt vmcnt(0)
    s_add_u32 s65, s79, 1024
    s_mov_b32 s74, 1
    s_branch L_hsok_5
L_spin_qkv_pro:
L_spin_qkv_pro_l:
    s_sub_u32 s56, s56, 1
    s_cbranch_scc1 L_exit
    buffer_load_dword v4, v5, s[4:7], s65 offen sc1
    s_waitcnt vmcnt(0)
    v_add_u32 v4, v4, v250
    v_cmp_gt_i32 vcc, s58, v4
    s_cbranch_vccz L_ret_qkv_pro
    s_and_b32 s63, s56, 63
    s_cbranch_scc1 L_spin_qkv_pro_l
    v_mov_b32 v8, 896
    buffer_load_dword v4, v8, s[4:7], s65 offen sc1
    s_waitcnt vmcnt(0)
    v_cmp_ne_u32 vcc, 0, v4
    s_cbranch_vccnz L_spin_qkv_pro_l
    buffer_wbl2 sc1
    s_waitcnt vmcnt(0)
    s_add_u32 s65, s79, 1024
    s_mov_b32 s74, 1
    buffer_store_dword v7, v6, s[4:7], s65 offen sc1
    s_branch L_spin_qkv_pro_l
L_spin_qkv0_fast:
L_spin_qkv0_fast_l:
    s_sub_u32 s56, s56, 1
    s_cbranch_scc1 L_exit
    buffer_load_dword v4, v5, s[4:7], s65 offen sc1
    s_waitcnt vmcnt(0)
    v_add_u32 v4, v4, v250
    v_cmp_gt_i32 vcc, s58, v4
    s_cbranch_vccz L_ret_qkv0_fast
    s_and_b32 s63, s56, 63
    s_cbranch_scc1 L_spin_qkv0_fast_l
    v_mov_b32 v8, 896
    buffer_load_dword v4, v8, s[4:7], s65 offen sc1
    s_waitcnt vmcnt(0)
    v_cmp_ne_u32 vcc, 0, v4
    s_cbranch_vccnz L_spin_qkv0_fast_l
    buffer_wbl2 sc1
    s_waitcnt vmcnt(0)
    s_add_u32 s65, s79, 1024
    s_mov_b32 s74, 1
    buffer_store_dword v7, v6, s[4:7], s65 offen sc1
    s_branch L_spin_qkv0_slow
L_spin_qkv1_fast:
L_spin_qkv1_fast_l:
    s_sub_u32 s56, s56, 1
    s_cbranch_scc1 L_exit
    buffer_load_dword v4, v5, s[4:7], s65 offen sc1
    s_waitcnt vmcnt(0)
    v_add_u32 v4, v4, v250
    v_cmp_gt_i32 vcc, s58, v4
    s_cbranch_vccz L_ret_qkv1_fast
    s_and_b32 s63, s56, 63
    s_cbranch_scc1 L_spin_qkv1_fast_l
    v_mov_b32 v8, 896
    buffer_load_dword v4, v8, s[4:7], s65 offen sc1
    s_waitcnt vmcnt(0)
    v_cmp_ne_u32 vcc, 0, v4
    s_cbranch_vccnz L_spin_qkv1_fast_l
    buffer_wbl2 sc1
    s_waitcnt vmcnt(0)
    s_add_u32 s65, s79, 1024
    s_mov_b32 s74, 1
    buffer_store_dword v7, v6, s[4:7], s65 offen sc1
    s_branch L_spin_qkv1_slow
L_qkv_loop_fast_nb:
    s_sub_u32 s56, s56, 1
    s_cbranch_scc1 L_exit
    buffer_load_dword v223, v35, s[20:23], 0 offen sc1
    s_waitcnt vmcnt(0)
    s_branch L_qkv_loop_fast_x3
L_spin_qkvdr_fast:
L_spin_qkvdr_fast_l:
    s_sub_u32 s56, s56, 1
    s_cbranch_scc1 L_exit
    buffer_load_dword v4, v5, s[4:7], s65 offen sc1
    s_waitcnt vmcnt(0)
    v_add_u32 v4, v4, v250
    v_cmp_gt_i32 vcc, s58, v4
    s_cbranch_vccz L_ret_qkvdr_fast
    s_and_b32 s63, s56, 63
    s_cbranch_scc1 L_spin_qkvdr_fast_l
    v_mov_b32 v8, 896
    buffer_load_dword v4, v8, s[4:7], s65 offen sc1
    s_waitcnt vmcnt(0)
    v_cmp_ne_u32 vcc, 0, v4
    s_cbranch_vccnz L_spin_qkvdr_fast_l
    buffer_wbl2 sc1
    s_waitcnt vmcnt(0)
    s_add_u32 s65, s79, 1024
    s_mov_b32 s74, 1
    buffer_store_dword v7, v6, s[4:7], s65 offen sc1
    s_branch L_spin_qkvdr_slow
L_spin_qkv0_slow:
L_spin_qkv0_slow_l:
    s_sub_u32 s56, s56, 1
    s_cbranch_scc1 L_exit
    buffer_load_dword v4, v5, s[4:7], s65 offen sc1
    s_waitcnt vmcnt(0)
    v_add_u32 v4, v4, v250
    v_cmp_gt_i32 vcc, s58, v4
    s_cbranch_vccz L_ret_qkv0_slow
    s_branch L_spin_qkv0_slow_l
L_spin_qkv1_slow:
L_spin_qkv1_slow_l:
    s_sub_u32 s56, s56, 1
    s_cbranch_scc1 L_exit
    buffer_load_dword v4, v5, s[4:7], s65 offen sc1
    s_waitcnt vmcnt(0)
    v_add_u32 v4, v4, v250
    v_cmp_gt_i32 vcc, s58, v4
    s_cbranch_vccz L_ret_qkv1_slow
    s_branch L_spin_qkv1_slow_l
L_qkv_loop_slow_nb:
    s_sub_u32 s56, s56, 1
    s_cbranch_scc1 L_exit
    buffer_load_dword v223, v35, s[20:23], 0 offen sc1
    s_waitcnt vmcnt(0)
    s_branch L_qkv_loop_slow_x3
L_spin_qkvdr_slow:
L_spin_qkvdr_slow_l:
    s_sub_u32 s56, s56, 1
    s_cbranch_scc1 L_exit
    buffer_load_dword v4, v5, s[4:7], s65 offen sc1
    s_waitcnt vmcnt(0)
    v_add_u32 v4, v4, v250
    v_cmp_gt_i32 vcc, s58, v4
    s_cbranch_vccz L_ret_qkvdr_slow
    s_branch L_spin_qkvdr_slow_l
L_hs_6:
    s_sub_u32 s56, s56, 1
    s_cbranch_scc1 L_exit
    s_sleep 1
    s_lshl_b32 s63, s3, 2
    v_mov_b32 v8, s63
    buffer_load_dword v4, v8, s[20:23], 0 offen sc1
    s_waitcnt vmcnt(0)
    v_cmp_eq_u32 vcc, 0, v4
    s_cbranch_vccnz L_hs_6
    s_branch L_hsret_7
L_hsmm_8:
    s_mov_b32 s63, 896
    v_mov_b32 v8, s63
    v_mov_b32 v9, 0x80000000
    v_cmp_eq_u32 vcc, 0, v0
    s_nop 1
    v_cndmask_b32 v8, v9, v8, vcc
    v_mov_b32 v9, 0
    buffer_store_dword v9, v8, s[4:7], s79 offen sc1
    s_waitcnt vmcnt(0)
    s_add_u32 s65, s79, 1024
    s_mov_b32 s74, 1
    s_branch L_hsok_9
L_spin_wo_pro:
L_spin_wo_pro_l:
    s_sub_u32 s56, s56, 1
    s_cbranch_scc1 L_exit
    buffer_load_dword v4, v5, s[4:7], s65 offen sc1
    s_waitcnt vmcnt(0)
    v_cmp_gt_i32 vcc, s58, v4
    s_cbranch_vccz L_ret_wo_pro
    s_and_b32 s63, s56, 63
    s_cbranch_scc1 L_spin_wo_pro_l
    v_mov_b32 v8, 896
    buffer_load_dword v4, v8, s[4:7], s65 offen sc1
    s_waitcnt vmcnt(0)
    v_cmp_ne_u32 vcc, 0, v4
    s_cbranch_vccnz L_spin_wo_pro_l
    buffer_wbl2 sc1
    s_waitcnt vmcnt(0)
    s_add_u32 s65, s79, 1024
    s_mov_b32 s74, 1
    buffer_store_dword v7, v6, s[4:7], s65 offen sc1
    s_branch L_spin_wo_pro_l
L_spin_woeven_fast:
L_spin_woeven_fast_l:
    s_sub_u32 s56, s56, 1
    s_cbranch_scc1 L_exit
    buffer_load_dword v4, v5, s[4:7], s65 offen sc1
    s_waitcnt vmcnt(0)
    v_cmp_gt_i32 vcc, s58, v4
    s_cbranch_vccz L_ret_woeven_fast
    s_and_b32 s63, s56, 63
    s_cbranch_scc1 L_spin_woeven_fast_l
    v_mov_b32 v8, 896
    buffer_load_dword v4, v8, s[4:7], s65 offen sc1
    s_waitcnt vmcnt(0)
    v_cmp_ne_u32 vcc, 0, v4
    s_cbranch_vccnz L_spin_woeven_fast_l
    buffer_wbl2 sc1
    s_waitcnt vmcnt(0)
    s_add_u32 s65, s79, 1024
    s_mov_b32 s74, 1
    buffer_store_dword v7, v6, s[4:7], s65 offen sc1
    s_branch L_spin_woeven_slow
L_spin_woodd_fast:
L_spin_woodd_fast_l:
    s_sub_u32 s56, s56, 1
    s_cbranch_scc1 L_exit
    buffer_load_dword v4, v5, s[4:7], s65 offen sc1
    s_waitcnt vmcnt(0)
    v_cmp_gt_i32 vcc, s58, v4
    s_cbranch_vccz L_ret_woodd_fast
    s_and_b32 s63, s56, 63
    s_cbranch_scc1 L_spin_woodd_fast_l
    v_mov_b32 v8, 896
    buffer_load_dword v4, v8, s[4:7], s65 offen sc1
    s_waitcnt vmcnt(0)
    v_cmp_ne_u32 vcc, 0, v4
    s_cbranch_vccnz L_spin_woodd_fast_l
    buffer_wbl2 sc1
    s_waitcnt vmcnt(0)
    s_add_u32 s65, s79, 1024
    s_mov_b32 s74, 1
    buffer_store_dword v7, v6, s[4:7], s65 offen sc1
    s_branch L_spin_woodd_slow
L_spin_woeven_slow:
L_spin_woeven_slow_l:
    s_sub_u32 s56, s56, 1
    s_cbranch_scc1 L_exit
    buffer_load_dword v4, v5, s[4:7], s65 offen sc1
    s_waitcnt vmcnt(0)
    v_cmp_gt_i32 vcc, s58, v4
    s_cbranch_vccz L_ret_woeven_slow
    s_branch L_spin_woeven_slow_l
L_spin_woodd_slow:
L_spin_woodd_slow_l:
    s_sub_u32 s56, s56, 1
    s_cbranch_scc1 L_exit
    buffer_load_dword v4, v5, s[4:7], s65 offen sc1
    s_waitcnt vmcnt(0)
    v_cmp_gt_i32 vcc, s58, v4
    s_cbranch_vccz L_ret_woodd_slow
    s_branch L_spin_woodd_slow_l
L_hs_10:
    s_sub_u32 s56, s56, 1
    s_cbranch_scc1 L_exit
    s_sleep 1
    s_lshl_b32 s63, s3, 2
    v_mov_b32 v8, s63
    buffer_load_dword v4, v8, s[20:23], 0 offen sc1
    s_waitcnt vmcnt(0)
    v_cmp_eq_u32 vcc, 0, v4
    s_cbranch_vccnz L_hs_10
    s_branch L_hsret_11
L_hsmm_12:
    s_mov_b32 s63, 896
    v_mov_b32 v8, s63
    v_mov_b32 v9, 0x80000000
    v_cmp_eq_u32 vcc, 0, v0
    s_nop 1
    v_cndmask_b32 v8, v9, v8, vcc
    v_mov_b32 v9, 0
    buffer_store_dword v9, v8, s[4:7], s79 offen sc1
    s_waitcnt vmcnt(0)
    s_add_u32 s65, s79, 1024
    s_mov_b32 s74, 1
    s_branch L_hsok_13
L_gu_gos:
    buffer_store_dword v7, v6, s[4:7], s65 offen sc1
    s_branch L_gu_god
L_spin_gu_pro:
L_spin_gu_pro_l:
    s_sub_u32 s56, s56, 1
    s_cbranch_scc1 L_exit
    buffer_load_dword v4, v5, s[4:7], s65 offen sc1
    s_waitcnt vmcnt(0)
    v_cmp_gt_i32 vcc, s58, v4
    s_cbranch_vccz L_ret_gu_pro
    s_and_b32 s63, s56, 63
    s_cbranch_scc1 L_spin_gu_pro_l
    v_mov_b32 v8, 896
    buffer_load_dword v4, v8, s[4:7], s65 offen sc1
    s_waitcnt vmcnt(0)
    v_cmp_ne_u32 vcc, 0, v4
    s_cbranch_vccnz L_spin_gu_pro_l
    buffer_wbl2 sc1
    s_waitcnt vmcnt(0)
    s_add_u32 s65, s79, 1024
    s_mov_b32 s74, 1
    buffer_store_dword v7, v6, s[4:7], s65 offen sc1
    s_branch L_spin_gu_pro_l
L_spin_gu1_pro:
L_spin_gu1_pro_l:
    s_sub_u32 s56, s56, 1
    s_cbranch_scc1 L_exit
    buffer_load_dword v4, v5, s[4:7], s65 offen sc1
    s_waitcnt vmcnt(0)
    v_cmp_gt_i32 vcc, s58, v4
    s_cbranch_vccz L_ret_gu1_pro
    s_and_b32 s63, s56, 63
    s_cbranch_scc1 L_spin_gu1_pro_l
    v_mov_b32 v8, 896
    buffer_load_dword v4, v8, s[4:7], s65 offen sc1
    s_waitcnt vmcnt(0)
    v_cmp_ne_u32 vcc, 0, v4
    s_cbranch_vccnz L_spin_gu1_pro_l
    buffer_wbl2 sc1
    s_waitcnt vmcnt(0)
    s_add_u32 s65, s79, 1024
    s_mov_b32 s74, 1
    buffer_store_dword v7, v6, s[4:7], s65 offen sc1
    s_branch L_spin_gu1_pro_l
L_spin_gueven_fast:
L_spin_gueven_fast_l:
    s_sub_u32 s56, s56, 1
    s_cbranch_scc1 L_exit
    buffer_load_dword v4, v5, s[4:7], s65 offen sc1
    s_waitcnt vmcnt(0)
    v_cmp_gt_i32 vcc, s58, v4
    s_cbranch_vccz L_ret_gueven_fast
    s_and_b32 s63, s56, 63
    s_cbranch_scc1 L_spin_gueven_fast_l
    v_mov_b32 v8, 896
    buffer_load_dword v4, v8, s[4:7], s65 offen sc1
    s_waitcnt vmcnt(0)
    v_cmp_ne_u32 vcc, 0, v4
    s_cbranch_vccnz L_spin_gueven_fast_l
    buffer_wbl2 sc1
    s_waitcnt vmcnt(0)
    s_add_u32 s65, s79, 1024
    s_mov_b32 s74, 1
    buffer_store_dword v7, v6, s[4:7], s65 offen sc1
    s_branch L_spin_gueven_slow
L_meet_gu_even_fast:
    s_sub_u32 s56, s56, 1
    s_cbranch_scc1 L_exit
    ds_read_b32 v249, v247
    s_waitcnt lgkmcnt(0)
    v_cmp_gt_i32 vcc, v248, v249
    s_cbranch_vccnz L_meet_gu_even_fast
    s_branch L_ret_meet_gu_even_fast
L_spin_guodd_fast:
L_spin_guodd_fast_l:
    s_sub_u32 s56, s56, 1
    s_cbranch_scc1 L_exit
    buffer_load_dword v4, v5, s[4:7], s65 offen sc1
    s_waitcnt vmcnt(0)
    v_cmp_gt_i32 vcc, s58, v4
    s_cbranch_vccz L_ret_guodd_fast
    s_and_b32 s63, s56, 63
    s_cbranch_scc1 L_spin_guodd_fast_l
    v_mov_b32 v8, 896
    buffer_load_dword v4, v8, s[4:7], s65 offen sc1
    s_waitcnt vmcnt(0)
    v_cmp_ne_u32 vcc, 0, v4
    s_cbranch_vccnz L_spin_guodd_fast_l
    buffer_wbl2 sc1
    s_waitcnt vmcnt(0)
    s_add_u32 s65, s79, 1024
    s_mov_b32 s74, 1
    buffer_store_dword v7, v6, s[4:7], s65 offen sc1
    s_branch L_spin_guodd_slow
L_meet_gu_odd_fast:
    s_sub_u32 s56, s56, 1
    s_cbranch_scc1 L_exit
    ds_read_b32 v249, v247
    s_waitcnt lgkmcnt(0)
    v_cmp_gt_i32 vcc, v248, v249
    s_cbranch_vccnz L_meet_gu_odd_fast
    s_branch L_ret_meet_gu_odd_fast
L_spin_gudr_fast:
L_spin_gudr_fast_l:
    s_sub_u32 s56, s56, 1
    s_cbranch_scc1 L_exit
    buffer_load_dword v4, v5, s[4:7], s65 offen sc1
    s_waitcnt vmcnt(0)
    v_cmp_gt_i32 vcc, s58, v4
    s_cbranch_vccz L_ret_gudr_fast
    s_and_b32 s63, s56, 63
    s_cbranch_scc1 L_spin_gudr_fast_l
    v_mov_b32 v8, 896
    buffer_load_dword v4, v8, s[4:7], s65 offen sc1
    s_waitcnt vmcnt(0)
    v_cmp_ne_u32 vcc, 0, v4
    s_cbranch_vccnz L_spin_gudr_fast_l
    buffer_wbl2 sc1
    s_waitcnt vmcnt(0)
    s_add_u32 s65, s79, 1024
    s_mov_b32 s74, 1
    buffer_store_dword v7, v6, s[4:7], s65 offen sc1
    s_branch L_spin_gudr_slow
L_spin_gueven_slow:
L_spin_gueven_slow_l:
    s_sub_u32 s56, s56, 1
    s_cbranch_scc1 L_exit
    buffer_load_dword v4, v5, s[4:7], s65 offen sc1
    s_waitcnt vmcnt(0)
    v_cmp_gt_i32 vcc, s58, v4
    s_cbranch_vccz L_ret_gueven_slow
    s_branch L_spin_gueven_slow_l
L_meet_gu_even_slow:
    s_sub_u32 s56, s56, 1
    s_cbranch_scc1 L_exit
    ds_read_b32 v249, v247
    s_waitcnt lgkmcnt(0)
    v_cmp_gt_i32 vcc, v248, v249
    s_cbranch_vccnz L_meet_gu_even_slow
    s_branch L_ret_meet_gu_even_slow
L_spin_guodd_slow:
L_spin_guodd_slow_l:
    s_sub_u32 s56, s56, 1
    s_cbranch_scc1 L_exit
    buffer_load_dword v4, v5, s[4:7], s65 offen sc1
    s_waitcnt vmcnt(0)
    v_cmp_gt_i32 vcc, s58, v4
    s_cbranch_vccz L_ret_guodd_slow
    s_branch L_spin_guodd_slow_l
L_meet_gu_odd_slow:
    s_sub_u32 s56, s56, 1
    s_cbranch_scc1 L_exit
    ds_read_b32 v249, v247
    s_waitcnt lgkmcnt(0)
    v_cmp_gt_i32 vcc, v248, v249
    s_cbranch_vccnz L_meet_gu_odd_slow
    s_branch L_ret_meet_gu_odd_slow
L_spin_gudr_slow:
L_spin_gudr_slow_l:
    s_sub_u32 s56, s56, 1
    s_cbranch_scc1 L_exit
    buffer_load_dword v4, v5, s[4:7], s65 offen sc1
    s_waitcnt vmcnt(0)
    v_cmp_gt_i32 vcc, s58, v4
    s_cbranch_vccz L_ret_gudr_slow
    s_branch L_spin_gudr_slow_l
L_hs_14:
    s_sub_u32 s56, s56, 1
    s_cbranch_scc1 L_exit
    s_sleep 1
    s_lshl_b32 s63, s3, 2
    v_mov_b32 v8, s63
    buffer_load_dword v4, v8, s[20:23], 0 offen sc1
    s_waitcnt vmcnt(0)
    v_cmp_eq_u32 vcc, 0, v4
    s_cbranch_vccnz L_hs_14
    s_branch L_hsret_15
L_hsmm_16:
    s_mov_b32 s63, 896
    v_mov_b32 v8, s63
    v_mov_b32 v9, 0x80000000
    v_cmp_eq_u32 vcc, 0, v0
    s_nop 1
    v_cndmask_b32 v8, v9, v8, vcc
    v_mov_b32 v9, 0
    buffer_store_dword v9, v8, s[4:7], s79 offen sc1
    s_waitcnt vmcnt(0)
    s_add_u32 s65, s79, 1024
    s_mov_b32 s74, 1
    s_branch L_hsok_17
L_dn_s0slowa:
    s_and_b32 s63, s67, 0x1ffff
    s_add_u32 s63, s63, s68
    buffer_store_dwordx4 v[168:171], v34, s[4:7], s63 offen sc1
    s_add_u32 s67, s67, 8192
    v_mov_b32 v7, 8
    s_waitcnt vmcnt(0)
    buffer_store_dword v7, v6, s[4:7], s65 offen sc1
    s_branch L_dn_s0donea
L_dn_s0slowb:
    s_and_b32 s63, s67, 0x1ffff
    s_add_u32 s63, s63, s68
    buffer_store_dwordx4 v[184:187], v34, s[4:7], s63 offen sc1
    s_add_u32 s67, s67, 8192
    s_and_b32 s63, s67, 0x1ffff
    s_add_u32 s63, s63, s68
    buffer_store_dwordx4 v[200:203], v34, s[4:7], s63 offen sc1
    s_add_u32 s67, s67, 8192
    v_mov_b32 v7, 17
    s_waitcnt vmcnt(0)
    buffer_store_dword v7, v6, s[4:7], s65 offen sc1
    s_branch L_dn_s0doneb
L_spin_dnw_pro:
L_spin_dnw_pro_l:
    s_sub_u32 s56, s56, 1
    s_cbranch_scc1 L_exit
    s_sleep 2
    buffer_load_dword v4, v5, s[4:7], s65 offen sc1
    s_waitcnt vmcnt(0)
    v_cmp_gt_i32 vcc, s58, v4
    s_cbranch_vccz L_ret_dnw_pro
    s_and_b32 s63, s56, 63
    s_cbranch_scc1 L_spin_dnw_pro_l
    v_mov_b32 v8, 896
    buffer_load_dword v4, v8, s[4:7], s65 offen sc1
    s_waitcnt vmcnt(0)
    v_cmp_ne_u32 vcc, 0, v4
    s_cbranch_vccnz L_spin_dnw_pro_l
    buffer_wbl2 sc1
    s_waitcnt vmcnt(0)
    s_add_u32 s65, s79, 1024
    s_mov_b32 s74, 1
    buffer_store_dword v7, v6, s[4:7], s65 offen sc1
    s_branch L_spin_dnw_pro_l
L_spin_dn_pro:
L_spin_dn_pro_l:
    s_sub_u32 s56, s56, 1
    s_cbranch_scc1 L_exit
    buffer_load_dword v4, v5, s[4:7], s65 offen sc1
    s_waitcnt vmcnt(0)
    v_cmp_gt_i32 vcc, s58, v4
    s_cbranch_vccz L_ret_dn_pro
    s_and_b32 s63, s56, 63
    s_cbranch_scc1 L_spin_dn_pro_l
    v_mov_b32 v8, 896
    buffer_load_dword v4, v8, s[4:7], s65 offen sc1
    s_waitcnt vmcnt(0)
    v_cmp_ne_u32 vcc, 0, v4
    s_cbranch_vccnz L_spin_dn_pro_l
    buffer_wbl2 sc1
    s_waitcnt vmcnt(0)
    s_add_u32 s65, s79, 1024
    s_mov_b32 s74, 1
    buffer_store_dword v7, v6, s[4:7], s65 offen sc1
    s_branch L_spin_dn_pro_l
L_spin_dneven_fast:
L_spin_dneven_fast_l:
    s_sub_u32 s56, s56, 1
    s_cbranch_scc1 L_exit
    buffer_load_dword v4, v5, s[4:7], s65 offen sc1
    s_waitcnt vmcnt(0)
    v_cmp_gt_i32 vcc, s58, v4
    s_cbranch_vccz L_ret_dneven_fast
    s_and_b32 s63, s56, 63
    s_cbranch_scc1 L_spin_dneven_fast_l
    v_mov_b32 v8, 896
    buffer_load_dword v4, v8, s[4:7], s65 offen sc1
    s_waitcnt vmcnt(0)
    v_cmp_ne_u32 vcc, 0, v4
    s_cbranch_vccnz L_spin_dneven_fast_l
    buffer_wbl2 sc1
    s_waitcnt vmcnt(0)
    s_add_u32 s65, s79, 1024
    s_mov_b32 s74, 1
    buffer_store_dword v7, v6, s[4:7], s65 offen sc1
    s_branch L_spin_dneven_slow
L_spin_dnodd_fast:
L_spin_dnodd_fast_l:
    s_sub_u32 s56, s56, 1
    s_cbranch_scc1 L_exit
    buffer_load_dword v4, v5, s[4:7], s65 offen sc1
    s_waitcnt vmcnt(0)
    v_cmp_gt_i32 vcc, s58, v4
    s_cbranch_vccz L_ret_dnodd_fast
    s_and_b32 s63, s56, 63
    s_cbranch_scc1 L_spin_dnodd_fast_l
    v_mov_b32 v8, 896
    buffer_load_dword v4, v8, s[4:7], s65 offen sc1
    s_waitcnt vmcnt(0)
    v_cmp_ne_u32 vcc, 0, v4
    s_cbranch_vccnz L_spin_dnodd_fast_l
    buffer_wbl2 sc1
    s_waitcnt vmcnt(0)
    s_add_u32 s65, s79, 1024
    s_mov_b32 s74, 1
    buffer_store_dword v7, v6, s[4:7], s65 offen sc1
    s_branch L_spin_dnodd_slow
L_spin_dneven2_fast:
L_spin_dneven2_fast_l:
    s_sub_u32 s56, s56, 1
    s_cbranch_scc1 L_exit
    buffer_load_dword v4, v5, s[4:7], s65 offen sc1
    s_waitcnt vmcnt(0)
    v_cmp_gt_i32 vcc, s58, v4
    s_cbranch_vccz L_ret_dneven2_fast
    s_and_b32 s63, s56, 63
    s_cbranch_scc1 L_spin_dneven2_fast_l
    v_mov_b32 v8, 896
    buffer_load_dword v4, v8, s[4:7], s65 offen sc1
    s_waitcnt vmcnt(0)
    v_cmp_ne_u32 vcc, 0, v4
    s_cbranch_vccnz L_spin_dneven2_fast_l
    buffer_wbl2 sc1
    s_waitcnt vmcnt(0)
    s_add_u32 s65, s79, 1024
    s_mov_b32 s74, 1
    buffer_store_dword v7, v6, s[4:7], s65 offen sc1
    s_branch L_spin_dneven2_slow
L_spin_dnodd2_fast:
L_spin_dnodd2_fast_l:
    s_sub_u32 s56, s56, 1
    s_cbranch_scc1 L_exit
    buffer_load_dword v4, v5, s[4:7], s65 offen sc1
    s_waitcnt vmcnt(0)
    v_cmp_gt_i32 vcc, s58, v4
    s_cbranch_vccz L_ret_dnodd2_fast
    s_and_b32 s63, s56, 63
    s_cbranch_scc1 L_spin_dnodd2_fast_l
    v_mov_b32 v8, 896
    buffer_load_dword v4, v8, s[4:7], s65 offen sc1
    s_waitcnt vmcnt(0)
    v_cmp_ne_u32 vcc, 0, v4
    s_cbranch_vccnz L_spin_dnodd2_fast_l
    buffer_wbl2 sc1
    s_waitcnt vmcnt(0)
    s_add_u32 s65, s79, 1024
    s_mov_b32 s74, 1
    buffer_store_dword v7, v6, s[4:7], s65 offen sc1
    s_branch L_spin_dnodd2_slow
L_spin_dneven_slow:
L_spin_dneven_slow_l:
    s_sub_u32 s56, s56, 1
    s_cbranch_scc1 L_exit
    buffer_load_dword v4, v5, s[4:7], s65 offen sc1
    s_waitcnt vmcnt(0)
    v_cmp_gt_i32 vcc, s58, v4
    s_cbranch_vccz L_ret_dneven_slow
    s_branch L_spin_dneven_slow_l
L_spin_dnodd_slow:
L_spin_dnodd_slow_l:
    s_sub_u32 s56, s56, 1
    s_cbranch_scc1 L_exit
    buffer_load_dword v4, v5, s[4:7], s65 offen sc1
    s_waitcnt vmcnt(0)
    v_cmp_gt_i32 vcc, s58, v4
    s_cbranch_vccz L_ret_dnodd_slow
    s_branch L_spin_dnodd_slow_l
L_spin_dneven2_slow:
L_spin_dneven2_slow_l:
    s_sub_u32 s56, s56, 1
    s_cbranch_scc1 L_exit
    buffer_load_dword v4, v5, s[4:7], s65 offen sc1
    s_waitcnt vmcnt(0)
    v_cmp_gt_i32 vcc, s58, v4
    s_cbranch_vccz L_ret_dneven2_slow
    s_branch L_spin_dneven2_slow_l
L_spin_dnodd2_slow:
L_spin_dnodd2_slow_l:
    s_sub_u32 s56, s56, 1
    s_cbranch_scc1 L_exit
    buffer_load_dword v4, v5, s[4:7], s65 offen sc1
    s_waitcnt vmcnt(0)
    v_cmp_gt_i32 vcc, s58, v4
    s_cbranch_vccz L_ret_dnodd2_slow
    s_branch L_spin_dnodd2_slow_l
L_exit:
    s_endpgm
.p2align 4
L_qkv_loop_slow:
    s_waitcnt lgkmcnt(2)
    v_mfma_f32_16x16x32_bf16 v[64:67], a[0:3], v[96:99], 0
    ds_read2_b64 v[224:227], v27 offset0:0 offset1:16
    v_mfma_f32_16x16x32_bf16 v[68:71], a[4:7], v[96:99], 0
    v_cvt_pk_bf16_f32 v242, v80, v81
    v_cvt_pk_bf16_f32 v243, v82, v83
    v_mul_f32 v188, v84, v62
    v_mfma_f32_16x16x32_bf16 v[72:75], v[96:99], a[8:11], 0
    s_waitcnt lgkmcnt(2)
    v_mul_f32 v189, v85, v62
    v_mul_f32 v190, v86, v62
    v_mul_f32 v191, v87, v62
    v_mfma_f32_16x16x32_bf16 v[64:67], a[12:15], v[100:103], v[64:67]
    ds_read_b128 v[108:111], v25 offset:0
    v_cvt_pk_bf16_f32 v78, v188, v189
    v_cvt_pk_bf16_f32 v79, v190, v191
    v_mfma_f32_16x16x32_bf16 v[68:71], a[16:19], v[100:103], v[68:71]
    s_waitcnt vmcnt(0)
    v_add_u32 v4, v4, v250
    v_cmp_gt_i32 vcc, s58, v4
    v_mfma_f32_16x16x32_bf16 v[168:171], v[76:79], v[242:245], v[48:51]
    v_mfma_f32_16x16x32_bf16 v[172:175], v[76:79], v[240:243], v[52:55]
    s_cbranch_vccnz L_spin_qkv0_slow
L_ret_qkv0_slow:
    v_mul_f32 v192, v88, v204
    v_mul_f32 v193, v89, v205
    v_mfma_f32_16x16x32_bf16 v[72:75], v[100:103], a[20:23], v[72:75]
    s_waitcnt lgkmcnt(2)
    v_mul_f32 v194, v90, v206
    v_mul_f32 v195, v91, v207
    v_cvt_pk_bf16_f32 v162, v192, v193
    v_mfma_f32_16x16x32_bf16 v[64:67], a[24:27], v[104:107], v[64:67]
    s_add_u32 m0, s78, 17408
    ds_read_b128 v[112:115], v22 offset:4096
    v_cvt_pk_bf16_f32 v163, v194, v195
    v_max_f32 v184, v168, v169
    v_mfma_f32_16x16x32_bf16 v[68:71], a[28:31], v[104:107], v[68:71]
    s_lshr_b32 s67, s66, 4
    buffer_load_dwordx4 v18, s[12:15], s66 offen offset:0 sc1 lds
    v_max_f32 v185, v170, v171
    v_mfma_f32_16x16x32_bf16 v[72:75], v[104:107], a[32:35], v[72:75]
    s_waitcnt lgkmcnt(1)
    v_max3_f32 v184, v172, v173, v184
    v_max3_f32 v185, v174, v175, v185
    v_max_f32 v196, v184, v185
    v_mfma_f32_16x16x32_bf16 v[64:67], a[36:39], v[108:111], v[64:67]
    buffer_load_dwordx4 v19, s[12:15], s66 offen offset:1024 sc1 lds
    ds_read_b128 v[116:119], v23 offset:4096
    v_mfma_f32_16x16x32_bf16 v[68:71], a[40:43], v[108:111], v[68:71]
    v_max_f32 v197, v184, v185
    v_add_f32 v224, v224, v226
    v_add_f32 v226, v225, v227
    v_mfma_f32_16x16x32_bf16 v[72:75], v[108:111], a[44:47], v[72:75]
    s_waitcnt lgkmcnt(1)
    v_permlane16_swap_b32 v196, v197
    v_max_f32 v198, v196, v197
    v_mfma_f32_16x16x32_bf16 v[64:67], a[48:51], v[112:115], v[64:67]
    buffer_load_dwordx4 v20, s[12:15], s66 offen offset:2048 sc1 lds
    ds_read_b128 v[120:123], v24 offset:4096
    v_mfma_f32_16x16x32_bf16 v[68:71], a[52:55], v[112:115], v[68:71]
    v_max_f32 v196, v196, v197
    v_permlane16_swap_b32 v224, v226
    v_mfma_f32_16x16x32_bf16 v[72:75], v[112:115], a[56:59], v[72:75]
    s_waitcnt lgkmcnt(1)
    v_permlane32_swap_b32 v196, v198
    v_max_f32 v196, v196, v198
    v_mfma_f32_16x16x32_bf16 v[64:67], a[60:63], v[116:119], v[64:67]
    buffer_load_dwordx4 v21, s[12:15], s66 offen offset:3072 sc1 lds
    ds_read_b128 v[124:127], v25 offset:4096
    v_mfma_f32_16x16x32_bf16 v[68:71], a[64:67], v[116:119], v[68:71]
    s_add_u32 m0, s68, 17408
    v_mul_f32 v196, v196, v63
    v_fma_f32 v184, v184, v63, -v196
    v_fma_f32 v185, v185, v63, -v196
    v_mfma_f32_16x16x32_bf16 v[72:75], v[116:119], a[68:71], v[72:75]
    s_waitcnt lgkmcnt(1)
    v_exp_f32 v184, v184
    v_add_f32 v225, v224, v226
    v_mfma_f32_16x16x32_bf16 v[64:67], a[72:75], v[120:123], v[64:67]
    s_add_u32 s66, s66, 16384
    buffer_load_dword v26, s[16:19], s67 offen sc1 lds
    ds_read_b128 v[128:131], v22 offset:8192
    v_mfma_f32_16x16x32_bf16 v[68:71], a[76:79], v[120:123], v[68:71]
    s_and_b32 s66, s66, 0x1fffff
    v_exp_f32 v185, v185
    v_cvt_pk_bf16_f32 v184, v184, v184
    v_mfma_f32_16x16x32_bf16 v[72:75], v[120:123], a[80:83], v[72:75]
    s_waitcnt lgkmcnt(1)
    v_cvt_pk_bf16_f32 v185, v185, v185
    v_and_b32 v164, v216, v184
    v_and_b32 v165, v217, v185
    v_mfma_f32_16x16x32_bf16 v[64:67], a[84:87], v[124:127], v[64:67]
    s_add_u32 s58, s58, 1
    ds_read_b128 v[132:135], v23 offset:8192
    v_and_b32 v166, v218, v184
    v_and_b32 v167, v219, v185
    v_mfma_f32_16x16x32_bf16 v[68:71], a[88:91], v[124:127], v[68:71]
    s_cmp_eq_u32 s58, s84
    s_cselect_b32 s66, s85, s66
    v_add_f32 v224, v224, v226
    v_mfma_f32_16x16x32_bf16 v[180:183], v[12:15], v[164:167], 0
    s_nop 0
    v_permlane32_swap_b32 v224, v225
    v_add_f32 v224, v224, v225
    v_mfma_f32_16x16x32_bf16 v[176:179], v[160:163], v[164:167], 0
    v_mul_f32 v226, v214, v224
    v_mul_f32 v224, v214, v224
    v_mfma_f32_16x16x32_bf16 v[72:75], v[124:127], a[92:95], v[72:75]
    s_waitcnt lgkmcnt(1)
    v_permlane16_swap_b32 v224, v226
    v_cvt_pk_bf16_f32 v225, v224, v224
    v_mfma_f32_16x16x32_bf16 v[64:67], a[96:99], v[128:131], v[64:67]
    ds_read_b128 v[136:139], v24 offset:8192
    v_fma_f32 v226, -v224, v224, v226
    v_mfma_f32_16x16x32_bf16 v[68:71], a[100:103], v[128:131], v[68:71]
    v_rcp_f32 v180, v180
    v_mfma_f32_16x16x32_bf16 v[72:75], v[128:131], a[104:107], v[72:75]
    s_waitcnt lgkmcnt(1)
    v_mul_f32 v176, v176, v180
    v_mul_f32 v177, v177, v180
    v_mfma_f32_16x16x32_bf16 v[64:67], a[108:111], v[132:135], v[64:67]
    ds_read_b128 v[140:143], v25 offset:8192
    v_mul_f32 v178, v178, v180
    v_mfma_f32_16x16x32_bf16 v[68:71], a[112:115], v[132:135], v[68:71]
    v_mul_f32 v179, v179, v180
    v_cvt_pk_bf16_f32 v176, v176, v177
    v_mfma_f32_16x16x32_bf16 v[72:75], v[132:135], a[116:119], v[72:75]
    s_waitcnt lgkmcnt(1)
    v_cvt_pk_bf16_f32 v177, v178, v179
    v_lshlrev_b32 v227, 16, v225
    v_mfma_f32_16x16x32_bf16 v[64:67], a[120:123], v[136:139], v[64:67]
    buffer_store_dwordx2 v[176:177], v29, s[4:7], s60 offen sc1
    v_mfma_f32_16x16x32_bf16 v[68:71], a[124:127], v[136:139], v[68:71]
    s_add_u32 s60, s60, 16384
    ds_read_b128 v[144:147], v22 offset:12288
    v_max_f32 v226, 0, v226
    v_mfma_f32_16x16x32_bf16 v[72:75], v[136:139], a[128:131], v[72:75]
    s_waitcnt lgkmcnt(1)
    v_sub_f32 v227, v224, v227
    v_add_f32 v226, 0x3727c5ac, v226
    v_mfma_f32_16x16x32_bf16 v[64:67], a[132:135], v[140:143], v[64:67]
    s_and_b32 s60, s60, 0x3ffeffff
    ds_read_b128 v[148:151], v23 offset:12288
    v_add_u32 v7, 1, v7
    v_mfma_f32_16x16x32_bf16 v[68:71], a[136:139], v[140:143], v[68:71]
    v_cvt_pk_bf16_f32 v228, v224, v227
    v_mfma_f32_16x16x32_bf16 v[72:75], v[140:143], a[140:143], v[72:75]
    s_waitcnt lgkmcnt(1)
    v_rsq_f32 v60, v226
    v_mfma_f32_16x16x32_bf16 v[64:67], v[36:39], v[228:231], v[64:67]
    v_mfma_f32_16x16x32_bf16 v[68:71], v[40:43], v[228:231], v[68:71]
    v_mfma_f32_16x16x32_bf16 v[72:75], v[228:231], v[44:47], v[72:75]
    v_mul_f32 v61, 0x3eb8aa3b, v60
    v_mfma_f32_16x16x32_bf16 v[64:67], a[144:147], v[144:147], v[64:67]
    ds_read_b128 v[152:155], v24 offset:12288
    v_mfma_f32_16x16x32_bf16 v[68:71], a[148:151], v[144:147], v[68:71]
    ds_read_b128 v[156:159], v25 offset:12288
    v_mfma_f32_16x16x32_bf16 v[72:75], v[144:147], a[152:155], v[72:75]
    s_waitcnt lgkmcnt(2)
    ds_write_b32 v31, v60 offset:0
    v_mfma_f32_16x16x32_bf16 v[64:67], a[156:159], v[148:151], v[64:67]
    ds_read_b128 v[200:203], v32 offset:0
    v_mfma_f32_16x16x32_bf16 v[68:71], a[160:163], v[148:151], v[68:71]
    buffer_load_dword v4, v5, s[4:7], s65 offen sc1
    v_mfma_f32_16x16x32_bf16 v[72:75], v[148:151], a[164:167], v[72:75]
    s_waitcnt lgkmcnt(3)
    v_mfma_f32_16x16x32_bf16 v[64:67], a[168:171], v[152:155], v[64:67]
    s_waitcnt vmcnt(2) lgkmcnt(2)
    s_barrier
    v_mfma_f32_16x16x32_bf16 v[68:71], a[172:175], v[152:155], v[68:71]
    s_waitcnt vmcnt(1)
    buffer_store_dword v7, v6, s[4:7], s65 offen sc1
    v_mfma_f32_16x16x32_bf16 v[72:75], v[152:155], a[176:179], v[72:75]
    ds_read_b128 v[96:99], v22 offset:17408
    v_mfma_f32_16x16x32_bf16 v[64:67], a[180:183], v[156:159], v[64:67]
    ds_read_b128 v[100:103], v23 offset:17408
    v_mfma_f32_16x16x32_bf16 v[68:71], a[184:187], v[156:159], v[68:71]
    ds_read_b128 v[104:107], v24 offset:17408
    v_mfma_f32_16x16x32_bf16 v[72:75], v[156:159], a[188:191], v[72:75]
    s_waitcnt lgkmcnt(2)
    v_mfma_f32_16x16x32_bf16 v[80:83], a[0:3], v[96:99], 0
    ds_read2_b64 v[224:227], v28 offset0:0 offset1:16
    v_mfma_f32_16x16x32_bf16 v[84:87], a[4:7], v[96:99], 0
    v_cvt_pk_bf16_f32 v242, v64, v65
    v_cvt_pk_bf16_f32 v243, v66, v67
    v_mul_f32 v188, v68, v60
    v_mfma_f32_16x16x32_bf16 v[88:91], v[96:99], a[8:11], 0
    s_waitcnt lgkmcnt(2)
    v_mul_f32 v189, v69, v60
    v_mul_f32 v190, v70, v60
    v_mul_f32 v191, v71, v60
    v_mfma_f32_16x16x32_bf16 v[80:83], a[12:15], v[100:103], v[80:83]
    ds_read_b128 v[108:111], v25 offset:17408
    v_cvt_pk_bf16_f32 v76, v188, v189
    v_cvt_pk_bf16_f32 v77, v190, v191
    v_mfma_f32_16x16x32_bf16 v[84:87], a[16:19], v[100:103], v[84:87]
    s_waitcnt vmcnt(1)
    v_add_u32 v4, v4, v250
    v_cmp_gt_i32 vcc, s58, v4
    v_mfma_f32_16x16x32_bf16 v[168:171], v[76:79], v[240:243], v[56:59]
    v_mfma_f32_16x16x32_bf16 v[172:175], v[76:79], v[242:245], v[52:55]
    s_cbranch_vccnz L_spin_qkv1_slow
L_ret_qkv1_slow:
    v_mul_f32 v192, v72, v200
    v_mul_f32 v193, v73, v201
    v_mfma_f32_16x16x32_bf16 v[88:91], v[100:103], a[20:23], v[88:91]
    s_waitcnt lgkmcnt(2)
    v_mul_f32 v194, v74, v202
    v_mul_f32 v195, v75, v203
    v_cvt_pk_bf16_f32 v160, v192, v193
    v_mfma_f32_16x16x32_bf16 v[80:83], a[24:27], v[104:107], v[80:83]
    s_add_u32 m0, s78, 0
    ds_read_b128 v[112:115], v22 offset:21504
    v_cvt_pk_bf16_f32 v161, v194, v195
    v_max_f32 v184, v168, v169
    v_mfma_f32_16x16x32_bf16 v[84:87], a[28:31], v[104:107], v[84:87]
    s_lshr_b32 s67, s66, 4
    buffer_load_dwordx4 v18, s[12:15], s66 offen offset:0 sc1 lds
    v_max_f32 v185, v170, v171
    v_mfma_f32_16x16x32_bf16 v[88:91], v[104:107], a[32:35], v[88:91]
    s_waitcnt lgkmcnt(1)
    v_max3_f32 v184, v172, v173, v184
    v_max3_f32 v185, v174, v175, v185
    v_max_f32 v196, v184, v185
    v_mfma_f32_16x16x32_bf16 v[80:83], a[36:39], v[108:111], v[80:83]
    buffer_load_dwordx4 v19, s[12:15], s66 offen offset:1024 sc1 lds
    ds_read_b128 v[116:119], v23 offset:21504
    v_mfma_f32_16x16x32_bf16 v[84:87], a[40:43], v[108:111], v[84:87]
    v_max_f32 v197, v184, v185
    v_add_f32 v224, v224, v226
    v_add_f32 v226, v225, v227
    v_mfma_f32_16x16x32_bf16 v[88:91], v[108:111], a[44:47], v[88:91]
    s_waitcnt lgkmcnt(1)
    v_permlane16_swap_b32 v196, v197
    v_max_f32 v198, v196, v197
    v_mfma_f32_16x16x32_bf16 v[80:83], a[48:51], v[112:115], v[80:83]
    buffer_load_dwordx4 v20, s[12:15], s66 offen offset:2048 sc1 lds
    ds_read_b128 v[120:123], v24 offset:21504
    v_mfma_f32_16x16x32_bf16 v[84:87], a[52:55], v[112:115], v[84:87]
    v_max_f32 v196, v196, v197
    v_permlane16_swap_b32 v224, v226
    v_mfma_f32_16x16x32_bf16 v[88:91], v[112:115], a[56:59], v[88:91]
    s_waitcnt lgkmcnt(1)
    v_permlane32_swap_b32 v196, v198
    v_max_f32 v196, v196, v198
    v_mfma_f32_16x16x32_bf16 v[80:83], a[60:63], v[116:119], v[80:83]
    buffer_load_dwordx4 v21, s[12:15], s66 offen offset:3072 sc1 lds
    ds_read_b128 v[124:127], v25 offset:21504
    v_mfma_f32_16x16x32_bf16 v[84:87], a[64:67], v[116:119], v[84:87]
    s_add_u32 m0, s68, 0
    v_mul_f32 v196, v196, v61
    v_fma_f32 v184, v184, v61, -v196
    v_fma_f32 v185, v185, v61, -v196
    v_mfma_f32_16x16x32_bf16 v[88:91], v[116:119], a[68:71], v[88:91]
    s_waitcnt lgkmcnt(1)
    v_exp_f32 v184, v184
    v_add_f32 v225, v224, v226
    v_mfma_f32_16x16x32_bf16 v[80:83], a[72:75], v[120:123], v[80:83]
    s_add_u32 s66, s66, 16384
    buffer_load_dword v26, s[16:19], s67 offen sc1 lds
    ds_read_b128 v[128:131], v22 offset:25600
    v_mfma_f32_16x16x32_bf16 v[84:87], a[76:79], v[120:123], v[84:87]
    s_and_b32 s66, s66, 0x1fffff
    v_exp_f32 v185, v185
    v_cvt_pk_bf16_f32 v184, v184, v184
    v_mfma_f32_16x16x32_bf16 v[88:91], v[120:123], a[80:83], v[88:91]
    s_waitcnt lgkmcnt(1)
    v_cvt_pk_bf16_f32 v185, v185, v185
    v_and_b32 v166, v216, v184
    v_and_b32 v167, v217, v185
    v_mfma_f32_16x16x32_bf16 v[80:83], a[84:87], v[124:127], v[80:83]
    s_add_u32 s58, s58, 1
    ds_read_b128 v[132:135], v23 offset:25600
    v_and_b32 v164, v218, v184
    v_and_b32 v165, v219, v185
    v_mfma_f32_16x16x32_bf16 v[84:87], a[88:91], v[124:127], v[84:87]
    s_cmp_ge_u32 s58, 36
    s_cselect_b64 s[28:29], -1, 0
    s_cselect_b64 s[12:13], s[24:25], s[12:13]
    s_cselect_b64 s[16:17], s[86:87], s[16:17]
    v_cndmask_b32 v5, v5, v199, s[28:29]
    v_add_f32 v224, v224, v226
    v_mfma_f32_16x16x32_bf16 v[180:183], v[12:15], v[164:167], 0
    s_nop 0
    v_permlane32_swap_b32 v224, v225
    v_add_f32 v224, v224, v225
    v_mfma_f32_16x16x32_bf16 v[176:179], v[160:163], v[164:167], 0
    v_mul_f32 v226, v214, v224
    v_mul_f32 v224, v214, v224
    v_mfma_f32_16x16x32_bf16 v[88:91], v[124:127], a[92:95], v[88:91]
    s_waitcnt lgkmcnt(1)
    v_permlane16_swap_b32 v224, v226
    v_cvt_pk_bf16_f32 v225, v224, v224
    v_mfma_f32_16x16x32_bf16 v[80:83], a[96:99], v[128:131], v[80:83]
    ds_read_b128 v[136:139], v24 offset:25600
    v_fma_f32 v226, -v224, v224, v226
    v_mfma_f32_16x16x32_bf16 v[84:87], a[100:103], v[128:131], v[84:87]
    v_rcp_f32 v180, v180
    v_mfma_f32_16x16x32_bf16 v[88:91], v[128:131], a[104:107], v[88:91]
    s_waitcnt lgkmcnt(1)
    v_mul_f32 v176, v176, v180
    v_mul_f32 v177, v177, v180
    v_mfma_f32_16x16x32_bf16 v[80:83], a[108:111], v[132:135], v[80:83]
    ds_read_b128 v[140:143], v25 offset:25600
    v_mul_f32 v178, v178, v180
    v_mfma_f32_16x16x32_bf16 v[84:87], a[112:115], v[132:135], v[84:87]
    v_mul_f32 v179, v179, v180
    v_cvt_pk_bf16_f32 v176, v176, v177
    v_mfma_f32_16x16x32_bf16 v[88:91], v[132:135], a[116:119], v[88:91]
    s_waitcnt lgkmcnt(1)
    v_cvt_pk_bf16_f32 v177, v178, v179
    v_lshlrev_b32 v227, 16, v225
    v_mfma_f32_16x16x32_bf16 v[80:83], a[120:123], v[136:139], v[80:83]
    buffer_store_dwordx2 v[176:177], v29, s[4:7], s60 offen sc1
    v_mfma_f32_16x16x32_bf16 v[84:87], a[124:127], v[136:139], v[84:87]
    s_add_u32 s60, s60, 16384
    ds_read_b128 v[144:147], v22 offset:29696
    v_max_f32 v226, 0, v226
    v_mfma_f32_16x16x32_bf16 v[88:91], v[136:139], a[128:131], v[88:91]
    s_waitcnt lgkmcnt(1)
    v_sub_f32 v227, v224, v227
    v_add_f32 v226, 0x3727c5ac, v226
    v_mfma_f32_16x16x32_bf16 v[80:83], a[132:135], v[140:143], v[80:83]
    s_and_b32 s60, s60, 0x3ffeffff
    ds_read_b128 v[148:151], v23 offset:29696
    v_add_u32 v7, 1, v7
    v_mfma_f32_16x16x32_bf16 v[84:87], a[136:139], v[140:143], v[84:87]
    v_cvt_pk_bf16_f32 v228, v224, v227
    v_mfma_f32_16x16x32_bf16 v[88:91], v[140:143], a[140:143], v[88:91]
    s_waitcnt lgkmcnt(1)
    v_rsq_f32 v62, v226
    v_mfma_f32_16x16x32_bf16 v[80:83], v[36:39], v[228:231], v[80:83]
    v_mfma_f32_16x16x32_bf16 v[84:87], v[40:43], v[228:231], v[84:87]
    v_mfma_f32_16x16x32_bf16 v[88:91], v[228:231], v[44:47], v[88:91]
    v_mul_f32 v63, 0x3eb8aa3b, v62
    v_mfma_f32_16x16x32_bf16 v[80:83], a[144:147], v[144:147], v[80:83]
    ds_read_b128 v[152:155], v24 offset:29696
    v_mfma_f32_16x16x32_bf16 v[84:87], a[148:151], v[144:147], v[84:87]
    ds_read_b128 v[156:159], v25 offset:29696
    v_mfma_f32_16x16x32_bf16 v[88:91], v[144:147], a[152:155], v[88:91]
    s_waitcnt lgkmcnt(2)
    ds_write_b32 v31, v62 offset:0
    v_mfma_f32_16x16x32_bf16 v[80:83], a[156:159], v[148:151], v[80:83]
    ds_read_b128 v[204:207], v32 offset:0
    v_mfma_f32_16x16x32_bf16 v[84:87], a[160:163], v[148:151], v[84:87]
    buffer_load_dword v4, v5, s[4:7], s65 offen sc1
    v_mfma_f32_16x16x32_bf16 v[88:91], v[148:151], a[164:167], v[88:91]
    s_waitcnt lgkmcnt(3)
    v_mfma_f32_16x16x32_bf16 v[80:83], a[168:171], v[152:155], v[80:83]
    s_waitcnt vmcnt(2) lgkmcnt(2)
    s_barrier
    v_mfma_f32_16x16x32_bf16 v[84:87], a[172:175], v[152:155], v[84:87]
    s_waitcnt vmcnt(1)
    buffer_store_dword v7, v6, s[4:7], s65 offen sc1
    v_mfma_f32_16x16x32_bf16 v[88:91], v[152:155], a[176:179], v[88:91]
    ds_read_b128 v[96:99], v22 offset:0
    v_mfma_f32_16x16x32_bf16 v[80:83], a[180:183], v[156:159], v[80:83]
    ds_read_b128 v[100:103], v23 offset:0
    v_mfma_f32_16x16x32_bf16 v[84:87], a[184:187], v[156:159], v[84:87]
    s_cmp_lg_u32 s58, s61
    ds_read_b128 v[104:107], v24 offset:0
    v_mfma_f32_16x16x32_bf16 v[88:91], v[156:159], a[188:191], v[88:91]
    s_cbranch_scc1 L_qkv_loop_slow
    s_cmp_gt_u32 s58, 18
    s_cbranch_scc1 L_qkv_loop_slow_e18
    v_mov_b32 v48, v56
    v_mov_b32 v49, v57
    v_mov_b32 v50, v58
    v_mov_b32 v51, v59
    s_mov_b32 s61, 18
    s_cmp_lt_u32 s58, 18
    s_cbranch_scc1 L_qkv_loop_slow
    s_mov_b64 s[12:13], s[50:51]
    s_mov_b64 s[16:17], s[26:27]
    s_mov_b32 s66, s82
    buffer_load_dword v223, v35, s[20:23], 0 offen sc1
    v_lshl_add_u32 v250, v251, 1, v250
    s_mov_b32 s58, 20
    s_mov_b32 s61, 22
    s_branch L_qkv_loop_slow
L_qkv_loop_slow_e18:
    s_cmp_gt_u32 s58, 22
    s_cbranch_scc1 L_qkv_loop_slow_x2
    ds_read_b128 v[92:95], v34 offset:17408
    v_subrev_u32 v7, 1, v7
    v_add_u32 v250, v251, v250
    s_add_u32 s60, s60, 0x3fffc000
    s_mov_b32 s84, 37
    s_mov_b32 s85, 0x40000000
    s_mov_b32 s61, 24
    s_waitcnt lgkmcnt(0)
    buffer_store_dwordx4 v[92:95], v33, s[4:7], 0 offen sc1
    s_branch L_qkv_loop_slow
L_qkv_loop_slow_x2:
    s_cmp_eq_u32 s58, 38
    s_cbranch_scc1 L_qkv_loop_slow_end
L_qkv_loop_slow_x3:
    v_cmp_eq_u32 vcc, 0, v223
    v_mov_b32 v8, 64
    s_mov_b32 s61, 38
    s_cbranch_vccnz L_qkv_loop_slow_nb
    buffer_store_dword v8, v215, s[4:7], s73 offen sc1
    s_branch L_qkv_loop_slow
L_qkv_loop_slow_end:
    s_cmp_eq_u32 s3, 7
    s_cselect_b64 vcc, -1, 0
    v_mov_b32 v11, 0xf149f2ca
    s_nop 1
    v_cndmask_b32 v48, v56, v11, vcc
    v_cndmask_b32 v49, v57, v11, vcc
    v_cndmask_b32 v50, v58, v11, vcc
    v_cndmask_b32 v51, v59, v11, vcc
    v_cvt_pk_bf16_f32 v242, v80, v81
    v_cvt_pk_bf16_f32 v243, v82, v83
    v_mul_f32 v188, v84, v62
    v_mul_f32 v189, v85, v62
    v_mul_f32 v190, v86, v62
    v_mul_f32 v191, v87, v62
    v_cvt_pk_bf16_f32 v78, v188, v189
    v_cvt_pk_bf16_f32 v79, v190, v191
    s_nop 1
    v_mfma_f32_16x16x32_bf16 v[168:171], v[76:79], v[242:245], v[48:51]
    v_mfma_f32_16x16x32_bf16 v[172:175], v[76:79], v[240:243], v[52:55]
    s_waitcnt lgkmcnt(3)
    v_mul_f32 v192, v88, v204
    v_mul_f32 v193, v89, v205
    v_mul_f32 v194, v90, v206
    v_mul_f32 v195, v91, v207
    v_cvt_pk_bf16_f32 v162, v192, v193
    v_cvt_pk_bf16_f32 v163, v194, v195
    v_max_f32 v184, v168, v169
    v_max_f32 v185, v170, v171
    v_max3_f32 v184, v172, v173, v184
    v_max3_f32 v185, v174, v175, v185
    v_max_f32 v196, v184, v185
    v_max_f32 v197, v184, v185
    s_nop 1
    v_permlane16_swap_b32 v196, v197
    v_max_f32 v198, v196, v197
    v_max_f32 v196, v196, v197
    s_nop 1
    v_permlane32_swap_b32 v196, v198
    v_max_f32 v196, v196, v198
    v_mul_f32 v196, v196, v63
    v_fma_f32 v184, v184, v63, -v196
    v_fma_f32 v185, v185, v63, -v196
    v_exp_f32 v184, v184
    v_exp_f32 v185, v185
    v_cvt_pk_bf16_f32 v184, v184, v184
    v_cvt_pk_bf16_f32 v185, v185, v185
    v_and_b32 v164, v216, v184
    v_and_b32 v165, v217, v185
    v_and_b32 v166, v218, v184
    v_and_b32 v167, v219, v185
    s_nop 1
    v_mfma_f32_16x16x32_bf16 v[180:183], v[12:15], v[164:167], 0
    v_mfma_f32_16x16x32_bf16 v[176:179], v[160:163], v[164:167], 0
    s_nop 6
    v_rcp_f32 v180, v180
    s_nop 0
    v_mul_f32 v176, v176, v180
    v_mul_f32 v177, v177, v180
    v_mul_f32 v178, v178, v180
    v_mul_f32 v179, v179, v180
    v_cvt_pk_bf16_f32 v176, v176, v177
    v_cvt_pk_bf16_f32 v177, v178, v179
    s_waitcnt vmcnt(1)
    v_add_u32 v4, v4, v250
    v_cmp_gt_i32 vcc, s58, v4
    s_cbranch_vccnz L_spin_qkvdr_slow
L_ret_qkvdr_slow:
    buffer_store_dwordx2 v[176:177], v29, s[4:7], s60 offen sc1
    v_mov_b32 v7, 64
    s_waitcnt vmcnt(0)
    buffer_store_dword v7, v6, s[4:7], s65 offen sc1
    s_endpgm
.p2align 4
L_wo_loop_slow:
    s_waitcnt lgkmcnt(4)
    v_mfma_f32_16x16x32_bf16 v[48:51], a[0:3], v[144:147], v[48:51]
    v_mfma_f32_16x16x32_bf16 v[52:55], a[4:7], v[144:147], v[52:55]
    s_waitcnt vmcnt(1)
    buffer_store_dword v7, v6, s[4:7], s65 offen sc1
    v_mfma_f32_16x16x32_bf16 v[56:59], a[8:11], v[144:147], v[56:59]
    v_cvt_pk_bf16_f32 v120, v64, v65
    v_cvt_pk_bf16_f32 v121, v66, v67
    v_mfma_f32_16x16x32_bf16 v[60:63], a[12:15], v[144:147], v[60:63]
    s_waitcnt lgkmcnt(3)
    v_cvt_pk_bf16_f32 v122, v68, v69
    v_cvt_pk_bf16_f32 v123, v70, v71
    v_mfma_f32_16x16x32_bf16 v[48:51], a[16:19], v[148:151], v[48:51]
    v_cvt_pk_bf16_f32 v124, v72, v73
    v_cvt_pk_bf16_f32 v125, v74, v75
    v_mfma_f32_16x16x32_bf16 v[52:55], a[20:23], v[148:151], v[52:55]
    v_cvt_pk_bf16_f32 v126, v76, v77
    v_cvt_pk_bf16_f32 v127, v78, v79
    v_mfma_f32_16x16x32_bf16 v[56:59], a[24:27], v[148:151], v[56:59]
    s_waitcnt vmcnt(1)
    v_cmp_gt_i32 vcc, s58, v4
    v_add_f32 v128, v64, v65
    v_mfma_f32_16x16x32_bf16 v[60:63], a[28:31], v[148:151], v[60:63]
    s_waitcnt lgkmcnt(2)
    v_mul_f32 v129, v64, v64
    v_fmac_f32 v129, v65, v65
    v_mfma_f32_16x16x32_bf16 v[48:51], a[32:35], v[152:155], v[48:51]
    s_cbranch_vccnz L_spin_woeven_slow
L_ret_woeven_slow:
    v_add_f32 v128, v128, v66
    v_fmac_f32 v129, v66, v66
    v_mfma_f32_16x16x32_bf16 v[52:55], a[36:39], v[152:155], v[52:55]
    s_mov_b32 m0, s68
    v_add_f32 v128, v128, v67
    v_fmac_f32 v129, v67, v67
    v_mfma_f32_16x16x32_bf16 v[56:59], a[40:43], v[152:155], v[56:59]
    s_add_u32 s58, s58, 1
    buffer_load_dwordx4 v26, s[12:15], s66 offen offset:0 sc1 lds
    v_mfma_f32_16x16x32_bf16 v[60:63], a[44:47], v[152:155], v[60:63]
    s_waitcnt lgkmcnt(1)
    buffer_load_dwordx4 v27, s[12:15], s66 offen offset:1024 sc1 lds
    v_mfma_f32_16x16x32_bf16 v[48:51], a[48:51], v[156:159], v[48:51]
    s_add_u32 m0, s78, 17408
    ds_read_b128 v[164:167], v3 offset:5120
    v_add_f32 v128, v128, v68
    v_mfma_f32_16x16x32_bf16 v[52:55], a[52:55], v[156:159], v[52:55]
    s_mov_b32 s60, s66
    v_fmac_f32 v129, v68, v68
    v_add_f32 v128, v128, v69
    v_mfma_f32_16x16x32_bf16 v[56:59], a[56:59], v[156:159], v[56:59]
    buffer_load_dwordx4 v22, s[4:7], s59 offen offset:0 sc1 lds
    v_mfma_f32_16x16x32_bf16 v[60:63], a[60:63], v[156:159], v[60:63]
    s_waitcnt lgkmcnt(1)
    v_fmac_f32 v129, v69, v69
    v_add_f32 v128, v128, v70
    v_mfma_f32_16x16x32_bf16 v[48:51], a[64:67], v[160:163], v[48:51]
    ds_read_b128 v[168:171], v3 offset:6144
    v_fmac_f32 v129, v70, v70
    v_mfma_f32_16x16x32_bf16 v[52:55], a[68:71], v[160:163], v[52:55]
    buffer_load_dwordx4 v22, s[4:7], s59 offen offset:1024 sc1 lds
    v_mfma_f32_16x16x32_bf16 v[56:59], a[72:75], v[160:163], v[56:59]
    v_add_f32 v128, v128, v71
    v_fmac_f32 v129, v71, v71
    v_mfma_f32_16x16x32_bf16 v[60:63], a[76:79], v[160:163], v[60:63]
    s_waitcnt lgkmcnt(1)
    v_add_f32 v128, v128, v72
    v_fmac_f32 v129, v72, v72
    v_mfma_f32_16x16x32_bf16 v[48:51], a[80:83], v[164:167], v[48:51]
    buffer_load_dwordx4 v22, s[4:7], s59 offen offset:2048 sc1 lds
    v_mfma_f32_16x16x32_bf16 v[52:55], a[84:87], v[164:167], v[52:55]
    ds_read_b128 v[172:175], v3 offset:7168
    v_add_f32 v128, v128, v73
    v_mfma_f32_16x16x32_bf16 v[56:59], a[88:91], v[164:167], v[56:59]
    v_fmac_f32 v129, v73, v73
    v_add_f32 v128, v128, v74
    v_mfma_f32_16x16x32_bf16 v[60:63], a[92:95], v[164:167], v[60:63]
    s_waitcnt lgkmcnt(1)
    buffer_load_dwordx4 v22, s[4:7], s59 offen offset:3072 sc1 lds
    v_mfma_f32_16x16x32_bf16 v[48:51], a[96:99], v[168:171], v[48:51]
    s_add_u32 s59, s59, 16384
    ds_read_b128 v[176:179], v3 offset:8192
    v_fmac_f32 v129, v74, v74
    v_mfma_f32_16x16x32_bf16 v[52:55], a[100:103], v[168:171], v[52:55]
    s_and_b32 s59, s59, 0x3ffeffff
    v_add_f32 v128, v128, v75
    v_fmac_f32 v129, v75, v75
    v_mfma_f32_16x16x32_bf16 v[56:59], a[104:107], v[168:171], v[56:59]
    s_add_u32 s66, s66, 16384
    buffer_store_dwordx2 v[120:121], v32, s[24:27], s83 offen sc1
    v_mfma_f32_16x16x32_bf16 v[60:63], a[108:111], v[168:171], v[60:63]
    s_waitcnt lgkmcnt(1)
    v_add_f32 v128, v128, v76
    v_fmac_f32 v129, v76, v76
    v_mfma_f32_16x16x32_bf16 v[48:51], a[112:115], v[172:175], v[48:51]
    s_and_b32 s66, s66, 0x1fffff
    ds_read_b128 v[180:183], v3 offset:9216
    v_add_f32 v128, v128, v77
    v_mfma_f32_16x16x32_bf16 v[52:55], a[116:119], v[172:175], v[52:55]
    s_cmp_eq_u32 s58, 17
    s_cselect_b32 s66, s77, s66
    s_cselect_b64 s[12:13], s[24:25], s[12:13]
    v_fmac_f32 v129, v77, v77
    v_add_f32 v128, v128, v78
    v_mfma_f32_16x16x32_bf16 v[56:59], a[120:123], v[172:175], v[56:59]
    s_cmp_eq_u32 s58, 33
    s_cselect_b32 s66, 0x40000000, s66
    v_fmac_f32 v129, v78, v78
    v_add_f32 v128, v128, v79
    v_mfma_f32_16x16x32_bf16 v[60:63], a[124:127], v[172:175], v[60:63]
    s_waitcnt lgkmcnt(1)
    v_fmac_f32 v129, v79, v79
    v_mfma_f32_16x16x32_bf16 v[48:51], a[128:131], v[176:179], v[48:51]
    buffer_store_dwordx2 v[122:123], v33, s[24:27], s83 offen sc1
    v_mfma_f32_16x16x32_bf16 v[52:55], a[132:135], v[176:179], v[52:55]
    ds_read_b128 v[184:187], v3 offset:10240
    v_mfma_f32_16x16x32_bf16 v[56:59], a[136:139], v[176:179], v[56:59]
    v_permlane16_swap_b32 v128, v129
    v_mfma_f32_16x16x32_bf16 v[60:63], a[140:143], v[176:179], v[60:63]
    s_waitcnt lgkmcnt(1)
    v_add_f32 v130, v128, v129
    v_add_f32 v128, v128, v129
    v_mfma_f32_16x16x32_bf16 v[48:51], a[144:147], v[180:183], v[48:51]
    s_waitcnt vmcnt(6)
    ds_read_b128 v[188:191], v3 offset:11264
    ds_read_b128 v[112:115], v28
    v_mfma_f32_16x16x32_bf16 v[52:55], a[148:151], v[180:183], v[52:55]
    ds_read_b128 v[116:119], v29
    v_mfma_f32_16x16x32_bf16 v[56:59], a[152:155], v[180:183], v[56:59]
    buffer_store_dwordx2 v[124:125], v34, s[24:27], s83 offen sc1
    v_mfma_f32_16x16x32_bf16 v[60:63], a[156:159], v[180:183], v[60:63]
    s_waitcnt lgkmcnt(3)
    v_permlane32_swap_b32 v128, v130
    v_mfma_f32_16x16x32_bf16 v[48:51], a[160:163], v[184:187], v[48:51]
    ds_read_b128 v[192:195], v3 offset:12288
    v_add_f32 v128, v128, v130
    v_mfma_f32_16x16x32_bf16 v[52:55], a[164:167], v[184:187], v[52:55]
    buffer_store_dword v128, v25, s[16:19], s67 offen sc1
    v_mfma_f32_16x16x32_bf16 v[56:59], a[168:171], v[184:187], v[56:59]
    s_waitcnt lgkmcnt(1)
    v_lshlrev_b32 v64, 16, v112
    v_and_b32 v65, 0xffff0000, v112
    v_mfma_f32_16x16x32_bf16 v[60:63], a[172:175], v[184:187], v[60:63]
    v_lshlrev_b32 v66, 16, v113
    v_and_b32 v67, 0xffff0000, v113
    v_mfma_f32_16x16x32_bf16 v[48:51], a[176:179], v[188:191], v[48:51]
    buffer_store_dwordx2 v[126:127], v35, s[24:27], s83 offen sc1
    v_mfma_f32_16x16x32_bf16 v[52:55], a[180:183], v[188:191], v[52:55]
    s_mov_b32 s83, s82
    ds_read_b128 v[196:199], v3 offset:13312
    v_lshlrev_b32 v68, 16, v114
    v_mfma_f32_16x16x32_bf16 v[56:59], a[184:187], v[188:191], v[56:59]
    s_lshr_b32 s67, s82, 4
    v_add_u32 v7, 1, v7
    v_and_b32 v69, 0xffff0000, v114
    v_mfma_f32_16x16x32_bf16 v[60:63], a[188:191], v[188:191], v[60:63]
    s_waitcnt lgkmcnt(1)
    v_lshlrev_b32 v70, 16, v115
    v_and_b32 v71, 0xffff0000, v115
    v_mfma_f32_16x16x32_bf16 v[48:51], a[192:195], v[192:195], v[48:51]
    ds_read_b128 v[200:203], v3 offset:14336
    v_lshlrev_b32 v72, 16, v116
    v_mfma_f32_16x16x32_bf16 v[52:55], a[196:199], v[192:195], v[52:55]
    v_and_b32 v73, 0xffff0000, v116
    v_lshlrev_b32 v74, 16, v117
    v_mfma_f32_16x16x32_bf16 v[56:59], a[200:203], v[192:195], v[56:59]
    v_and_b32 v75, 0xffff0000, v117
    v_lshlrev_b32 v76, 16, v118
    v_mfma_f32_16x16x32_bf16 v[60:63], a[204:207], v[192:195], v[60:63]
    s_waitcnt lgkmcnt(1)
    v_and_b32 v77, 0xffff0000, v118
    v_lshlrev_b32 v78, 16, v119
    v_mfma_f32_16x16x32_bf16 v[48:51], a[208:211], v[196:199], v[48:51]
    buffer_load_dword v4, v5, s[4:7], s65 offen sc1
    v_mfma_f32_16x16x32_bf16 v[52:55], a[212:215], v[196:199], v[52:55]
    ds_read_b128 v[204:207], v3 offset:15360
    v_and_b32 v79, 0xffff0000, v119
    v_mfma_f32_16x16x32_bf16 v[56:59], a[216:219], v[196:199], v[56:59]
    v_mfma_f32_16x16x32_bf16 v[60:63], a[220:223], v[196:199], v[60:63]
    s_waitcnt lgkmcnt(1)
    v_mfma_f32_16x16x32_bf16 v[48:51], a[224:227], v[200:203], v[48:51]
    v_mfma_f32_16x16x32_bf16 v[52:55], a[228:231], v[200:203], v[52:55]
    s_waitcnt vmcnt(6) lgkmcnt(0)
    s_barrier
    v_mfma_f32_16x16x32_bf16 v[56:59], a[232:235], v[200:203], v[56:59]
    ds_read_b128 v[144:147], v3 offset:17408
    v_mfma_f32_16x16x32_bf16 v[60:63], a[236:239], v[200:203], v[60:63]
    ds_read_b128 v[148:151], v3 offset:18432
    v_mfma_f32_16x16x32_bf16 v[48:51], a[240:243], v[204:207], v[48:51]
    ds_read_b128 v[152:155], v3 offset:19456
    v_mfma_f32_16x16x32_bf16 v[52:55], a[244:247], v[204:207], v[52:55]
    ds_read_b128 v[156:159], v3 offset:20480
    v_mfma_f32_16x16x32_bf16 v[56:59], a[248:251], v[204:207], v[56:59]
    ds_read_b128 v[160:163], v3 offset:21504
    v_mfma_f32_16x16x32_bf16 v[60:63], a[252:255], v[204:207], v[60:63]
    s_waitcnt lgkmcnt(4)
    v_mfma_f32_16x16x32_bf16 v[64:67], a[0:3], v[144:147], v[64:67]
    v_mfma_f32_16x16x32_bf16 v[68:71], a[4:7], v[144:147], v[68:71]
    s_waitcnt vmcnt(1)
    buffer_store_dword v7, v6, s[4:7], s65 offen sc1
    v_mfma_f32_16x16x32_bf16 v[72:75], a[8:11], v[144:147], v[72:75]
    v_cvt_pk_bf16_f32 v120, v48, v49
    v_cvt_pk_bf16_f32 v121, v50, v51
    v_mfma_f32_16x16x32_bf16 v[76:79], a[12:15], v[144:147], v[76:79]
    s_waitcnt lgkmcnt(3)
    v_cvt_pk_bf16_f32 v122, v52, v53
    v_cvt_pk_bf16_f32 v123, v54, v55
    v_mfma_f32_16x16x32_bf16 v[64:67], a[16:19], v[148:151], v[64:67]
    v_cvt_pk_bf16_f32 v124, v56, v57
    v_cvt_pk_bf16_f32 v125, v58, v59
    v_mfma_f32_16x16x32_bf16 v[68:71], a[20:23], v[148:151], v[68:71]
    v_cvt_pk_bf16_f32 v126, v60, v61
    v_cvt_pk_bf16_f32 v127, v62, v63
    v_mfma_f32_16x16x32_bf16 v[72:75], a[24:27], v[148:151], v[72:75]
    s_waitcnt vmcnt(1)
    v_cmp_gt_i32 vcc, s58, v4
    v_add_f32 v128, v48, v49
    v_mfma_f32_16x16x32_bf16 v[76:79], a[28:31], v[148:151], v[76:79]
    s_waitcnt lgkmcnt(2)
    v_mul_f32 v129, v48, v48
    v_fmac_f32 v129, v49, v49
    v_mfma_f32_16x16x32_bf16 v[64:67], a[32:35], v[152:155], v[64:67]
    s_cbranch_vccnz L_spin_woodd_slow
L_ret_woodd_slow:
    v_add_f32 v128, v128, v50
    v_fmac_f32 v129, v50, v50
    v_mfma_f32_16x16x32_bf16 v[68:71], a[36:39], v[152:155], v[68:71]
    s_mov_b32 m0, s68
    v_add_f32 v128, v128, v51
    v_fmac_f32 v129, v51, v51
    v_mfma_f32_16x16x32_bf16 v[72:75], a[40:43], v[152:155], v[72:75]
    s_add_u32 s58, s58, 1
    buffer_load_dwordx4 v26, s[12:15], s66 offen offset:0 sc1 lds
    v_mfma_f32_16x16x32_bf16 v[76:79], a[44:47], v[152:155], v[76:79]
    s_waitcnt lgkmcnt(1)
    buffer_load_dwordx4 v27, s[12:15], s66 offen offset:1024 sc1 lds
    v_mfma_f32_16x16x32_bf16 v[64:67], a[48:51], v[156:159], v[64:67]
    s_add_u32 m0, s78, 0
    ds_read_b128 v[164:167], v3 offset:22528
    v_add_f32 v128, v128, v52
    v_mfma_f32_16x16x32_bf16 v[68:71], a[52:55], v[156:159], v[68:71]
    s_mov_b32 s82, s66
    v_fmac_f32 v129, v52, v52
    v_add_f32 v128, v128, v53
    v_mfma_f32_16x16x32_bf16 v[72:75], a[56:59], v[156:159], v[72:75]
    buffer_load_dwordx4 v22, s[4:7], s59 offen offset:0 sc1 lds
    v_mfma_f32_16x16x32_bf16 v[76:79], a[60:63], v[156:159], v[76:79]
    s_waitcnt lgkmcnt(1)
    v_fmac_f32 v129, v53, v53
    v_add_f32 v128, v128, v54
    v_mfma_f32_16x16x32_bf16 v[64:67], a[64:67], v[160:163], v[64:67]
    ds_read_b128 v[168:171], v3 offset:23552
    v_fmac_f32 v129, v54, v54
    v_mfma_f32_16x16x32_bf16 v[68:71], a[68:71], v[160:163], v[68:71]
    buffer_load_dwordx4 v22, s[4:7], s59 offen offset:1024 sc1 lds
    v_mfma_f32_16x16x32_bf16 v[72:75], a[72:75], v[160:163], v[72:75]
    v_add_f32 v128, v128, v55
    v_fmac_f32 v129, v55, v55
    v_mfma_f32_16x16x32_bf16 v[76:79], a[76:79], v[160:163], v[76:79]
    s_waitcnt lgkmcnt(1)
    v_add_f32 v128, v128, v56
    v_fmac_f32 v129, v56, v56
    v_mfma_f32_16x16x32_bf16 v[64:67], a[80:83], v[164:167], v[64:67]
    buffer_load_dwordx4 v22, s[4:7], s59 offen offset:2048 sc1 lds
    v_mfma_f32_16x16x32_bf16 v[68:71], a[84:87], v[164:167], v[68:71]
    ds_read_b128 v[172:175], v3 offset:24576
    v_add_f32 v128, v128, v57
    v_mfma_f32_16x16x32_bf16 v[72:75], a[88:91], v[164:167], v[72:75]
    v_fmac_f32 v129, v57, v57
    v_add_f32 v128, v128, v58
    v_mfma_f32_16x16x32_bf16 v[76:79], a[92:95], v[164:167], v[76:79]
    s_waitcnt lgkmcnt(1)
    buffer_load_dwordx4 v22, s[4:7], s59 offen offset:3072 sc1 lds
    v_mfma_f32_16x16x32_bf16 v[64:67], a[96:99], v[168:171], v[64:67]
    s_add_u32 s59, s59, 16384
    ds_read_b128 v[176:179], v3 offset:25600
    v_fmac_f32 v129, v58, v58
    v_mfma_f32_16x16x32_bf16 v[68:71], a[100:103], v[168:171], v[68:71]
    s_and_b32 s59, s59, 0x3ffeffff
    v_add_f32 v128, v128, v59
    v_fmac_f32 v129, v59, v59
    v_mfma_f32_16x16x32_bf16 v[72:75], a[104:107], v[168:171], v[72:75]
    s_add_u32 s66, s66, 16384
    buffer_store_dwordx2 v[120:121], v32, s[24:27], s83 offen sc1
    v_mfma_f32_16x16x32_bf16 v[76:79], a[108:111], v[168:171], v[76:79]
    s_waitcnt lgkmcnt(1)
    v_add_f32 v128, v128, v60
    v_fmac_f32 v129, v60, v60
    v_mfma_f32_16x16x32_bf16 v[64:67], a[112:115], v[172:175], v[64:67]
    s_and_b32 s66, s66, 0x1fffff
    ds_read_b128 v[180:183], v3 offset:26624
    v_add_f32 v128, v128, v61
    v_mfma_f32_16x16x32_bf16 v[68:71], a[116:119], v[172:175], v[68:71]
    s_cmp_eq_u32 s58, 32
    s_cselect_b64 s[12:13], s[86:87], s[12:13]
    v_fmac_f32 v129, v61, v61
    v_add_f32 v128, v128, v62
    v_mfma_f32_16x16x32_bf16 v[72:75], a[120:123], v[172:175], v[72:75]
    v_fmac_f32 v129, v62, v62
    v_add_f32 v128, v128, v63
    v_mfma_f32_16x16x32_bf16 v[76:79], a[124:127], v[172:175], v[76:79]
    s_waitcnt lgkmcnt(1)
    v_fmac_f32 v129, v63, v63
    v_mfma_f32_16x16x32_bf16 v[64:67], a[128:131], v[176:179], v[64:67]
    buffer_store_dwordx2 v[122:123], v33, s[24:27], s83 offen sc1
    v_mfma_f32_16x16x32_bf16 v[68:71], a[132:135], v[176:179], v[68:71]
    ds_read_b128 v[184:187], v3 offset:27648
    v_mfma_f32_16x16x32_bf16 v[72:75], a[136:139], v[176:179], v[72:75]
    v_permlane16_swap_b32 v128, v129
    v_mfma_f32_16x16x32_bf16 v[76:79], a[140:143], v[176:179], v[76:79]
    s_waitcnt lgkmcnt(1)
    v_add_f32 v130, v128, v129
    v_add_f32 v128, v128, v129
    v_mfma_f32_16x16x32_bf16 v[64:67], a[144:147], v[180:183], v[64:67]
    s_waitcnt vmcnt(6)
    ds_read_b128 v[188:191], v3 offset:28672
    ds_read_b128 v[112:115], v28
    v_mfma_f32_16x16x32_bf16 v[68:71], a[148:151], v[180:183], v[68:71]
    ds_read_b128 v[116:119], v29
    v_mfma_f32_16x16x32_bf16 v[72:75], a[152:155], v[180:183], v[72:75]
    buffer_store_dwordx2 v[124:125], v34, s[24:27], s83 offen sc1
    v_mfma_f32_16x16x32_bf16 v[76:79], a[156:159], v[180:183], v[76:79]
    s_waitcnt lgkmcnt(3)
    v_permlane32_swap_b32 v128, v130
    v_mfma_f32_16x16x32_bf16 v[64:67], a[160:163], v[184:187], v[64:67]
    ds_read_b128 v[192:195], v3 offset:29696
    v_add_f32 v128, v128, v130
    v_mfma_f32_16x16x32_bf16 v[68:71], a[164:167], v[184:187], v[68:71]
    buffer_store_dword v128, v25, s[16:19], s67 offen sc1
    v_mfma_f32_16x16x32_bf16 v[72:75], a[168:171], v[184:187], v[72:75]
    s_waitcnt lgkmcnt(1)
    v_lshlrev_b32 v48, 16, v112
    v_and_b32 v49, 0xffff0000, v112
    v_mfma_f32_16x16x32_bf16 v[76:79], a[172:175], v[184:187], v[76:79]
    v_lshlrev_b32 v50, 16, v113
    v_and_b32 v51, 0xffff0000, v113
    v_mfma_f32_16x16x32_bf16 v[64:67], a[176:179], v[188:191], v[64:67]
    buffer_store_dwordx2 v[126:127], v35, s[24:27], s83 offen sc1
    v_mfma_f32_16x16x32_bf16 v[68:71], a[180:183], v[188:191], v[68:71]
    s_mov_b32 s83, s60
    ds_read_b128 v[196:199], v3 offset:30720
    v_lshlrev_b32 v52, 16, v114
    v_mfma_f32_16x16x32_bf16 v[72:75], a[184:187], v[188:191], v[72:75]
    s_lshr_b32 s67, s60, 4
    v_add_u32 v7, 1, v7
    v_and_b32 v53, 0xffff0000, v114
    v_mfma_f32_16x16x32_bf16 v[76:79], a[188:191], v[188:191], v[76:79]
    s_waitcnt lgkmcnt(1)
    v_lshlrev_b32 v54, 16, v115
    v_and_b32 v55, 0xffff0000, v115
    v_mfma_f32_16x16x32_bf16 v[64:67], a[192:195], v[192:195], v[64:67]
    ds_read_b128 v[200:203], v3 offset:31744
    v_lshlrev_b32 v56, 16, v116
    v_mfma_f32_16x16x32_bf16 v[68:71], a[196:199], v[192:195], v[68:71]
    v_and_b32 v57, 0xffff0000, v116
    v_lshlrev_b32 v58, 16, v117
    v_mfma_f32_16x16x32_bf16 v[72:75], a[200:203], v[192:195], v[72:75]
    v_and_b32 v59, 0xffff0000, v117
    v_lshlrev_b32 v60, 16, v118
    v_mfma_f32_16x16x32_bf16 v[76:79], a[204:207], v[192:195], v[76:79]
    s_waitcnt lgkmcnt(1)
    v_and_b32 v61, 0xffff0000, v118
    v_lshlrev_b32 v62, 16, v119
    v_mfma_f32_16x16x32_bf16 v[64:67], a[208:211], v[196:199], v[64:67]
    buffer_load_dword v4, v5, s[4:7], s65 offen sc1
    v_mfma_f32_16x16x32_bf16 v[68:71], a[212:215], v[196:199], v[68:71]
    ds_read_b128 v[204:207], v3 offset:32768
    v_and_b32 v63, 0xffff0000, v119
    v_mfma_f32_16x16x32_bf16 v[72:75], a[216:219], v[196:199], v[72:75]
    v_mfma_f32_16x16x32_bf16 v[76:79], a[220:223], v[196:199], v[76:79]
    s_waitcnt lgkmcnt(1)
    v_mfma_f32_16x16x32_bf16 v[64:67], a[224:227], v[200:203], v[64:67]
    v_mfma_f32_16x16x32_bf16 v[68:71], a[228:231], v[200:203], v[68:71]
    s_waitcnt vmcnt(6) lgkmcnt(0)
    s_barrier
    v_mfma_f32_16x16x32_bf16 v[72:75], a[232:235], v[200:203], v[72:75]
    ds_read_b128 v[144:147], v3 offset:0
    v_mfma_f32_16x16x32_bf16 v[76:79], a[236:239], v[200:203], v[76:79]
    ds_read_b128 v[148:151], v3 offset:1024
    v_mfma_f32_16x16x32_bf16 v[64:67], a[240:243], v[204:207], v[64:67]
    ds_read_b128 v[152:155], v3 offset:2048
    v_mfma_f32_16x16x32_bf16 v[68:71], a[244:247], v[204:207], v[68:71]
    s_sub_u32 s61, s61, 1
    ds_read_b128 v[156:159], v3 offset:3072
    v_mfma_f32_16x16x32_bf16 v[72:75], a[248:251], v[204:207], v[72:75]
    s_cmp_lg_u32 s61, 0
    ds_read_b128 v[160:163], v3 offset:4096
    v_mfma_f32_16x16x32_bf16 v[76:79], a[252:255], v[204:207], v[76:79]
    s_cbranch_scc1 L_wo_loop_slow
    s_waitcnt vmcnt(1)
    buffer_store_dword v7, v6, s[4:7], s65 offen sc1
    v_cvt_pk_bf16_f32 v120, v64, v65
    v_cvt_pk_bf16_f32 v121, v66, v67
    buffer_store_dwordx2 v[120:121], v32, s[24:27], s83 offen sc1
    v_cvt_pk_bf16_f32 v122, v68, v69
    v_cvt_pk_bf16_f32 v123, v70, v71
    buffer_store_dwordx2 v[122:123], v33, s[24:27], s83 offen sc1
    v_cvt_pk_bf16_f32 v124, v72, v73
    v_cvt_pk_bf16_f32 v125, v74, v75
    buffer_store_dwordx2 v[124:125], v34, s[24:27], s83 offen sc1
    v_cvt_pk_bf16_f32 v126, v76, v77
    v_cvt_pk_bf16_f32 v127, v78, v79
    buffer_store_dwordx2 v[126:127], v35, s[24:27], s83 offen sc1
    v_add_f32 v128, v64, v65
    v_mul_f32 v129, v64, v64
    v_fmac_f32 v129, v65, v65
    v_add_f32 v128, v128, v66
    v_fmac_f32 v129, v66, v66
    v_add_f32 v128, v128, v67
    v_fmac_f32 v129, v67, v67
    v_add_f32 v128, v128, v68
    v_fmac_f32 v129, v68, v68
    v_add_f32 v128, v128, v69
    v_fmac_f32 v129, v69, v69
    v_add_f32 v128, v128, v70
    v_fmac_f32 v129, v70, v70
    v_add_f32 v128, v128, v71
    v_fmac_f32 v129, v71, v71
    v_add_f32 v128, v128, v72
    v_fmac_f32 v129, v72, v72
    v_add_f32 v128, v128, v73
    v_fmac_f32 v129, v73, v73
    v_add_f32 v128, v128, v74
    v_fmac_f32 v129, v74, v74
    v_add_f32 v128, v128, v75
    v_fmac_f32 v129, v75, v75
    v_add_f32 v128, v128, v76
    v_fmac_f32 v129, v76, v76
    v_add_f32 v128, v128, v77
    v_fmac_f32 v129, v77, v77
    v_add_f32 v128, v128, v78
    v_fmac_f32 v129, v78, v78
    v_add_f32 v128, v128, v79
    v_fmac_f32 v129, v79, v79
    s_nop 1
    v_permlane16_swap_b32 v128, v129
    v_add_f32 v130, v128, v129
    v_add_f32 v128, v128, v129
    s_nop 1
    v_permlane32_swap_b32 v128, v130
    v_add_f32 v128, v128, v130
    buffer_store_dword v128, v25, s[16:19], s67 offen sc1
    v_mov_b32 v7, 64
    s_waitcnt vmcnt(0)
    buffer_store_dword v7, v6, s[4:7], s65 offen sc1
    s_endpgm
.p2align 4
L_gu_loop_slow:
    s_waitcnt lgkmcnt(2)
    v_mfma_f32_16x16x32_bf16 v[48:51], a[0:3], v[144:147], 0
    ds_read2_b32 v[136:137], v24 offset0:0 offset1:32
    ds_read2_b32 v[138:139], v24 offset0:16 offset1:48
    v_mfma_f32_16x16x32_bf16 v[52:55], a[4:7], v[144:147], 0
    v_fma_f32 v112, -v27, v32, v64
    v_fma_f32 v113, -v27, v33, v65
    v_mfma_f32_16x16x32_bf16 v[56:59], a[8:11], v[144:147], 0
    v_fma_f32 v114, -v27, v34, v66
    v_fma_f32 v115, -v27, v35, v67
    v_mfma_f32_16x16x32_bf16 v[60:63], a[12:15], v[144:147], 0
    s_waitcnt lgkmcnt(3)
    v_fma_f32 v116, -v27, v36, v68
    v_fma_f32 v117, -v27, v37, v69
    v_mfma_f32_16x16x32_bf16 v[48:51], a[16:19], v[148:151], v[48:51]
    ds_read2st64_b64 v[156:159], v81 offset0:6 offset1:7
    v_fma_f32 v118, -v27, v38, v70
    v_mfma_f32_16x16x32_bf16 v[52:55], a[20:23], v[148:151], v[52:55]
    v_fma_f32 v119, -v27, v39, v71
    v_fma_f32 v120, -v27, v40, v72
    v_mfma_f32_16x16x32_bf16 v[56:59], a[24:27], v[148:151], v[56:59]
    v_max_f32 v112, 0, v112
    v_fma_f32 v121, -v27, v41, v73
    v_mfma_f32_16x16x32_bf16 v[60:63], a[28:31], v[148:151], v[60:63]
    s_waitcnt lgkmcnt(3)
    v_max_f32 v113, 0, v113
    v_fma_f32 v122, -v27, v42, v74
    v_mfma_f32_16x16x32_bf16 v[48:51], a[32:35], v[152:155], v[48:51]
    ds_read2st64_b64 v[160:163], v80 offset0:9 offset1:10
    v_max_f32 v114, 0, v114
    v_mfma_f32_16x16x32_bf16 v[52:55], a[36:39], v[152:155], v[52:55]
    s_waitcnt vmcnt(0)
    v_cmp_gt_i32 vcc, s58, v4
    v_fma_f32 v123, -v27, v43, v75
    v_mfma_f32_16x16x32_bf16 v[56:59], a[40:43], v[152:155], v[56:59]
    v_max_f32 v115, 0, v115
    v_fma_f32 v124, -v27, v44, v76
    v_mfma_f32_16x16x32_bf16 v[60:63], a[44:47], v[152:155], v[60:63]
    s_waitcnt lgkmcnt(1)
    v_max_f32 v116, 0, v116
    v_fma_f32 v125, -v27, v45, v77
    v_mfma_f32_16x16x32_bf16 v[48:51], a[48:51], v[156:159], v[48:51]
    s_cbranch_vccnz L_spin_gueven_slow
L_ret_gueven_slow:
    ds_read2st64_b64 v[164:167], v80 offset0:11 offset1:12
    v_max_f32 v117, 0, v117
    v_mfma_f32_16x16x32_bf16 v[52:55], a[52:55], v[156:159], v[52:55]
    s_add_u32 m0, s78, 17408
    v_fma_f32 v126, -v27, v46, v78
    v_max_f32 v118, 0, v118
    v_mfma_f32_16x16x32_bf16 v[56:59], a[56:59], v[156:159], v[56:59]
    s_add_u32 s58, s58, 1
    buffer_load_dwordx4 v84, s[12:15], s66 offen offset:256 sc1 lds
    v_mfma_f32_16x16x32_bf16 v[60:63], a[60:63], v[156:159], v[60:63]
    s_waitcnt lgkmcnt(1)
    buffer_load_dwordx4 v85, s[12:15], s66 offen offset:1280 sc1 lds
    v_mfma_f32_16x16x32_bf16 v[48:51], a[64:67], v[160:163], v[48:51]
    ds_read2st64_b64 v[168:171], v80 offset0:13 offset1:14
    v_fma_f32 v127, -v27, v47, v79
    v_mfma_f32_16x16x32_bf16 v[52:55], a[68:71], v[160:163], v[52:55]
    v_max_f32 v119, 0, v119
    v_mul_f32 v120, v120, v31
    v_mfma_f32_16x16x32_bf16 v[56:59], a[72:75], v[160:163], v[56:59]
    v_mul_f32 v121, v121, v31
    v_mul_f32 v122, v122, v31
    v_mfma_f32_16x16x32_bf16 v[60:63], a[76:79], v[160:163], v[60:63]
    s_waitcnt lgkmcnt(1)
    buffer_load_dwordx4 v86, s[12:15], s66 offen offset:2304 sc1 lds
    v_mfma_f32_16x16x32_bf16 v[48:51], a[80:83], v[164:167], v[48:51]
    ds_read2st64_b64 v[172:175], v80 offset0:15 offset1:16
    v_mul_f32 v123, v123, v31
    v_mfma_f32_16x16x32_bf16 v[52:55], a[84:87], v[164:167], v[52:55]
    v_mul_f32 v124, v124, v31
    v_mul_f32 v125, v125, v31
    v_mfma_f32_16x16x32_bf16 v[56:59], a[88:91], v[164:167], v[56:59]
    v_mul_f32 v126, v126, v31
    v_mul_f32 v127, v127, v31
    v_mfma_f32_16x16x32_bf16 v[60:63], a[92:95], v[164:167], v[60:63]
    s_waitcnt lgkmcnt(1)
    buffer_load_dwordx4 v87, s[12:15], s66 offen offset:3328 sc1 lds
    v_mfma_f32_16x16x32_bf16 v[48:51], a[96:99], v[168:171], v[48:51]
    s_lshr_b32 s67, s66, 4
    ds_read2st64_b64 v[176:179], v81 offset0:17 offset1:18
    v_mul_f32 v112, v112, v120
    v_mfma_f32_16x16x32_bf16 v[52:55], a[100:103], v[168:171], v[52:55]
    v_mul_f32 v113, v113, v121
    v_mul_f32 v114, v114, v122
    v_mfma_f32_16x16x32_bf16 v[56:59], a[104:107], v[168:171], v[56:59]
    v_mul_f32 v115, v115, v123
    v_mul_f32 v116, v116, v124
    v_mfma_f32_16x16x32_bf16 v[60:63], a[108:111], v[168:171], v[60:63]
    s_waitcnt lgkmcnt(1)
    buffer_load_dword v22, s[24:27], s67 offen sc1 lds
    v_mfma_f32_16x16x32_bf16 v[48:51], a[112:115], v[172:175], v[48:51]
    s_add_u32 s66, s66, 16384
    ds_read2st64_b64 v[180:183], v81 offset0:19 offset1:20
    v_mul_f32 v117, v117, v125
    v_mfma_f32_16x16x32_bf16 v[52:55], a[116:119], v[172:175], v[52:55]
    s_and_b32 s66, s66, 0x1fffff
    v_mul_f32 v118, v118, v126
    v_mul_f32 v119, v119, v127
    v_mfma_f32_16x16x32_bf16 v[56:59], a[120:123], v[172:175], v[56:59]
    s_cmp_eq_u32 s58, 29
    s_cselect_b32 s66, s77, s66
    v_cvt_pk_bf16_f32 v128, v112, v113
    v_cvt_pk_bf16_f32 v129, v114, v115
    v_mfma_f32_16x16x32_bf16 v[60:63], a[124:127], v[172:175], v[60:63]
    s_waitcnt lgkmcnt(1)
    v_cvt_pk_bf16_f32 v130, v116, v117
    v_cvt_pk_bf16_f32 v131, v118, v119
    v_mfma_f32_16x16x32_bf16 v[48:51], a[128:131], v[176:179], v[48:51]
    s_cmp_eq_u32 s58, 45
    s_cselect_b32 s66, 0x40000000, s66
    buffer_store_dwordx4 v[128:131], v28, s[4:7], s60 offen sc1
    v_mfma_f32_16x16x32_bf16 v[52:55], a[132:135], v[176:179], v[52:55]
    s_add_u32 s60, s60, 65536
    ds_read2st64_b64 v[184:187], v81 offset0:21 offset1:22
    v_add_u32 v7, 1, v7
    v_mfma_f32_16x16x32_bf16 v[56:59], a[136:139], v[176:179], v[56:59]
    s_andn2_b32 s60, s60, 262144
    ds_read2st64_b64 v[188:191], v81 offset0:23 offset1:24
    v_mfma_f32_16x16x32_bf16 v[60:63], a[140:143], v[176:179], v[60:63]
    s_waitcnt lgkmcnt(2)
    v_add_f32 v136, v136, v137
    v_mfma_f32_16x16x32_bf16 v[48:51], a[144:147], v[180:183], v[48:51]
    ds_read2st64_b64 v[192:195], v80 offset0:26 offset1:27
    v_add_f32 v138, v138, v139
    v_mfma_f32_16x16x32_bf16 v[52:55], a[148:151], v[180:183], v[52:55]
    v_mfma_f32_16x16x32_bf16 v[56:59], a[152:155], v[180:183], v[56:59]
    ds_read2st64_b64 v[196:199], v80 offset0:28 offset1:29
    v_mfma_f32_16x16x32_bf16 v[60:63], a[156:159], v[180:183], v[60:63]
    s_waitcnt lgkmcnt(3)
    v_permlane16_swap_b32 v136, v138
    v_mfma_f32_16x16x32_bf16 v[48:51], a[160:163], v[184:187], v[48:51]
    ds_read2st64_b64 v[200:203], v80 offset0:30 offset1:31
    v_add_f32 v137, v136, v138
    v_mfma_f32_16x16x32_bf16 v[52:55], a[164:167], v[184:187], v[52:55]
    v_add_f32 v136, v136, v138
    v_mfma_f32_16x16x32_bf16 v[56:59], a[168:171], v[184:187], v[56:59]
    ds_read2st64_b64 v[204:207], v80 offset0:32 offset1:33
    v_mfma_f32_16x16x32_bf16 v[60:63], a[172:175], v[184:187], v[60:63]
    s_waitcnt lgkmcnt(4)
    v_permlane32_swap_b32 v136, v137
    v_mfma_f32_16x16x32_bf16 v[48:51], a[176:179], v[188:191], v[48:51]
    v_add_u32 v248, 1, v248
    v_add_f32 v136, v136, v137
    v_mfma_f32_16x16x32_bf16 v[52:55], a[180:183], v[188:191], v[52:55]
    v_mul_f32 v138, 0x3b000000, v136
    v_mul_f32 v26, 0x3b000000, v136
    v_mfma_f32_16x16x32_bf16 v[56:59], a[184:187], v[188:191], v[56:59]
    v_mfma_f32_16x16x32_bf16 v[60:63], a[188:191], v[188:191], v[60:63]
    s_waitcnt lgkmcnt(3)
    v_permlane16_swap_b32 v26, v138
    v_mfma_f32_16x16x32_bf16 v[48:51], a[192:195], v[192:195], v[48:51]
    s_waitcnt vmcnt(1) lgkmcnt(0)
    ds_write_b32 v246, v248
    v_mfma_f32_16x16x32_bf16 v[52:55], a[196:199], v[192:195], v[52:55]
    v_fma_f32 v138, -v26, v26, v138
    v_max_f32 v138, 0, v138
    v_mfma_f32_16x16x32_bf16 v[56:59], a[200:203], v[192:195], v[56:59]
    v_add_f32 v138, 0x3727c5ac, v138
    v_mfma_f32_16x16x32_bf16 v[60:63], a[204:207], v[192:195], v[60:63]
    v_rcp_f32 v30, v138
    v_mfma_f32_16x16x32_bf16 v[48:51], a[208:211], v[196:199], v[48:51]
    ds_read_b32 v249, v247
    v_mfma_f32_16x16x32_bf16 v[52:55], a[212:215], v[196:199], v[52:55]
    v_mfma_f32_16x16x32_bf16 v[56:59], a[216:219], v[196:199], v[56:59]
    s_waitcnt vmcnt(0)
    buffer_store_dword v7, v6, s[4:7], s65 offen sc1
    v_mfma_f32_16x16x32_bf16 v[60:63], a[220:223], v[196:199], v[60:63]
    v_mfma_f32_16x16x32_bf16 v[48:51], a[224:227], v[200:203], v[48:51]
    s_waitcnt lgkmcnt(0)
    buffer_load_dword v4, v5, s[4:7], s65 offen sc1
    v_mfma_f32_16x16x32_bf16 v[52:55], a[228:231], v[200:203], v[52:55]
    v_cmp_gt_i32 vcc, v248, v249
    v_mfma_f32_16x16x32_bf16 v[56:59], a[232:235], v[200:203], v[56:59]
    v_mfma_f32_16x16x32_bf16 v[60:63], a[236:239], v[200:203], v[60:63]
    s_cbranch_vccnz L_meet_gu_even_slow
L_ret_meet_gu_even_slow:
    ds_read2st64_b64 v[144:147], v81 offset0:34 offset1:35
    v_mfma_f32_16x16x32_bf16 v[48:51], a[240:243], v[204:207], v[48:51]
    v_mfma_f32_16x16x32_bf16 v[52:55], a[244:247], v[204:207], v[52:55]
    ds_read2st64_b64 v[148:151], v81 offset0:36 offset1:37
    v_mfma_f32_16x16x32_bf16 v[56:59], a[248:251], v[204:207], v[56:59]
    v_mfma_f32_16x16x32_bf16 v[60:63], a[252:255], v[204:207], v[60:63]
    ds_read2st64_b64 v[152:155], v81 offset0:38 offset1:39
L_gu_loop_slow_in:
    s_waitcnt lgkmcnt(2)
    v_mfma_f32_16x16x32_bf16 v[64:67], a[0:3], v[144:147], 0
    ds_read2_b32 v[136:137], v25 offset0:0 offset1:32
    ds_read2_b32 v[138:139], v25 offset0:16 offset1:48
    v_mfma_f32_16x16x32_bf16 v[68:71], a[4:7], v[144:147], 0
    v_fma_f32 v112, -v26, v32, v48
    v_fma_f32 v113, -v26, v33, v49
    v_mfma_f32_16x16x32_bf16 v[72:75], a[8:11], v[144:147], 0
    v_fma_f32 v114, -v26, v34, v50
    v_fma_f32 v115, -v26, v35, v51
    v_mfma_f32_16x16x32_bf16 v[76:79], a[12:15], v[144:147], 0
    s_waitcnt lgkmcnt(3)
    v_fma_f32 v116, -v26, v36, v52
    v_fma_f32 v117, -v26, v37, v53
    v_mfma_f32_16x16x32_bf16 v[64:67], a[16:19], v[148:151], v[64:67]
    ds_read2st64_b64 v[156:159], v81 offset0:40 offset1:41
    v_fma_f32 v118, -v26, v38, v54
    v_mfma_f32_16x16x32_bf16 v[68:71], a[20:23], v[148:151], v[68:71]
    v_fma_f32 v119, -v26, v39, v55
    v_fma_f32 v120, -v26, v40, v56
    v_mfma_f32_16x16x32_bf16 v[72:75], a[24:27], v[148:151], v[72:75]
    v_max_f32 v112, 0, v112
    v_fma_f32 v121, -v26, v41, v57
    v_mfma_f32_16x16x32_bf16 v[76:79], a[28:31], v[148:151], v[76:79]
    s_waitcnt lgkmcnt(3)
    v_max_f32 v113, 0, v113
    v_fma_f32 v122, -v26, v42, v58
    v_mfma_f32_16x16x32_bf16 v[64:67], a[32:35], v[152:155], v[64:67]
    ds_read2st64_b64 v[160:163], v80 offset0:43 offset1:44
    v_max_f32 v114, 0, v114
    v_mfma_f32_16x16x32_bf16 v[68:71], a[36:39], v[152:155], v[68:71]
    s_waitcnt vmcnt(0)
    v_cmp_gt_i32 vcc, s58, v4
    v_fma_f32 v123, -v26, v43, v59
    v_mfma_f32_16x16x32_bf16 v[72:75], a[40:43], v[152:155], v[72:75]
    v_max_f32 v115, 0, v115
    v_fma_f32 v124, -v26, v44, v60
    v_mfma_f32_16x16x32_bf16 v[76:79], a[44:47], v[152:155], v[76:79]
    s_waitcnt lgkmcnt(1)
    v_max_f32 v116, 0, v116
    v_fma_f32 v125, -v26, v45, v61
    v_mfma_f32_16x16x32_bf16 v[64:67], a[48:51], v[156:159], v[64:67]
    s_cbranch_vccnz L_spin_guodd_slow
L_ret_guodd_slow:
    ds_read2st64_b64 v[164:167], v80 offset0:45 offset1:46
    v_max_f32 v117, 0, v117
    v_mfma_f32_16x16x32_bf16 v[68:71], a[52:55], v[156:159], v[68:71]
    s_add_u32 m0, s78, 0
    v_fma_f32 v126, -v26, v46, v62
    v_max_f32 v118, 0, v118
    v_mfma_f32_16x16x32_bf16 v[72:75], a[56:59], v[156:159], v[72:75]
    s_add_u32 s58, s58, 1
    buffer_load_dwordx4 v84, s[12:15], s66 offen offset:256 sc1 lds
    v_mfma_f32_16x16x32_bf16 v[76:79], a[60:63], v[156:159], v[76:79]
    s_waitcnt lgkmcnt(1)
    buffer_load_dwordx4 v85, s[12:15], s66 offen offset:1280 sc1 lds
    v_mfma_f32_16x16x32_bf16 v[64:67], a[64:67], v[160:163], v[64:67]
    ds_read2st64_b64 v[168:171], v80 offset0:47 offset1:48
    v_fma_f32 v127, -v26, v47, v63
    v_mfma_f32_16x16x32_bf16 v[68:71], a[68:71], v[160:163], v[68:71]
    v_max_f32 v119, 0, v119
    v_mul_f32 v120, v120, v30
    v_mfma_f32_16x16x32_bf16 v[72:75], a[72:75], v[160:163], v[72:75]
    v_mul_f32 v121, v121, v30
    v_mul_f32 v122, v122, v30
    v_mfma_f32_16x16x32_bf16 v[76:79], a[76:79], v[160:163], v[76:79]
    s_waitcnt lgkmcnt(1)
    buffer_load_dwordx4 v86, s[12:15], s66 offen offset:2304 sc1 lds
    v_mfma_f32_16x16x32_bf16 v[64:67], a[80:83], v[164:167], v[64:67]
    ds_read2st64_b64 v[172:175], v80 offset0:49 offset1:50
    v_mul_f32 v123, v123, v30
    v_mfma_f32_16x16x32_bf16 v[68:71], a[84:87], v[164:167], v[68:71]
    v_mul_f32 v124, v124, v30
    v_mul_f32 v125, v125, v30
    v_mfma_f32_16x16x32_bf16 v[72:75], a[88:91], v[164:167], v[72:75]
    v_mul_f32 v126, v126, v30
    v_mul_f32 v127, v127, v30
    v_mfma_f32_16x16x32_bf16 v[76:79], a[92:95], v[164:167], v[76:79]
    s_waitcnt lgkmcnt(1)
    buffer_load_dwordx4 v87, s[12:15], s66 offen offset:3328 sc1 lds
    v_mfma_f32_16x16x32_bf16 v[64:67], a[96:99], v[168:171], v[64:67]
    s_lshr_b32 s67, s66, 4
    ds_read2st64_b64 v[176:179], v81 offset0:51 offset1:52
    v_mul_f32 v112, v112, v120
    v_mfma_f32_16x16x32_bf16 v[68:71], a[100:103], v[168:171], v[68:71]
    v_mul_f32 v113, v113, v121
    v_mul_f32 v114, v114, v122
    v_mfma_f32_16x16x32_bf16 v[72:75], a[104:107], v[168:171], v[72:75]
    v_mul_f32 v115, v115, v123
    v_mul_f32 v116, v116, v124
    v_mfma_f32_16x16x32_bf16 v[76:79], a[108:111], v[168:171], v[76:79]
    s_waitcnt lgkmcnt(1)
    buffer_load_dword v22, s[24:27], s67 offen sc1 lds
    v_mfma_f32_16x16x32_bf16 v[64:67], a[112:115], v[172:175], v[64:67]
    s_add_u32 s66, s66, 16384
    ds_read2st64_b64 v[180:183], v81 offset0:53 offset1:54
    v_mul_f32 v117, v117, v125
    v_mfma_f32_16x16x32_bf16 v[68:71], a[116:119], v[172:175], v[68:71]
    s_and_b32 s66, s66, 0x1fffff
    v_mul_f32 v118, v118, v126
    v_mul_f32 v119, v119, v127
    v_mfma_f32_16x16x32_bf16 v[72:75], a[120:123], v[172:175], v[72:75]
    v_cvt_pk_bf16_f32 v128, v112, v113
    v_cvt_pk_bf16_f32 v129, v114, v115
    v_mfma_f32_16x16x32_bf16 v[76:79], a[124:127], v[172:175], v[76:79]
    s_waitcnt lgkmcnt(1)
    v_cvt_pk_bf16_f32 v130, v116, v117
    v_cvt_pk_bf16_f32 v131, v118, v119
    v_mfma_f32_16x16x32_bf16 v[64:67], a[128:131], v[176:179], v[64:67]
    buffer_store_dwordx4 v[128:131], v28, s[4:7], s60 offen sc1
    v_mfma_f32_16x16x32_bf16 v[68:71], a[132:135], v[176:179], v[68:71]
    s_add_u32 s60, s60, 65536
    ds_read2st64_b64 v[184:187], v81 offset0:55 offset1:56
    v_add_u32 v7, 1, v7
    v_mfma_f32_16x16x32_bf16 v[72:75], a[136:139], v[176:179], v[72:75]
    s_andn2_b32 s60, s60, 262144
    ds_read2st64_b64 v[188:191], v81 offset0:57 offset1:58
    v_add_f32 v136, v136, v137
    v_mfma_f32_16x16x32_bf16 v[76:79], a[140:143], v[176:179], v[76:79]
    s_waitcnt lgkmcnt(2)
    v_add_f32 v138, v138, v139
    v_mfma_f32_16x16x32_bf16 v[64:67], a[144:147], v[180:183], v[64:67]
    ds_read2st64_b64 v[192:195], v80 offset0:60 offset1:61
    v_mfma_f32_16x16x32_bf16 v[68:71], a[148:151], v[180:183], v[68:71]
    v_permlane16_swap_b32 v136, v138
    v_mfma_f32_16x16x32_bf16 v[72:75], a[152:155], v[180:183], v[72:75]
    ds_read2st64_b64 v[196:199], v80 offset0:62 offset1:63
    v_add_f32 v137, v136, v138
    v_mfma_f32_16x16x32_bf16 v[76:79], a[156:159], v[180:183], v[76:79]
    s_waitcnt lgkmcnt(3)
    v_add_f32 v136, v136, v138
    v_mfma_f32_16x16x32_bf16 v[64:67], a[160:163], v[184:187], v[64:67]
    ds_read2st64_b64 v[200:203], v80 offset0:64 offset1:65
    v_mfma_f32_16x16x32_bf16 v[68:71], a[164:167], v[184:187], v[68:71]
    v_permlane32_swap_b32 v136, v137
    v_mfma_f32_16x16x32_bf16 v[72:75], a[168:171], v[184:187], v[72:75]
    ds_read2st64_b64 v[204:207], v80 offset0:66 offset1:67
    v_add_f32 v136, v136, v137
    v_mfma_f32_16x16x32_bf16 v[76:79], a[172:175], v[184:187], v[76:79]
    s_waitcnt lgkmcnt(4)
    v_mul_f32 v138, 0x3b000000, v136
    v_mul_f32 v27, 0x3b000000, v136
    v_mfma_f32_16x16x32_bf16 v[64:67], a[176:179], v[188:191], v[64:67]
    v_add_u32 v248, 1, v248
    v_mfma_f32_16x16x32_bf16 v[68:71], a[180:183], v[188:191], v[68:71]
    v_permlane16_swap_b32 v27, v138
    v_mfma_f32_16x16x32_bf16 v[72:75], a[184:187], v[188:191], v[72:75]
    v_fma_f32 v138, -v27, v27, v138
    v_max_f32 v138, 0, v138
    v_mfma_f32_16x16x32_bf16 v[76:79], a[188:191], v[188:191], v[76:79]
    s_waitcnt lgkmcnt(3)
    v_add_f32 v138, 0x3727c5ac, v138
    v_mfma_f32_16x16x32_bf16 v[64:67], a[192:195], v[192:195], v[64:67]
    s_waitcnt vmcnt(1) lgkmcnt(0)
    ds_write_b32 v246, v248
    v_mfma_f32_16x16x32_bf16 v[68:71], a[196:199], v[192:195], v[68:71]
    v_rcp_f32 v31, v138
    v_mfma_f32_16x16x32_bf16 v[72:75], a[200:203], v[192:195], v[72:75]
    v_mfma_f32_16x16x32_bf16 v[76:79], a[204:207], v[192:195], v[76:79]
    v_mfma_f32_16x16x32_bf16 v[64:67], a[208:211], v[196:199], v[64:67]
    ds_read_b32 v249, v247
    v_mfma_f32_16x16x32_bf16 v[68:71], a[212:215], v[196:199], v[68:71]
    v_mfma_f32_16x16x32_bf16 v[72:75], a[216:219], v[196:199], v[72:75]
    s_waitcnt vmcnt(0)
    buffer_store_dword v7, v6, s[4:7], s65 offen sc1
    v_mfma_f32_16x16x32_bf16 v[76:79], a[220:223], v[196:199], v[76:79]
    v_mfma_f32_16x16x32_bf16 v[64:67], a[224:227], v[200:203], v[64:67]
    s_waitcnt lgkmcnt(0)
    buffer_load_dword v4, v5, s[4:7], s65 offen sc1
    v_mfma_f32_16x16x32_bf16 v[68:71], a[228:231], v[200:203], v[68:71]
    v_cmp_gt_i32 vcc, v248, v249
    v_mfma_f32_16x16x32_bf16 v[72:75], a[232:235], v[200:203], v[72:75]
    v_mfma_f32_16x16x32_bf16 v[76:79], a[236:239], v[200:203], v[76:79]
    s_cbranch_vccnz L_meet_gu_odd_slow
L_ret_meet_gu_odd_slow:
    ds_read2st64_b64 v[144:147], v81 offset0:0 offset1:1
    v_mfma_f32_16x16x32_bf16 v[64:67], a[240:243], v[204:207], v[64:67]
    v_mfma_f32_16x16x32_bf16 v[68:71], a[244:247], v[204:207], v[68:71]
    s_sub_u32 s61, s61, 1
    ds_read2st64_b64 v[148:151], v81 offset0:2 offset1:3
    v_mfma_f32_16x16x32_bf16 v[72:75], a[248:251], v[204:207], v[72:75]
    s_cmp_lg_u32 s61, 0
    v_mfma_f32_16x16x32_bf16 v[76:79], a[252:255], v[204:207], v[76:79]
    ds_read2st64_b64 v[152:155], v81 offset0:4 offset1:5
    s_cbranch_scc1 L_gu_loop_slow
    v_fma_f32 v112, -v27, v32, v64
    v_fma_f32 v113, -v27, v33, v65
    v_fma_f32 v114, -v27, v34, v66
    v_fma_f32 v115, -v27, v35, v67
    v_fma_f32 v116, -v27, v36, v68
    v_fma_f32 v117, -v27, v37, v69
    v_fma_f32 v118, -v27, v38, v70
    v_fma_f32 v119, -v27, v39, v71
    v_fma_f32 v120, -v27, v40, v72
    v_max_f32 v112, 0, v112
    v_fma_f32 v121, -v27, v41, v73
    v_max_f32 v113, 0, v113
    v_fma_f32 v122, -v27, v42, v74
    v_max_f32 v114, 0, v114
    v_fma_f32 v123, -v27, v43, v75
    v_max_f32 v115, 0, v115
    v_fma_f32 v124, -v27, v44, v76
    v_max_f32 v116, 0, v116
    v_fma_f32 v125, -v27, v45, v77
    v_max_f32 v117, 0, v117
    v_fma_f32 v126, -v27, v46, v78
    v_max_f32 v118, 0, v118
    v_fma_f32 v127, -v27, v47, v79
    v_max_f32 v119, 0, v119
    v_mul_f32 v120, v120, v31
    v_mul_f32 v121, v121, v31
    v_mul_f32 v122, v122, v31
    v_mul_f32 v123, v123, v31
    v_mul_f32 v124, v124, v31
    v_mul_f32 v125, v125, v31
    v_mul_f32 v126, v126, v31
    v_mul_f32 v127, v127, v31
    v_mul_f32 v112, v112, v120
    v_mul_f32 v113, v113, v121
    v_mul_f32 v114, v114, v122
    v_mul_f32 v115, v115, v123
    v_mul_f32 v116, v116, v124
    v_mul_f32 v117, v117, v125
    v_mul_f32 v118, v118, v126
    v_mul_f32 v119, v119, v127
    v_cvt_pk_bf16_f32 v128, v112, v113
    v_cvt_pk_bf16_f32 v129, v114, v115
    v_cvt_pk_bf16_f32 v130, v116, v117
    v_cvt_pk_bf16_f32 v131, v118, v119
    s_waitcnt vmcnt(0)
    v_cmp_gt_i32 vcc, s58, v4
    s_cbranch_vccnz L_spin_gudr_slow
L_ret_gudr_slow:
    buffer_store_dwordx4 v[128:131], v28, s[4:7], s60 offen sc1
    v_mov_b32 v7, 64
    s_waitcnt vmcnt(0)
    buffer_store_dword v7, v6, s[4:7], s65 offen sc1
    s_endpgm
.p2align 4
L_dn_loop_slow:
    s_waitcnt vmcnt(9)
    v_mfma_f32_16x16x32_bf16 v[48:51], a[0:3], v[80:83], 0
    ds_read_b64 v[40:41], v28
    v_mfma_f32_16x16x32_bf16 v[52:55], a[4:7], v[80:83], 0
    ds_write_b128 v29, v[64:67] offset:17408
    v_mfma_f32_16x16x32_bf16 v[56:59], a[8:11], v[80:83], 0
    s_waitcnt vmcnt(8)
    buffer_load_dword v4, v5, s[4:7], s65 offen sc1
    v_mfma_f32_16x16x32_bf16 v[48:51], a[16:19], v[84:87], v[48:51]
    buffer_load_dwordx4 v[108:111], v25, s[4:7], s59 offen offset:3072 sc1
    v_mfma_f32_16x16x32_bf16 v[52:55], a[20:23], v[84:87], v[52:55]
    v_mfma_f32_16x16x32_bf16 v[56:59], a[24:27], v[84:87], v[56:59]
    s_waitcnt vmcnt(9)
    ds_write_b128 v29, v[68:71] offset:17472
    v_mfma_f32_16x16x32_bf16 v[48:51], a[32:35], v[88:91], v[48:51]
    s_waitcnt lgkmcnt(2)
    v_lshlrev_b32 v60, 16, v40
    v_and_b32 v61, 0xffff0000, v40
    v_mfma_f32_16x16x32_bf16 v[52:55], a[36:39], v[88:91], v[52:55]
    v_lshlrev_b32 v62, 16, v41
    v_and_b32 v63, 0xffff0000, v41
    v_mfma_f32_16x16x32_bf16 v[56:59], a[40:43], v[88:91], v[56:59]
    buffer_load_dwordx4 v[112:115], v26, s[4:7], s59 offen offset:0 sc1
    v_mfma_f32_16x16x32_bf16 v[60:63], a[12:15], v[80:83], v[60:63]
    buffer_load_dwordx4 v[116:119], v26, s[4:7], s59 offen offset:1024 sc1
    v_mfma_f32_16x16x32_bf16 v[60:63], a[28:31], v[84:87], v[60:63]
    ds_write_b128 v29, v[72:75] offset:17536
    v_mfma_f32_16x16x32_bf16 v[60:63], a[44:47], v[88:91], v[60:63]
    s_waitcnt vmcnt(10)
    v_mfma_f32_16x16x32_bf16 v[48:51], a[48:51], v[92:95], v[48:51]
    buffer_load_dwordx4 v[120:123], v26, s[4:7], s59 offen offset:2048 sc1
    v_mfma_f32_16x16x32_bf16 v[52:55], a[52:55], v[92:95], v[52:55]
    ds_write_b128 v29, v[76:79] offset:17600
    v_mfma_f32_16x16x32_bf16 v[56:59], a[56:59], v[92:95], v[56:59]
    s_waitcnt vmcnt(5)
    v_add_u32 v7, 1, v7
    v_mfma_f32_16x16x32_bf16 v[60:63], a[60:63], v[92:95], v[60:63]
    buffer_store_dword v7, v6, s[4:7], s65 offen sc1
    v_mfma_f32_16x16x32_bf16 v[48:51], a[64:67], v[96:99], v[48:51]
    buffer_load_dwordx4 v[124:127], v26, s[4:7], s59 offen offset:3072 sc1
    v_mfma_f32_16x16x32_bf16 v[52:55], a[68:71], v[96:99], v[52:55]
    v_mfma_f32_16x16x32_bf16 v[56:59], a[72:75], v[96:99], v[56:59]
    v_mfma_f32_16x16x32_bf16 v[60:63], a[76:79], v[96:99], v[60:63]
    s_waitcnt lgkmcnt(0)
    s_barrier
    v_mfma_f32_16x16x32_bf16 v[48:51], a[80:83], v[100:103], v[48:51]
    buffer_load_dwordx4 v[128:131], v27, s[4:7], s59 offen offset:0 sc1
    v_mfma_f32_16x16x32_bf16 v[52:55], a[84:87], v[100:103], v[52:55]
    ds_read2_b64 v[136:139], v224 offset0:16 offset1:0
    ds_read2_b64 v[140:143], v225 offset0:16 offset1:0
    v_mfma_f32_16x16x32_bf16 v[56:59], a[88:91], v[100:103], v[56:59]
    buffer_load_dwordx4 v[132:135], v27, s[4:7], s59 offen offset:1024 sc1
    v_mfma_f32_16x16x32_bf16 v[60:63], a[92:95], v[100:103], v[60:63]
    ds_read2_b64 v[144:147], v226 offset0:0 offset1:16
    ds_read2_b64 v[148:151], v227 offset0:0 offset1:16
    v_mfma_f32_16x16x32_bf16 v[48:51], a[96:99], v[104:107], v[48:51]
    s_waitcnt vmcnt(8)
    v_cmp_gt_i32 vcc, s58, v4
    s_add_u32 s59, s59, 131072
    v_mfma_f32_16x16x32_bf16 v[52:55], a[100:103], v[104:107], v[52:55]
    s_andn2_b32 s59, s59, 262144
    v_mfma_f32_16x16x32_bf16 v[56:59], a[104:107], v[104:107], v[56:59]
    s_cbranch_vccnz L_spin_dneven_slow
L_ret_dneven_slow:
    buffer_load_dword v31, s[12:15], s66 offen offset:0 sc1 lds
    v_mfma_f32_16x16x32_bf16 v[60:63], a[108:111], v[104:107], v[60:63]
    s_waitcnt vmcnt(8)
    buffer_load_dword v32, s[12:15], s66 offen offset:256 sc1 lds
    v_mfma_f32_16x16x32_bf16 v[48:51], a[112:115], v[108:111], v[48:51]
    s_add_u32 s58, s58, 1
    buffer_load_dwordx4 v[80:83], v24, s[4:7], s60 offen offset:0 sc1
    v_mfma_f32_16x16x32_bf16 v[52:55], a[116:119], v[108:111], v[52:55]
    s_mov_b32 s76, s66
    s_waitcnt lgkmcnt(2)
    v_add_f32 v136, v136, v140
    v_mfma_f32_16x16x32_bf16 v[56:59], a[120:123], v[108:111], v[56:59]
    s_add_u32 s66, s66, 16384
    v_add_f32 v137, v137, v141
    v_add_f32 v138, v138, v142
    v_mfma_f32_16x16x32_bf16 v[60:63], a[124:127], v[108:111], v[60:63]
    s_waitcnt vmcnt(9)
    buffer_load_dwordx4 v[84:87], v24, s[4:7], s60 offen offset:1024 sc1
    v_mfma_f32_16x16x32_bf16 v[48:51], a[128:131], v[112:115], v[48:51]
    s_and_b32 s66, s66, 0x1fffff
    v_add_f32 v139, v139, v143
    s_cmp_eq_u32 s58, 18
    s_cselect_b32 s66, s77, s66
    v_mfma_f32_16x16x32_bf16 v[52:55], a[132:135], v[112:115], v[52:55]
    s_waitcnt lgkmcnt(0)
    v_add_f32 v144, v144, v148
    v_add_f32 v145, v145, v149
    v_mfma_f32_16x16x32_bf16 v[56:59], a[136:139], v[112:115], v[56:59]
    buffer_load_dwordx4 v[88:91], v24, s[4:7], s60 offen offset:2048 sc1
    v_mfma_f32_16x16x32_bf16 v[60:63], a[140:143], v[112:115], v[60:63]
    s_waitcnt vmcnt(10)
    v_add_f32 v146, v146, v150
    v_add_f32 v147, v147, v151
    v_mfma_f32_16x16x32_bf16 v[48:51], a[144:147], v[116:119], v[48:51]
    v_add_f32 v136, v136, v144
    v_add_f32 v137, v137, v145
    v_mfma_f32_16x16x32_bf16 v[52:55], a[148:151], v[116:119], v[52:55]
    v_add_f32 v138, v138, v146
    v_add_f32 v139, v139, v147
    v_mfma_f32_16x16x32_bf16 v[56:59], a[152:155], v[116:119], v[56:59]
    buffer_load_dwordx4 v[92:95], v24, s[4:7], s60 offen offset:3072 sc1
    v_mfma_f32_16x16x32_bf16 v[60:63], a[156:159], v[116:119], v[60:63]
    s_waitcnt vmcnt(10)
    v_add_f32 v144, v136, v137
    v_mul_f32 v145, v136, v136
    v_mfma_f32_16x16x32_bf16 v[48:51], a[160:163], v[120:123], v[48:51]
    v_fmac_f32 v145, v137, v137
    v_add_f32 v144, v144, v138
    v_mfma_f32_16x16x32_bf16 v[52:55], a[164:167], v[120:123], v[52:55]
    buffer_load_dwordx4 v[96:99], v25, s[4:7], s60 offen offset:0 sc1
    v_mfma_f32_16x16x32_bf16 v[56:59], a[168:171], v[120:123], v[56:59]
    v_fmac_f32 v145, v138, v138
    v_add_f32 v144, v144, v139
    v_mfma_f32_16x16x32_bf16 v[60:63], a[172:175], v[120:123], v[60:63]
    s_waitcnt vmcnt(9)
    v_fmac_f32 v145, v139, v139
    v_add_f32_dpp v144, v144, v144 quad_perm:[1,0,3,2] row_mask:0xf bank_mask:0xf
    v_mfma_f32_16x16x32_bf16 v[48:51], a[176:179], v[124:127], v[48:51]
    v_add_f32_dpp v145, v145, v145 quad_perm:[1,0,3,2] row_mask:0xf bank_mask:0xf
    v_cndmask_b32 v144, v144, v145, s[28:29]
    v_mfma_f32_16x16x32_bf16 v[52:55], a[180:183], v[124:127], v[52:55]
    buffer_load_dwordx4 v[100:103], v25, s[4:7], s60 offen offset:1024 sc1
    v_mfma_f32_16x16x32_bf16 v[56:59], a[184:187], v[124:127], v[56:59]
    v_add_f32_dpp v144, v144, v144 row_ror:2 row_mask:0xf bank_mask:0xf
    v_cvt_pk_bf16_f32 v140, v136, v137
    v_mfma_f32_16x16x32_bf16 v[60:63], a[188:191], v[124:127], v[60:63]
    s_waitcnt vmcnt(9)
    v_cvt_pk_bf16_f32 v141, v138, v139
    v_mfma_f32_16x16x32_bf16 v[48:51], a[192:195], v[128:131], v[48:51]
    v_add_f32_dpp v144, v144, v144 row_ror:4 row_mask:0xf bank_mask:0xf
    v_mfma_f32_16x16x32_bf16 v[52:55], a[196:199], v[128:131], v[52:55]
    buffer_store_dword v140, v33, s[12:15], s83 offen offset:0 sc1
    v_mfma_f32_16x16x32_bf16 v[56:59], a[200:203], v[128:131], v[56:59]
    buffer_store_dword v141, v33, s[12:15], s83 offen offset:64 sc1
    v_mfma_f32_16x16x32_bf16 v[60:63], a[204:207], v[128:131], v[60:63]
    s_waitcnt vmcnt(10)
    v_add_f32_dpp v144, v144, v144 row_ror:8 row_mask:0xf bank_mask:0xf
    ds_bpermute_b32 v145, v30, v144
    v_mfma_f32_16x16x32_bf16 v[48:51], a[208:211], v[132:135], v[48:51]
    s_mov_b32 s83, s82
    buffer_load_dwordx4 v[104:107], v25, s[4:7], s60 offen offset:2048 sc1
    v_mfma_f32_16x16x32_bf16 v[52:55], a[212:215], v[132:135], v[52:55]
    v_mfma_f32_16x16x32_bf16 v[56:59], a[216:219], v[132:135], v[56:59]
    v_mfma_f32_16x16x32_bf16 v[60:63], a[220:223], v[132:135], v[60:63]
    s_waitcnt lgkmcnt(0)
    buffer_store_dword v145, v34, s[16:19], s67 offen sc1
    s_lshr_b32 s67, s82, 4
    s_waitcnt vmcnt(9)
    v_mfma_f32_16x16x32_bf16 v[64:67], a[0:3], v[80:83], 0
    ds_read_b64 v[40:41], v28
    v_mfma_f32_16x16x32_bf16 v[68:71], a[4:7], v[80:83], 0
    ds_write_b128 v29, v[48:51] offset:0
    v_mfma_f32_16x16x32_bf16 v[72:75], a[8:11], v[80:83], 0
    s_waitcnt vmcnt(8)
    buffer_load_dword v4, v5, s[4:7], s65 offen sc1
    v_mfma_f32_16x16x32_bf16 v[64:67], a[16:19], v[84:87], v[64:67]
    buffer_load_dwordx4 v[108:111], v25, s[4:7], s60 offen offset:3072 sc1
    v_mfma_f32_16x16x32_bf16 v[68:71], a[20:23], v[84:87], v[68:71]
    v_mfma_f32_16x16x32_bf16 v[72:75], a[24:27], v[84:87], v[72:75]
    s_waitcnt vmcnt(9)
    ds_write_b128 v29, v[52:55] offset:64
    v_mfma_f32_16x16x32_bf16 v[64:67], a[32:35], v[88:91], v[64:67]
    s_waitcnt lgkmcnt(2)
    v_lshlrev_b32 v76, 16, v40
    v_and_b32 v77, 0xffff0000, v40
    v_mfma_f32_16x16x32_bf16 v[68:71], a[36:39], v[88:91], v[68:71]
    v_lshlrev_b32 v78, 16, v41
    v_and_b32 v79, 0xffff0000, v41
    v_mfma_f32_16x16x32_bf16 v[72:75], a[40:43], v[88:91], v[72:75]
    buffer_load_dwordx4 v[112:115], v26, s[4:7], s60 offen offset:0 sc1
    v_mfma_f32_16x16x32_bf16 v[76:79], a[12:15], v[80:83], v[76:79]
    buffer_load_dwordx4 v[116:119], v26, s[4:7], s60 offen offset:1024 sc1
    v_mfma_f32_16x16x32_bf16 v[76:79], a[28:31], v[84:87], v[76:79]
    ds_write_b128 v29, v[56:59] offset:128
    v_mfma_f32_16x16x32_bf16 v[76:79], a[44:47], v[88:91], v[76:79]
    s_waitcnt vmcnt(10)
    v_mfma_f32_16x16x32_bf16 v[64:67], a[48:51], v[92:95], v[64:67]
    buffer_load_dwordx4 v[120:123], v26, s[4:7], s60 offen offset:2048 sc1
    v_mfma_f32_16x16x32_bf16 v[68:71], a[52:55], v[92:95], v[68:71]
    ds_write_b128 v29, v[60:63] offset:192
    v_mfma_f32_16x16x32_bf16 v[72:75], a[56:59], v[92:95], v[72:75]
    s_waitcnt vmcnt(5)
    v_add_u32 v7, 1, v7
    v_mfma_f32_16x16x32_bf16 v[76:79], a[60:63], v[92:95], v[76:79]
    buffer_store_dword v7, v6, s[4:7], s65 offen sc1
    v_mfma_f32_16x16x32_bf16 v[64:67], a[64:67], v[96:99], v[64:67]
    buffer_load_dwordx4 v[124:127], v26, s[4:7], s60 offen offset:3072 sc1
    v_mfma_f32_16x16x32_bf16 v[68:71], a[68:71], v[96:99], v[68:71]
    v_mfma_f32_16x16x32_bf16 v[72:75], a[72:75], v[96:99], v[72:75]
    v_mfma_f32_16x16x32_bf16 v[76:79], a[76:79], v[96:99], v[76:79]
    s_waitcnt lgkmcnt(0)
    s_barrier
    v_mfma_f32_16x16x32_bf16 v[64:67], a[80:83], v[100:103], v[64:67]
    buffer_load_dwordx4 v[128:131], v27, s[4:7], s60 offen offset:0 sc1
    v_mfma_f32_16x16x32_bf16 v[68:71], a[84:87], v[100:103], v[68:71]
    ds_read2_b64 v[136:139], v220 offset0:16 offset1:0
    ds_read2_b64 v[140:143], v221 offset0:16 offset1:0
    v_mfma_f32_16x16x32_bf16 v[72:75], a[88:91], v[100:103], v[72:75]
    buffer_load_dwordx4 v[132:135], v27, s[4:7], s60 offen offset:1024 sc1
    v_mfma_f32_16x16x32_bf16 v[76:79], a[92:95], v[100:103], v[76:79]
    ds_read2_b64 v[144:147], v222 offset0:0 offset1:16
    ds_read2_b64 v[148:151], v223 offset0:0 offset1:16
    v_mfma_f32_16x16x32_bf16 v[64:67], a[96:99], v[104:107], v[64:67]
    s_waitcnt vmcnt(8)
    v_cmp_gt_i32 vcc, s58, v4
    s_add_u32 s60, s60, 131072
    v_mfma_f32_16x16x32_bf16 v[68:71], a[100:103], v[104:107], v[68:71]
    s_andn2_b32 s60, s60, 262144
    v_mfma_f32_16x16x32_bf16 v[72:75], a[104:107], v[104:107], v[72:75]
    s_cbranch_vccnz L_spin_dnodd_slow
L_ret_dnodd_slow:
    buffer_load_dword v31, s[12:15], s66 offen offset:0 sc1 lds
    v_mfma_f32_16x16x32_bf16 v[76:79], a[108:111], v[104:107], v[76:79]
    s_waitcnt vmcnt(8)
    buffer_load_dword v32, s[12:15], s66 offen offset:256 sc1 lds
    v_mfma_f32_16x16x32_bf16 v[64:67], a[112:115], v[108:111], v[64:67]
    s_add_u32 s58, s58, 1
    buffer_load_dwordx4 v[80:83], v24, s[4:7], s59 offen offset:0 sc1
    v_mfma_f32_16x16x32_bf16 v[68:71], a[116:119], v[108:111], v[68:71]
    s_mov_b32 s82, s66
    s_waitcnt lgkmcnt(2)
    v_add_f32 v136, v136, v140
    v_mfma_f32_16x16x32_bf16 v[72:75], a[120:123], v[108:111], v[72:75]
    s_add_u32 s66, s66, 16384
    v_add_f32 v137, v137, v141
    v_add_f32 v138, v138, v142
    v_mfma_f32_16x16x32_bf16 v[76:79], a[124:127], v[108:111], v[76:79]
    s_waitcnt vmcnt(9)
    buffer_load_dwordx4 v[84:87], v24, s[4:7], s59 offen offset:1024 sc1
    v_mfma_f32_16x16x32_bf16 v[64:67], a[128:131], v[112:115], v[64:67]
    s_and_b32 s66, s66, 0x1fffff
    v_add_f32 v139, v139, v143
    v_mfma_f32_16x16x32_bf16 v[68:71], a[132:135], v[112:115], v[68:71]
    s_waitcnt lgkmcnt(0)
    v_add_f32 v144, v144, v148
    v_add_f32 v145, v145, v149
    v_mfma_f32_16x16x32_bf16 v[72:75], a[136:139], v[112:115], v[72:75]
    buffer_load_dwordx4 v[88:91], v24, s[4:7], s59 offen offset:2048 sc1
    v_mfma_f32_16x16x32_bf16 v[76:79], a[140:143], v[112:115], v[76:79]
    s_waitcnt vmcnt(10)
    v_add_f32 v146, v146, v150
    v_add_f32 v147, v147, v151
    v_mfma_f32_16x16x32_bf16 v[64:67], a[144:147], v[116:119], v[64:67]
    v_add_f32 v136, v136, v144
    v_add_f32 v137, v137, v145
    v_mfma_f32_16x16x32_bf16 v[68:71], a[148:151], v[116:119], v[68:71]
    v_add_f32 v138, v138, v146
    v_add_f32 v139, v139, v147
    v_mfma_f32_16x16x32_bf16 v[72:75], a[152:155], v[116:119], v[72:75]
    buffer_load_dwordx4 v[92:95], v24, s[4:7], s59 offen offset:3072 sc1
    v_mfma_f32_16x16x32_bf16 v[76:79], a[156:159], v[116:119], v[76:79]
    s_waitcnt vmcnt(10)
    v_add_f32 v144, v136, v137
    v_mul_f32 v145, v136, v136
    v_mfma_f32_16x16x32_bf16 v[64:67], a[160:163], v[120:123], v[64:67]
    v_fmac_f32 v145, v137, v137
    v_add_f32 v144, v144, v138
    v_mfma_f32_16x16x32_bf16 v[68:71], a[164:167], v[120:123], v[68:71]
    buffer_load_dwordx4 v[96:99], v25, s[4:7], s59 offen offset:0 sc1
    v_mfma_f32_16x16x32_bf16 v[72:75], a[168:171], v[120:123], v[72:75]
    v_fmac_f32 v145, v138, v138
    v_add_f32 v144, v144, v139
    v_mfma_f32_16x16x32_bf16 v[76:79], a[172:175], v[120:123], v[76:79]
    s_waitcnt vmcnt(9)
    v_fmac_f32 v145, v139, v139
    v_add_f32_dpp v144, v144, v144 quad_perm:[1,0,3,2] row_mask:0xf bank_mask:0xf
    v_mfma_f32_16x16x32_bf16 v[64:67], a[176:179], v[124:127], v[64:67]
    v_add_f32_dpp v145, v145, v145 quad_perm:[1,0,3,2] row_mask:0xf bank_mask:0xf
    v_cndmask_b32 v144, v144, v145, s[28:29]
    v_mfma_f32_16x16x32_bf16 v[68:71], a[180:183], v[124:127], v[68:71]
    buffer_load_dwordx4 v[100:103], v25, s[4:7], s59 offen offset:1024 sc1
    v_mfma_f32_16x16x32_bf16 v[72:75], a[184:187], v[124:127], v[72:75]
    v_add_f32_dpp v144, v144, v144 row_ror:2 row_mask:0xf bank_mask:0xf
    v_cvt_pk_bf16_f32 v140, v136, v137
    v_mfma_f32_16x16x32_bf16 v[76:79], a[188:191], v[124:127], v[76:79]
    s_waitcnt vmcnt(9)
    v_cvt_pk_bf16_f32 v141, v138, v139
    v_mfma_f32_16x16x32_bf16 v[64:67], a[192:195], v[128:131], v[64:67]
    v_add_f32_dpp v144, v144, v144 row_ror:4 row_mask:0xf bank_mask:0xf
    v_mfma_f32_16x16x32_bf16 v[68:71], a[196:199], v[128:131], v[68:71]
    buffer_store_dword v140, v33, s[12:15], s83 offen offset:0 sc1
    v_mfma_f32_16x16x32_bf16 v[72:75], a[200:203], v[128:131], v[72:75]
    buffer_store_dword v141, v33, s[12:15], s83 offen offset:64 sc1
    v_mfma_f32_16x16x32_bf16 v[76:79], a[204:207], v[128:131], v[76:79]
    s_waitcnt vmcnt(10)
    v_add_f32_dpp v144, v144, v144 row_ror:8 row_mask:0xf bank_mask:0xf
    ds_bpermute_b32 v145, v30, v144
    v_mfma_f32_16x16x32_bf16 v[64:67], a[208:211], v[132:135], v[64:67]
    s_mov_b32 s83, s76
    buffer_load_dwordx4 v[104:107], v25, s[4:7], s59 offen offset:2048 sc1
    v_mfma_f32_16x16x32_bf16 v[68:71], a[212:215], v[132:135], v[68:71]
    v_mfma_f32_16x16x32_bf16 v[72:75], a[216:219], v[132:135], v[72:75]
    v_mfma_f32_16x16x32_bf16 v[76:79], a[220:223], v[132:135], v[76:79]
    s_waitcnt lgkmcnt(0)
    buffer_store_dword v145, v34, s[16:19], s67 offen sc1
    s_lshr_b32 s67, s76, 4
    s_sub_u32 s61, s61, 1
    s_cmp_lg_u32 s61, 0
    s_cbranch_scc1 L_dn_loop_slow
    s_mov_b32 s61, 7
.p2align 4
L_dn_loop2_slow:
    s_waitcnt vmcnt(8)
    v_mfma_f32_16x16x32_bf16 v[48:51], a[0:3], v[80:83], 0
    ds_read_b64 v[40:41], v28
    v_mfma_f32_16x16x32_bf16 v[52:55], a[4:7], v[80:83], 0
    ds_write_b128 v29, v[64:67] offset:17408
    v_mfma_f32_16x16x32_bf16 v[56:59], a[8:11], v[80:83], 0
    s_waitcnt vmcnt(7)
    buffer_load_dword v4, v5, s[4:7], s65 offen sc1
    v_mfma_f32_16x16x32_bf16 v[48:51], a[16:19], v[84:87], v[48:51]
    buffer_load_dwordx4 v[108:111], v25, s[4:7], s59 offen offset:3072 sc1
    v_mfma_f32_16x16x32_bf16 v[52:55], a[20:23], v[84:87], v[52:55]
    v_mfma_f32_16x16x32_bf16 v[56:59], a[24:27], v[84:87], v[56:59]
    s_waitcnt vmcnt(8)
    ds_write_b128 v29, v[68:71] offset:17472
    v_mfma_f32_16x16x32_bf16 v[48:51], a[32:35], v[88:91], v[48:51]
    s_waitcnt lgkmcnt(2)
    v_lshlrev_b32 v60, 16, v40
    v_and_b32 v61, 0xffff0000, v40
    v_mfma_f32_16x16x32_bf16 v[52:55], a[36:39], v[88:91], v[52:55]
    v_lshlrev_b32 v62, 16, v41
    v_and_b32 v63, 0xffff0000, v41
    v_mfma_f32_16x16x32_bf16 v[56:59], a[40:43], v[88:91], v[56:59]
    buffer_load_dwordx4 v[112:115], v26, s[4:7], s59 offen offset:0 sc1
    v_mfma_f32_16x16x32_bf16 v[60:63], a[12:15], v[80:83], v[60:63]
    buffer_load_dwordx4 v[116:119], v26, s[4:7], s59 offen offset:1024 sc1
    v_mfma_f32_16x16x32_bf16 v[60:63], a[28:31], v[84:87], v[60:63]
    v_add_u32 v7, 1, v7
    v_mfma_f32_16x16x32_bf16 v[60:63], a[44:47], v[88:91], v[60:63]
    s_waitcnt vmcnt(7)
    ds_write_b128 v29, v[72:75] offset:17536
    v_mfma_f32_16x16x32_bf16 v[48:51], a[48:51], v[92:95], v[48:51]
    buffer_store_dword v7, v6, s[4:7], s65 offen sc1
    v_mfma_f32_16x16x32_bf16 v[52:55], a[52:55], v[92:95], v[52:55]
    ds_write_b128 v29, v[76:79] offset:17600
    v_mfma_f32_16x16x32_bf16 v[56:59], a[56:59], v[92:95], v[56:59]
    buffer_load_dwordx4 v[120:123], v26, s[4:7], s59 offen offset:2048 sc1
    v_mfma_f32_16x16x32_bf16 v[60:63], a[60:63], v[92:95], v[60:63]
    s_waitcnt vmcnt(8)
    v_mfma_f32_16x16x32_bf16 v[48:51], a[64:67], v[96:99], v[48:51]
    v_mfma_f32_16x16x32_bf16 v[52:55], a[68:71], v[96:99], v[52:55]
    buffer_load_dwordx4 v[124:127], v26, s[4:7], s59 offen offset:3072 sc1
    v_mfma_f32_16x16x32_bf16 v[56:59], a[72:75], v[96:99], v[56:59]
    v_mfma_f32_16x16x32_bf16 v[60:63], a[76:79], v[96:99], v[60:63]
    s_waitcnt vmcnt(8)
    s_waitcnt lgkmcnt(0)
    s_barrier
    v_mfma_f32_16x16x32_bf16 v[48:51], a[80:83], v[100:103], v[48:51]
    buffer_load_dwordx4 v[128:131], v27, s[4:7], s59 offen offset:0 sc1
    v_mfma_f32_16x16x32_bf16 v[52:55], a[84:87], v[100:103], v[52:55]
    ds_read2_b64 v[136:139], v224 offset0:16 offset1:0
    ds_read2_b64 v[140:143], v225 offset0:16 offset1:0
    v_mfma_f32_16x16x32_bf16 v[56:59], a[88:91], v[100:103], v[56:59]
    buffer_load_dwordx4 v[132:135], v27, s[4:7], s59 offen offset:1024 sc1
    v_mfma_f32_16x16x32_bf16 v[60:63], a[92:95], v[100:103], v[60:63]
    s_waitcnt vmcnt(9)
    ds_read2_b64 v[144:147], v226 offset0:0 offset1:16
    ds_read2_b64 v[148:151], v227 offset0:0 offset1:16
    v_mfma_f32_16x16x32_bf16 v[48:51], a[96:99], v[104:107], v[48:51]
    s_waitcnt vmcnt(8)
    v_cmp_gt_i32 vcc, s58, v4
    s_add_u32 s59, s59, 131072
    v_mfma_f32_16x16x32_bf16 v[52:55], a[100:103], v[104:107], v[52:55]
    s_andn2_b32 s59, s59, 262144
    v_mfma_f32_16x16x32_bf16 v[56:59], a[104:107], v[104:107], v[56:59]
    s_cbranch_vccnz L_spin_dneven2_slow
L_ret_dneven2_slow:
    buffer_load_dword v31, s[12:15], s66 offen offset:0 sc1 lds
    v_mfma_f32_16x16x32_bf16 v[60:63], a[108:111], v[104:107], v[60:63]
    s_waitcnt vmcnt(8)
    buffer_load_dword v32, s[12:15], s66 offen offset:256 sc1 lds
    v_mfma_f32_16x16x32_bf16 v[48:51], a[112:115], v[108:111], v[48:51]
    s_add_u32 s58, s58, 1
    buffer_load_dwordx4 v[80:83], v24, s[4:7], s60 offen offset:0 sc1
    v_mfma_f32_16x16x32_bf16 v[52:55], a[116:119], v[108:111], v[52:55]
    s_mov_b32 s76, s66
    s_waitcnt lgkmcnt(2)
    v_add_f32 v136, v136, v140
    v_mfma_f32_16x16x32_bf16 v[56:59], a[120:123], v[108:111], v[56:59]
    s_add_u32 s66, s66, 16384
    v_add_f32 v137, v137, v141
    v_add_f32 v138, v138, v142
    v_mfma_f32_16x16x32_bf16 v[60:63], a[124:127], v[108:111], v[60:63]
    s_waitcnt vmcnt(9)
    v_add_f32 v139, v139, v143
    s_and_b32 s66, s66, 0x1fffff
    v_mfma_f32_16x16x32_bf16 v[48:51], a[128:131], v[112:115], v[48:51]
    s_cmp_eq_u32 s58, 34
    s_cselect_b32 s66, 0x40000000, s66
    buffer_load_dwordx4 v[84:87], v24, s[4:7], s60 offen offset:1024 sc1
    v_mfma_f32_16x16x32_bf16 v[52:55], a[132:135], v[112:115], v[52:55]
    s_waitcnt lgkmcnt(0)
    v_add_f32 v144, v144, v148
    v_add_f32 v145, v145, v149
    v_mfma_f32_16x16x32_bf16 v[56:59], a[136:139], v[112:115], v[56:59]
    v_add_f32 v146, v146, v150
    v_add_f32 v147, v147, v151
    v_mfma_f32_16x16x32_bf16 v[60:63], a[140:143], v[112:115], v[60:63]
    s_waitcnt vmcnt(9)
    buffer_load_dwordx4 v[88:91], v24, s[4:7], s60 offen offset:2048 sc1
    v_mfma_f32_16x16x32_bf16 v[48:51], a[144:147], v[116:119], v[48:51]
    v_add_f32 v136, v136, v144
    v_add_f32 v137, v137, v145
    v_mfma_f32_16x16x32_bf16 v[52:55], a[148:151], v[116:119], v[52:55]
    v_add_f32 v138, v138, v146
    v_add_f32 v139, v139, v147
    v_mfma_f32_16x16x32_bf16 v[56:59], a[152:155], v[116:119], v[56:59]
    v_cvt_pk_bf16_f32 v140, v136, v137
    v_cvt_pk_bf16_f32 v141, v138, v139
    v_mfma_f32_16x16x32_bf16 v[60:63], a[156:159], v[116:119], v[60:63]
    s_waitcnt vmcnt(8)
    buffer_store_dword v140, v33, s[12:15], s83 offen offset:0
    v_mfma_f32_16x16x32_bf16 v[48:51], a[160:163], v[120:123], v[48:51]
    v_mfma_f32_16x16x32_bf16 v[52:55], a[164:167], v[120:123], v[52:55]
    buffer_store_dword v141, v33, s[12:15], s83 offen offset:64
    v_mfma_f32_16x16x32_bf16 v[56:59], a[168:171], v[120:123], v[56:59]
    s_mov_b32 s83, s82
    v_mfma_f32_16x16x32_bf16 v[60:63], a[172:175], v[120:123], v[60:63]
    s_waitcnt vmcnt(9)
    buffer_load_dwordx4 v[92:95], v24, s[4:7], s60 offen offset:3072 sc1
    v_mfma_f32_16x16x32_bf16 v[48:51], a[176:179], v[124:127], v[48:51]
    v_mfma_f32_16x16x32_bf16 v[52:55], a[180:183], v[124:127], v[52:55]
    v_mfma_f32_16x16x32_bf16 v[56:59], a[184:187], v[124:127], v[56:59]
    v_mfma_f32_16x16x32_bf16 v[60:63], a[188:191], v[124:127], v[60:63]
    s_waitcnt vmcnt(9)
    buffer_load_dwordx4 v[96:99], v25, s[4:7], s60 offen offset:0 sc1
    v_mfma_f32_16x16x32_bf16 v[48:51], a[192:195], v[128:131], v[48:51]
    v_mfma_f32_16x16x32_bf16 v[52:55], a[196:199], v[128:131], v[52:55]
    v_mfma_f32_16x16x32_bf16 v[56:59], a[200:203], v[128:131], v[56:59]
    buffer_load_dwordx4 v[100:103], v25, s[4:7], s60 offen offset:1024 sc1
    v_mfma_f32_16x16x32_bf16 v[60:63], a[204:207], v[128:131], v[60:63]
    s_waitcnt vmcnt(10)
    v_mfma_f32_16x16x32_bf16 v[48:51], a[208:211], v[132:135], v[48:51]
    v_mfma_f32_16x16x32_bf16 v[52:55], a[212:215], v[132:135], v[52:55]
    v_mfma_f32_16x16x32_bf16 v[56:59], a[216:219], v[132:135], v[56:59]
    buffer_load_dwordx4 v[104:107], v25, s[4:7], s60 offen offset:2048 sc1
    v_mfma_f32_16x16x32_bf16 v[60:63], a[220:223], v[132:135], v[60:63]
    s_waitcnt vmcnt(8)
    v_mfma_f32_16x16x32_bf16 v[64:67], a[0:3], v[80:83], 0
    ds_read_b64 v[40:41], v28
    v_mfma_f32_16x16x32_bf16 v[68:71], a[4:7], v[80:83], 0
    ds_write_b128 v29, v[48:51] offset:0
    v_mfma_f32_16x16x32_bf16 v[72:75], a[8:11], v[80:83], 0
    s_waitcnt vmcnt(7)
    buffer_load_dword v4, v5, s[4:7], s65 offen sc1
    v_mfma_f32_16x16x32_bf16 v[64:67], a[16:19], v[84:87], v[64:67]
    buffer_load_dwordx4 v[108:111], v25, s[4:7], s60 offen offset:3072 sc1
    v_mfma_f32_16x16x32_bf16 v[68:71], a[20:23], v[84:87], v[68:71]
    v_mfma_f32_16x16x32_bf16 v[72:75], a[24:27], v[84:87], v[72:75]
    s_waitcnt vmcnt(8)
    ds_write_b128 v29, v[52:55] offset:64
    v_mfma_f32_16x16x32_bf16 v[64:67], a[32:35], v[88:91], v[64:67]
    s_waitcnt lgkmcnt(2)
    v_lshlrev_b32 v76, 16, v40
    v_and_b32 v77, 0xffff0000, v40
    v_mfma_f32_16x16x32_bf16 v[68:71], a[36:39], v[88:91], v[68:71]
    v_lshlrev_b32 v78, 16, v41
    v_and_b32 v79, 0xffff0000, v41
    v_mfma_f32_16x16x32_bf16 v[72:75], a[40:43], v[88:91], v[72:75]
    buffer_load_dwordx4 v[112:115], v26, s[4:7], s60 offen offset:0 sc1
    v_mfma_f32_16x16x32_bf16 v[76:79], a[12:15], v[80:83], v[76:79]
    buffer_load_dwordx4 v[116:119], v26, s[4:7], s60 offen offset:1024 sc1
    v_mfma_f32_16x16x32_bf16 v[76:79], a[28:31], v[84:87], v[76:79]
    v_add_u32 v7, 1, v7
    v_mfma_f32_16x16x32_bf16 v[76:79], a[44:47], v[88:91], v[76:79]
    s_waitcnt vmcnt(7)
    ds_write_b128 v29, v[56:59] offset:128
    v_mfma_f32_16x16x32_bf16 v[64:67], a[48:51], v[92:95], v[64:67]
    buffer_store_dword v7, v6, s[4:7], s65 offen sc1
    v_mfma_f32_16x16x32_bf16 v[68:71], a[52:55], v[92:95], v[68:71]
    ds_write_b128 v29, v[60:63] offset:192
    v_mfma_f32_16x16x32_bf16 v[72:75], a[56:59], v[92:95], v[72:75]
    buffer_load_dwordx4 v[120:123], v26, s[4:7], s60 offen offset:2048 sc1
    v_mfma_f32_16x16x32_bf16 v[76:79], a[60:63], v[92:95], v[76:79]
    s_waitcnt vmcnt(8)
    v_mfma_f32_16x16x32_bf16 v[64:67], a[64:67], v[96:99], v[64:67]
    v_mfma_f32_16x16x32_bf16 v[68:71], a[68:71], v[96:99], v[68:71]
    buffer_load_dwordx4 v[124:127], v26, s[4:7], s60 offen offset:3072 sc1
    v_mfma_f32_16x16x32_bf16 v[72:75], a[72:75], v[96:99], v[72:75]
    v_mfma_f32_16x16x32_bf16 v[76:79], a[76:79], v[96:99], v[76:79]
    s_waitcnt vmcnt(8)
    s_waitcnt lgkmcnt(0)
    s_barrier
    v_mfma_f32_16x16x32_bf16 v[64:67], a[80:83], v[100:103], v[64:67]
    buffer_load_dwordx4 v[128:131], v27, s[4:7], s60 offen offset:0 sc1
    v_mfma_f32_16x16x32_bf16 v[68:71], a[84:87], v[100:103], v[68:71]
    ds_read2_b64 v[136:139], v220 offset0:16 offset1:0
    ds_read2_b64 v[140:143], v221 offset0:16 offset1:0
    v_mfma_f32_16x16x32_bf16 v[72:75], a[88:91], v[100:103], v[72:75]
    buffer_load_dwordx4 v[132:135], v27, s[4:7], s60 offen offset:1024 sc1
    v_mfma_f32_16x16x32_bf16 v[76:79], a[92:95], v[100:103], v[76:79]
    s_waitcnt vmcnt(9)
    ds_read2_b64 v[144:147], v222 offset0:0 offset1:16
    ds_read2_b64 v[148:151], v223 offset0:0 offset1:16
    v_mfma_f32_16x16x32_bf16 v[64:67], a[96:99], v[104:107], v[64:67]
    s_waitcnt vmcnt(8)
    v_cmp_gt_i32 vcc, s58, v4
    s_add_u32 s60, s60, 131072
    v_mfma_f32_16x16x32_bf16 v[68:71], a[100:103], v[104:107], v[68:71]
    s_andn2_b32 s60, s60, 262144
    v_mfma_f32_16x16x32_bf16 v[72:75], a[104:107], v[104:107], v[72:75]
    s_cbranch_vccnz L_spin_dnodd2_slow
L_ret_dnodd2_slow:
    buffer_load_dword v31, s[12:15], s66 offen offset:0 sc1 lds
    v_mfma_f32_16x16x32_bf16 v[76:79], a[108:111], v[104:107], v[76:79]
    s_waitcnt vmcnt(8)
    buffer_load_dword v32, s[12:15], s66 offen offset:256 sc1 lds
    v_mfma_f32_16x16x32_bf16 v[64:67], a[112:115], v[108:111], v[64:67]
    s_add_u32 s58, s58, 1
    buffer_load_dwordx4 v[80:83], v24, s[4:7], s59 offen offset:0 sc1
    v_mfma_f32_16x16x32_bf16 v[68:71], a[116:119], v[108:111], v[68:71]
    s_mov_b32 s82, s66
    s_waitcnt lgkmcnt(2)
    v_add_f32 v136, v136, v140
    v_mfma_f32_16x16x32_bf16 v[72:75], a[120:123], v[108:111], v[72:75]
    s_add_u32 s66, s66, 16384
    v_add_f32 v137, v137, v141
    v_add_f32 v138, v138, v142
    v_mfma_f32_16x16x32_bf16 v[76:79], a[124:127], v[108:111], v[76:79]
    s_waitcnt vmcnt(9)
    v_add_f32 v139, v139, v143
    s_and_b32 s66, s66, 0x1fffff
    v_mfma_f32_16x16x32_bf16 v[64:67], a[128:131], v[112:115], v[64:67]
    s_waitcnt lgkmcnt(0)
    buffer_load_dwordx4 v[84:87], v24, s[4:7], s59 offen offset:1024 sc1
    v_mfma_f32_16x16x32_bf16 v[68:71], a[132:135], v[112:115], v[68:71]
    v_add_f32 v144, v144, v148
    v_add_f32 v145, v145, v149
    v_mfma_f32_16x16x32_bf16 v[72:75], a[136:139], v[112:115], v[72:75]
    v_add_f32 v146, v146, v150
    v_add_f32 v147, v147, v151
    v_mfma_f32_16x16x32_bf16 v[76:79], a[140:143], v[112:115], v[76:79]
    s_waitcnt vmcnt(9)
    buffer_load_dwordx4 v[88:91], v24, s[4:7], s59 offen offset:2048 sc1
    v_mfma_f32_16x16x32_bf16 v[64:67], a[144:147], v[116:119], v[64:67]
    v_add_f32 v136, v136, v144
    v_add_f32 v137, v137, v145
    v_mfma_f32_16x16x32_bf16 v[68:71], a[148:151], v[116:119], v[68:71]
    v_add_f32 v138, v138, v146
    v_add_f32 v139, v139, v147
    v_mfma_f32_16x16x32_bf16 v[72:75], a[152:155], v[116:119], v[72:75]
    v_cvt_pk_bf16_f32 v140, v136, v137
    v_cvt_pk_bf16_f32 v141, v138, v139
    v_mfma_f32_16x16x32_bf16 v[76:79], a[156:159], v[116:119], v[76:79]
    s_waitcnt vmcnt(8)
    buffer_store_dword v140, v33, s[12:15], s83 offen offset:0
    v_mfma_f32_16x16x32_bf16 v[64:67], a[160:163], v[120:123], v[64:67]
    v_mfma_f32_16x16x32_bf16 v[68:71], a[164:167], v[120:123], v[68:71]
    buffer_store_dword v141, v33, s[12:15], s83 offen offset:64
    v_mfma_f32_16x16x32_bf16 v[72:75], a[168:171], v[120:123], v[72:75]
    s_mov_b32 s83, s76
    v_mfma_f32_16x16x32_bf16 v[76:79], a[172:175], v[120:123], v[76:79]
    s_waitcnt vmcnt(9)
    buffer_load_dwordx4 v[92:95], v24, s[4:7], s59 offen offset:3072 sc1
    v_mfma_f32_16x16x32_bf16 v[64:67], a[176:179], v[124:127], v[64:67]
    v_mfma_f32_16x16x32_bf16 v[68:71], a[180:183], v[124:127], v[68:71]
    v_mfma_f32_16x16x32_bf16 v[72:75], a[184:187], v[124:127], v[72:75]
    v_mfma_f32_16x16x32_bf16 v[76:79], a[188:191], v[124:127], v[76:79]
    s_waitcnt vmcnt(9)
    buffer_load_dwordx4 v[96:99], v25, s[4:7], s59 offen offset:0 sc1
    v_mfma_f32_16x16x32_bf16 v[64:67], a[192:195], v[128:131], v[64:67]
    v_mfma_f32_16x16x32_bf16 v[68:71], a[196:199], v[128:131], v[68:71]
    v_mfma_f32_16x16x32_bf16 v[72:75], a[200:203], v[128:131], v[72:75]
    buffer_load_dwordx4 v[100:103], v25, s[4:7], s59 offen offset:1024 sc1
    v_mfma_f32_16x16x32_bf16 v[76:79], a[204:207], v[128:131], v[76:79]
    s_waitcnt vmcnt(10)
    v_mfma_f32_16x16x32_bf16 v[64:67], a[208:211], v[132:135], v[64:67]
    v_mfma_f32_16x16x32_bf16 v[68:71], a[212:215], v[132:135], v[68:71]
    s_sub_u32 s61, s61, 1
    v_mfma_f32_16x16x32_bf16 v[72:75], a[216:219], v[132:135], v[72:75]
    s_cmp_lg_u32 s61, 0
    buffer_load_dwordx4 v[104:107], v25, s[4:7], s59 offen offset:2048 sc1
    v_mfma_f32_16x16x32_bf16 v[76:79], a[220:223], v[132:135], v[76:79]
    s_cbranch_scc1 L_dn_loop2_slow
    s_nop 0
    ds_write_b128 v29, v[64:67] offset:17408
    ds_write_b128 v29, v[68:71] offset:17472
    s_nop 0
    ds_write_b128 v29, v[72:75] offset:17536
    s_nop 1
    ds_write_b128 v29, v[76:79] offset:17600
    s_waitcnt lgkmcnt(0)
    s_barrier
    ds_read2_b64 v[136:139], v224 offset0:16 offset1:0
    ds_read2_b64 v[140:143], v225 offset0:16 offset1:0
    ds_read2_b64 v[144:147], v226 offset0:0 offset1:16
    ds_read2_b64 v[148:151], v227 offset0:0 offset1:16
    s_waitcnt lgkmcnt(2)
    v_add_f32 v136, v136, v140
    v_add_f32 v137, v137, v141
    v_add_f32 v138, v138, v142
    v_add_f32 v139, v139, v143
    s_waitcnt lgkmcnt(0)
    v_add_f32 v144, v144, v148
    v_add_f32 v145, v145, v149
    v_add_f32 v146, v146, v150
    v_add_f32 v147, v147, v151
    v_add_f32 v136, v136, v144
    v_add_f32 v137, v137, v145
    v_add_f32 v138, v138, v146
    v_add_f32 v139, v139, v147
    v_cvt_pk_bf16_f32 v140, v136, v137
    v_cvt_pk_bf16_f32 v141, v138, v139
    buffer_store_dword v140, v33, s[12:15], s83 offen offset:0
    buffer_store_dword v141, v33, s[12:15], s83 offen offset:64
    s_endpgm
.section .rodata,"a"
.p2align 6
.amdhsa_kernel interleave_layers__sliding_local_dilated__glu_gated_reglu__prompt_kernel
  .amdhsa_next_free_vgpr 512
  .amdhsa_next_free_sgpr 96
  .amdhsa_accum_offset 256
  .amdhsa_group_segment_fixed_size 0
  .amdhsa_kernarg_size 80
  .amdhsa_user_sgpr_count 2
  .amdhsa_user_sgpr_kernarg_segment_ptr 1
  .amdhsa_system_sgpr_workgroup_id_x 1
.end_amdhsa_kernel
```
